```python
import torch

def _softmax(x, axis=-1):
    return torch.softmax(x, dim=axis)
def _gelu(x):
    return torch.nn.functional.gelu(x, approximate="tanh")
def _silu(x):
    return torch.nn.functional.silu(x)
def _sigmoid(x):
    return torch.sigmoid(x)
def _layernorm(x, axis=-1, eps=1e-5):
    m = x.mean(dim=axis, keepdim=True)
    v = x.var(dim=axis, keepdim=True, unbiased=False)
    return (x - m) / torch.sqrt(v + eps)
def _scatter_add(tgt, idx, src, axis=0):
    return tgt.clone().index_add_(axis, idx, src)
def _segment_sum(src, seg, n):
    out = torch.zeros((n,) + src.shape[1:], dtype=src.dtype)
    return out.index_add_(0, seg, src)
def _pad(x, pw):
    flat = tuple(v for pair in reversed(pw) for v in pair)
    return torch.nn.functional.pad(x, flat)

kernel_name = 'recurrent_scan__sliding_local_dilated__glu_gated_reglu__prompt'

def setup_inputs():

    _w = (lambda a: (lambda t: t.to(torch.bfloat16) if t.is_floating_point() else t)(torch.as_tensor(a)))
    def _A_setup():
        B, S, D = 1, 2048, 640
        return {
            "x": _w((lambda *s: torch.randn(*s, dtype=torch.bfloat16) * 0.05)(B, S, D)),
            "wqkv": _w((lambda *s: torch.randn(*s, dtype=torch.bfloat16) * 0.2)(D, 3 * D)),
            "wo": _w((lambda *s: torch.randn(*s, dtype=torch.bfloat16) * 0.2)(D, D)),
        }
    _A_in = _A_setup()

    def _B_setup():
        B, S, D, F = 1, 2048, 640, 1728
        return {
            "x": _w((lambda *s: torch.randn(*s, dtype=torch.bfloat16) * 0.05)(B, S, D)),
            "W_gate": _w((lambda *s: torch.randn(*s, dtype=torch.bfloat16) * 0.1)(D, F) * (2.0 / D) ** 0.5),
            "W_up": _w((lambda *s: torch.randn(*s, dtype=torch.bfloat16) * 0.1)(D, F) * (2.0 / D) ** 0.5),
            "W_down": _w((lambda *s: torch.randn(*s, dtype=torch.bfloat16) * 0.1)(F, D) * (1.0 / F) ** 0.5),
        }
    _B_in = _B_setup()

    return {
        "A_x": _A_in["x"],
        "A_wqkv": _A_in["wqkv"],
        "A_wo": _A_in["wo"],
        "B_x": _B_in["x"],
        "B_W_gate": _B_in["W_gate"],
        "B_W_up": _B_in["W_up"],
        "B_W_down": _B_in["W_down"],
    }

def reference(A_x, A_wqkv, A_wo, B_x, B_W_gate, B_W_up, B_W_down):
    def _A_ref(x, wqkv, wo):
        B, S, D = x.shape
        H = 32; Dh = D // H
        W, dil = 8, 2
        qkv = (lambda x, *d: x.permute(*d))((x @ wqkv).reshape(B, S, 3, H, Dh), 2, 0, 3, 1, 4)
        q, k, v = qkv[0], qkv[1], qkv[2]
        scale = Dh ** -0.5
        pos = torch.arange(S)
        off = torch.arange(W) * dil
        idx = pos[:, None] - off[None, :]
        mask = idx >= 0
        idx_c = torch.where(mask, idx, 0).reshape(-1)
        kg = k[:, :, idx_c, :].reshape(B, H, S, W, Dh)
        vg = v[:, :, idx_c, :].reshape(B, H, S, W, Dh)
        logits = torch.einsum("bhsd,bhswd->bhsw", q, kg) * scale
        logits = torch.where(mask[None, None, :, :], logits, -1e9)
        attn = _softmax(logits, axis=-1)
        o = torch.einsum("bhsw,bhswd->bhsd", attn, vg)
        return (lambda x, *d: x.permute(*d))(o, 0, 2, 1, 3).reshape(B, S, D) @ wo

    def _B_ref(x, W_gate, W_up, W_down):
        gate = torch.einsum("bsd,df->bsf", x, W_gate)
        up = torch.einsum("bsd,df->bsf", x, W_up)
        gate = gate * (lambda x, dt: x.to(dt))(gate > 0, gate.dtype)
        h = gate * up
        return torch.einsum("bsf,fd->bsd", h, W_down)

    x = A_x
    xn = _layernorm(x, axis=-1)
    s = _A_ref(xn, A_wqkv, A_wo)
    g = _silu(_B_ref(xn, B_W_gate, B_W_up, B_W_down))
    return x + s * g
```

```asm
; @launch grid=(256,1,1) block=(256,1,1) lds=163840
.amdgcn_target "amdgcn-amd-amdhsa--gfx950"
.text
.globl recurrent_scan__sliding_local_dilated__glu_gated_reglu__prompt_kernel
.p2align 12
.p2align 8
.type recurrent_scan__sliding_local_dilated__glu_gated_reglu__prompt_kernel,@function
recurrent_scan__sliding_local_dilated__glu_gated_reglu__prompt_kernel:
    s_load_dwordx16 s[4:19], s[0:1], 0
    s_load_dwordx4 s[20:23], s[0:1], 64
    s_cmp_lt_u32 s2, 96
    s_cbranch_scc1 L_qkv
    s_cmp_lt_u32 s2, 256
    s_cbranch_scc1 L_go
    s_endpgm
L_ret:
    s_setpc_b64 s[10:11]
L_go:
    s_getpc_b64 s[82:83]
L_pc:
    s_and_b32 s3, s2, 0xf8
    s_lshl_b32 s3, s3, 9
    s_sub_u32 s3, s3, 49152
    v_lshlrev_b32 v5, 4, v0
    v_add_u32 v5, s3, v5
    v_min_u32 v5, L_codeend-L_pc-4, v5
    global_load_dword a255, v5, s[82:83]
    v_lshrrev_b32 v1, 6, v0
    s_lshr_b32 s63, s2, 3
    v_readfirstlane_b32 s60, v1
    v_and_b32 v1, 63, v0
    s_bfe_u32 s64, s2, 0x10002
    s_and_b32 s65, s2, 3
    s_lshl_b32 s67, s60, 10
    s_and_b32 s66, s2, 0xfb
    s_sub_u32 s66, s66, 248
    s_cmp_lt_u32 s66, 3
    s_cbranch_scc1 L_spare
    s_mul_i32 s65, s65, 19
    s_add_u32 s65, s65, s63
    s_sub_u32 s65, s65, 12
    s_mul_i32 s62, s65, 94
    s_lshr_b32 s62, s62, 10
    s_mul_i32 s66, s62, 11
    s_sub_u32 s65, s65, s66
    s_mul_i32 s61, s64, 5
    s_add_u32 s61, s61, s65
    s_add_u32 s64, s64, 5
    s_cmp_ge_u32 s65, s64
    s_cselect_b32 s66, 5, 0
    s_addc_u32 s62, s62, s62
    s_sub_u32 s61, s61, s66
L_glu:
    s_mul_i32 s63, s61, 188
    v_lshrrev_b32 v48, 3, v0
    v_lshrrev_b32 v49, 4, v0
    v_xor_b32 v50, v49, v0
    v_and_b32 v50, 7, v50
    v_cmp_gt_u32 vcc, 28, v48
    v_add_u32_e64 v48, s63, v48
    v_mul_u32_u24 v48, 1280, v48
    v_lshl_add_u32 v5, v50, 4, v48
    v_add_u32 v6, 40960, v5
    v_add_u32 v7, 81920, v5
    v_add_u32 v8, 122880, v5
    v_add_u32 v9, 163840, v5
    v_add_u32 v10, 204800, v5
    v_mov_b32 v51, 2147418112
    v_cndmask_b32 v10, v51, v10, vcc
    v_lshrrev_b32 v48, 4, v1
    v_lshlrev_b32 v49, 1, v48
    v_xor_b32 v49, v49, v0
    v_and_b32 v49, 15, v49
    s_cmp_eq_u32 s62, 13
    s_cselect_b32 s65, 8, 16
    v_mul_u32_u24 v48, 3456, v48
    s_mul_i32 s64, s60, 55296
    s_lshl_b32 s63, s62, 8
    s_add_u32 s64, s64, s63
    v_cmp_gt_u32 vcc, s65, v49
    v_lshlrev_b32 v50, 4, v49
    v_add3_u32 v50, v50, v48, s64
    v_cndmask_b32 v11, v51, v50, vcc
    v_add_u32 v12, 12800, v11
    v_xor_b32 v49, 8, v49
    s_add_u32 s64, s64, 25600
    v_cmp_gt_u32 vcc, s65, v49
    v_lshlrev_b32 v50, 4, v49
    v_add3_u32 v50, v50, v48, s64
    v_cndmask_b32 v13, v51, v50, vcc
    v_add_u32 v14, 12800, v13
    s_lshl_b32 s68, s60, 12
    s_cmp_eq_u32 s60, 3
    s_cselect_b32 s73, 0x00ffffff, -1
    s_mov_b32 s72, -1
    s_and_b32 s63, s2, 4
    s_lshl_b32 s63, s63, 8
    s_and_b32 s64, s2, 0xf8
    s_lshl2_add_u32 s63, s64, s63
    s_and_b32 s64, s2, 3
    s_lshl3_add_u32 s63, s64, s63
    v_lshrrev_b32 v44, 5, v0
    v_add_u32 v44, s63, v44
    v_mul_u32_u24 v46, 1280, v44
    v_and_b32_e64 v47, 31, v0
    v_lshl_add_u32 v45, v47, 2, v46
    s_mov_b32 s26, 2621440
    s_mov_b32 s27, 0x20000
    s_mov_b32 s30, 2211840
    s_mov_b32 s31, 0x20000
    s_mov_b32 s34, 2211840
    s_mov_b32 s35, 0x20000
    s_mov_b32 s58, 2211840
    s_mov_b32 s59, 0x20000
    s_cmp_lt_u32 s60, 2
    s_waitcnt lgkmcnt(0)
    s_mov_b64 s[24:25], s[4:5]
    s_cselect_b64 s[56:57], s[12:13], s[14:15]
    s_mov_b64 s[28:29], s[12:13]
    s_mov_b64 s[32:33], s[14:15]
    s_add_u32 m0, s67, 106496
    s_mov_b32 s70, 0
    buffer_load_dwordx4 v5, s[24:27], s70 offen lds
    s_add_u32 m0, s67, 110592
    s_nop 0
    buffer_load_dwordx4 v6, s[24:27], s70 offen lds
    s_add_u32 m0, s67, 114688
    s_nop 0
    buffer_load_dwordx4 v7, s[24:27], s70 offen lds
    s_add_u32 m0, s67, 118784
    s_nop 0
    buffer_load_dwordx4 v8, s[24:27], s70 offen lds
    s_add_u32 m0, s67, 122880
    s_nop 0
    buffer_load_dwordx4 v9, s[24:27], s70 offen lds
    s_add_u32 m0, s67, 126976
    s_mov_b64 exec, s[72:73]
    buffer_load_dwordx4 v10, s[24:27], s70 offen lds
    s_mov_b64 exec, -1
    s_add_u32 m0, s68, 90112
    s_mov_b32 s71, 0
    buffer_load_dwordx4 v11, s[28:31], s71 offen lds
    buffer_load_dwordx4 v12, s[28:31], s71 offen offset:1024 lds
    buffer_load_dwordx4 v13, s[28:31], s71 offen offset:2048 lds
    buffer_load_dwordx4 v14, s[28:31], s71 offen offset:3072 lds
    v_mul_u32_u24 v48, 21846, v1
    v_lshrrev_b32 v48, 16, v48
    v_mul_u32_u24 v48, 29, v48
    s_mul_i32 s63, s61, 3
    s_min_u32 s63, s63, 29
    v_add3_u32 v48, v48, v1, s63
    v_mul_u32_u24 v48, 3456, v48
    v_cmp_gt_u32 vcc, 18, v1
    s_and_b32 s63, s60, 1
    s_lshl1_add_u32 s63, s62, s63
    s_min_u32 s63, s63, 26
    s_lshl_b32 s63, s63, 7
    v_add_u32 v48, s63, v48
    v_cndmask_b32 v52, v51, v48, vcc
    v_mov_b32 v60, 0x3f803f80
    v_mov_b32 v61, 0x3f803f80
    v_mov_b32 v62, 0x3f803f80
    v_mov_b32 v63, 0x3f803f80
    v_and_b32 v48, 7, v0
    s_and_b32 s63, s60, 1
    s_mul_i32 s63, s63, 106496
    s_add_u32 s63, s63, 24448
    v_lshl_add_u32 v48, v48, 4, s63
    ds_write_b128 v48, v[60:63]
    v_and_b32 v48, 15, v0
    v_bfe_u32 v49, v0, 4, 2
    v_lshrrev_b32 v50, 1, v48
    v_xor_b32 v50, v50, v49
    v_lshlrev_b32 v50, 4, v50
    v_lshl_add_u32 v50, v48, 7, v50
    s_lshr_b32 s63, s60, 1
    s_mul_i32 s63, s63, 12288
    v_add_u32 v56, s63, v50
    v_xor_b32 v57, 64, v56
    v_add_u32 v54, 106496, v56
    v_add_u32 v55, 106496, v57
    v_bfe_u32 v48, v0, 2, 2
    v_lshl_add_u32 v50, v49, 3, v48
    v_and_b32 v51, 3, v0
    v_lshlrev_b32 v51, 3, v51
    v_lshl_add_u32 v50, v50, 8, v51
    v_add_u32 v50, 40960, v50
    v_bfe_u32 v51, v0, 2, 3
    s_and_b32 s63, s60, 1
    s_lshl_b32 s63, s63, 2
    v_xor_b32 v51, s63, v51
    v_lshl_add_u32 v15, v51, 5, v50
    v_xor_b32 v16, 32, v15
    v_xor_b32 v17, 64, v15
    v_xor_b32 v18, 96, v15
    v_subrev_u32 v60, 16384, v15
    v_subrev_u32 v61, 16384, v16
    v_subrev_u32 v62, 16384, v17
    v_subrev_u32 v63, 16384, v18
    s_mov_b64 exec, 0
    s_call_b64 s[10:11], L_hop_glu
    s_mov_b64 exec, -1
    s_add_u32 m0, s68, 73728
    s_nop 0
    buffer_load_dwordx4 v11, s[32:35], s71 offen lds
    buffer_load_dwordx4 v12, s[32:35], s71 offen offset:1024 lds
    buffer_load_dwordx4 v13, s[32:35], s71 offen offset:2048 lds
    buffer_load_dwordx4 v14, s[32:35], s71 offen offset:3072 lds
    s_add_u32 m0, s67, 0
    s_mov_b32 s70, 128
    buffer_load_dwordx4 v5, s[24:27], s70 offen lds
    s_add_u32 m0, s67, 4096
    s_nop 0
    buffer_load_dwordx4 v6, s[24:27], s70 offen lds
    s_add_u32 m0, s67, 8192
    s_nop 0
    buffer_load_dwordx4 v7, s[24:27], s70 offen lds
    s_add_u32 m0, s67, 12288
    s_nop 0
    buffer_load_dwordx4 v8, s[24:27], s70 offen lds
    s_add_u32 m0, s67, 16384
    s_nop 0
    buffer_load_dwordx4 v9, s[24:27], s70 offen lds
    s_add_u32 m0, s67, 20480
    s_mov_b64 exec, s[72:73]
    buffer_load_dwordx4 v10, s[24:27], s70 offen lds
    s_mov_b64 exec, -1
    s_mov_b32 s66, 221184
    buffer_load_dword a255, v52, s[56:59], s66 offen
    buffer_load_dword v26, v45, s[24:27], 0 offen offset:256
    buffer_load_dword v27, v45, s[24:27], 0 offen offset:384
    s_branch L_glu2
L_hop_glu:
    s_cmp_eq_u32 s60, 0
    s_cbranch_scc1 L_pg0
    s_cmp_eq_u32 s60, 1
    s_cbranch_scc1 L_pg1
    s_cmp_eq_u32 s60, 2
    s_cbranch_scc1 L_pg2
    s_branch L_pg3
L_qkv:
    v_lshrrev_b32 v1, 6, v0
    s_lshr_b32 s63, s2, 3
    v_readfirstlane_b32 s60, v1
    v_and_b32 v1, 63, v0
    s_bfe_u32 s64, s2, 0x10002
    s_and_b32 s65, s2, 3
    s_lshl_b32 s67, s60, 10
    s_lshr_b32 s61, s63, 1
    s_mul_i32 s66, s64, 6
    s_add_u32 s61, s61, s66
    s_and_b32 s62, s63, 1
    s_lshl1_add_u32 s62, s65, s62
    s_mul_i32 s63, s61, 176
    s_sub_u32 s63, s63, 16
    v_lshrrev_b32 v60, 3, v0
    v_lshrrev_b32 v61, 4, v0
    v_xor_b32 v61, v61, v0
    v_and_b32 v61, 7, v61
    v_add_u32 v62, s63, v60
    v_cmp_le_i32 vcc, 0, v62
    v_mul_i32_i24 v60, 1280, v62
    v_lshl_add_u32 v5, v61, 4, v60
    v_add_u32 v6, 40960, v5
    v_add_u32 v7, 81920, v5
    v_add_u32 v8, 122880, v5
    v_add_u32 v9, 163840, v5
    v_add_u32 v10, 204800, v5
    v_mov_b32 v63, 2147418112
    v_cndmask_b32 v5, v63, v5, vcc
    s_mul_i32 s63, s62, 160
    s_mul_i32 s64, s60, 192
    v_add_u32 v60, s64, v1
    v_mul_u32_u24 v61, 745, v60
    v_lshrrev_b32 v61, 16, v61
    v_mul_u32_u24 v62, 88, v61
    v_sub_u32 v60, v60, v62
    v_cmp_gt_u32 vcc, 80, v60
    v_mul_u32_u24 v62, 6554, v60
    v_lshrrev_b32 v62, 16, v62
    v_mul_u32_u24 v61, 30720, v61
    v_mul_u32_u24 v62, 3680, v62
    v_lshl_add_u32 v61, v60, 4, v61
    v_add3_u32 v61, v61, v62, s63
    v_cndmask_b32 v70, v63, v61, vcc
    s_add_u32 s64, s64, 64
    s_sub_u32 s63, s63, 1024
    v_add_u32 v60, s64, v1
    v_mul_u32_u24 v61, 745, v60
    v_lshrrev_b32 v61, 16, v61
    v_mul_u32_u24 v62, 88, v61
    v_sub_u32 v60, v60, v62
    v_cmp_gt_u32 vcc, 80, v60
    v_mul_u32_u24 v62, 6554, v60
    v_lshrrev_b32 v62, 16, v62
    v_mul_u32_u24 v61, 30720, v61
    v_mul_u32_u24 v62, 3680, v62
    v_lshl_add_u32 v61, v60, 4, v61
    v_add3_u32 v61, v61, v62, s63
    v_cndmask_b32 v71, v63, v61, vcc
    s_add_u32 s64, s64, 64
    s_sub_u32 s63, s63, 1024
    v_add_u32 v60, s64, v1
    v_mul_u32_u24 v61, 745, v60
    v_lshrrev_b32 v61, 16, v61
    v_mul_u32_u24 v62, 88, v61
    v_cmp_gt_u32 s[74:75], 8, v61
    v_sub_u32 v60, v60, v62
    v_cmp_gt_u32 vcc, 80, v60
    v_mul_u32_u24 v62, 6554, v60
    v_lshrrev_b32 v62, 16, v62
    v_mul_u32_u24 v61, 30720, v61
    v_mul_u32_u24 v62, 3680, v62
    v_lshl_add_u32 v61, v60, 4, v61
    v_add3_u32 v61, v61, v62, s63
    v_cndmask_b32 v72, v63, v61, vcc
    v_cndmask_b32 v72, v63, v72, s[74:75]
    s_mul_i32 s68, s60, 3072
    s_cmp_eq_u32 s60, 0
    s_cselect_b32 s72, 0xffffff00, -1
    s_mov_b32 s73, -1
    s_and_b32 s63, s2, 4
    s_lshl_b32 s63, s63, 8
    s_and_b32 s64, s2, 0xf8
    s_lshl2_add_u32 s63, s64, s63
    s_and_b32 s64, s2, 3
    s_lshl3_add_u32 s63, s64, s63
    v_lshrrev_b32 v42, 5, v0
    v_add_u32 v42, s63, v42
    v_mul_u32_u24 v44, 1280, v42
    v_and_b32 v45, 31, v0
    v_lshl_add_u32 v43, v45, 2, v44
    s_mov_b32 s26, 2621440
    s_mov_b32 s27, 0x20000
    s_mov_b32 s30, 2457600
    s_mov_b32 s31, 0x20000
    s_waitcnt lgkmcnt(0)
    s_mov_b64 s[28:29], s[6:7]
    s_mov_b64 s[24:25], s[4:5]
    s_add_u32 m0, s67, 0
    s_mov_b32 s70, 0
    s_mov_b64 exec, s[72:73]
    buffer_load_dwordx4 v5, s[24:27], s70 offen lds
    s_mov_b64 exec, -1
    s_add_u32 m0, s67, 4096
    s_nop 0
    buffer_load_dwordx4 v6, s[24:27], s70 offen lds
    s_add_u32 m0, s67, 8192
    s_nop 0
    buffer_load_dwordx4 v7, s[24:27], s70 offen lds
    s_add_u32 m0, s67, 12288
    s_nop 0
    buffer_load_dwordx4 v8, s[24:27], s70 offen lds
    s_add_u32 m0, s67, 16384
    s_nop 0
    buffer_load_dwordx4 v9, s[24:27], s70 offen lds
    s_add_u32 m0, s67, 20480
    s_nop 0
    buffer_load_dwordx4 v10, s[24:27], s70 offen lds
    s_add_u32 m0, s68, 49152
    s_mov_b32 s71, 2560
    buffer_load_dwordx4 v70, s[28:31], s71 offen lds
    buffer_load_dwordx4 v71, s[28:31], s71 offen offset:1024 lds
    buffer_load_dwordx4 v72, s[28:31], s71 offen offset:2048 lds
    s_lshl_b32 s63, s61, 2
    s_add_u32 s63, s63, s60
    s_lshl_b32 s63, s63, 4
    s_add_u32 s63, s63, s62
    s_mul_i32 s63, s63, 160
    v_cmp_gt_u32 vcc, 24, v1
    v_lshrrev_b32 v60, 2, v1
    v_mul_u32_u24 v60, 122880, v60
    v_and_b32 v61, 2, v1
    v_mul_u32_u24 v61, 640, v61
    v_and_b32 v62, 1, v1
    v_mul_u32_u24 v62, 156, v62
    v_add3_u32 v60, v60, v61, v62
    v_add_u32 v60, s63, v60
    v_cndmask_b32 v74, v63, v60, vcc
    v_mov_b32 v64, 0x3f803f80
    v_mov_b32 v65, 0x3f803f80
    v_mov_b32 v66, 0x3f803f80
    v_mov_b32 v67, 0x3f803f80
    v_and_b32 v60, 7, v0
    s_and_b32 s63, s60, 1
    s_mul_i32 s63, s63, 24576
    v_lshl_add_u32 v60, v60, 4, s63
    ds_write_b128 v60, v[64:67]
    v_and_b32 v60, 15, v0
    v_bfe_u32 v61, v0, 4, 2
    v_lshrrev_b32 v62, 1, v60
    v_xor_b32 v62, v62, v61
    v_lshlrev_b32 v62, 4, v62
    v_lshl_add_u32 v62, v60, 7, v62
    s_mul_i32 s63, s60, 6144
    v_add_u32 v11, s63, v62
    v_xor_b32 v12, 64, v11
    v_mul_u32_u24 v62, 1408, v61
    v_bfe_u32 v63, v0, 2, 2
    v_mul_u32_u24 v63, 160, v63
    v_add_u32 v62, v62, v63
    v_add_u32 v62, 49152, v62
    v_and_b32 v63, 3, v0
    v_lshl_add_u32 v15, v63, 3, v62
    v_mul_u32_u24 v63, 40, v63
    v_add3_u32 v16, v62, v63, 32
    v_add_u32 v13, 61440, v15
    v_add_u32 v14, 61440, v16
    s_mov_b64 exec, 0
    s_call_b64 s[10:11], L_hop_qkv
    s_mov_b64 exec, -1
    s_add_u32 m0, s68, 61440
    s_mov_b32 s71, 1280
    buffer_load_dwordx4 v70, s[28:31], s71 offen lds
    buffer_load_dwordx4 v71, s[28:31], s71 offen offset:1024 lds
    buffer_load_dwordx4 v72, s[28:31], s71 offen offset:2048 lds
    s_add_u32 m0, s68, 73728
    s_mov_b32 s71, 0
    buffer_load_dwordx4 v70, s[28:31], s71 offen lds
    buffer_load_dwordx4 v71, s[28:31], s71 offen offset:1024 lds
    buffer_load_dwordx4 v72, s[28:31], s71 offen offset:2048 lds
    s_mov_b32 s66, 245760
    buffer_load_dword a255, v74, s[28:31], s66 offen
    buffer_load_dword v24, v43, s[24:27], 0 offen offset:256
    buffer_load_dword v25, v43, s[24:27], 0 offen offset:384
    s_branch L_qkv2
L_hop_qkv:
    s_cmp_eq_u32 s60, 0
    s_cbranch_scc1 L_pg6
    s_cmp_eq_u32 s60, 1
    s_cbranch_scc1 L_pg7
    s_cmp_eq_u32 s60, 2
    s_cbranch_scc1 L_pg8
    s_branch L_pg9
.p2align 12
L_glu2:
    s_waitcnt vmcnt(13) lgkmcnt(0)
    s_barrier
    ds_read_b64_tr_b16 a[48:49], v17 offset:49152
    ds_read_b64_tr_b16 a[50:51], v17 offset:50176
    ds_read_b64_tr_b16 a[52:53], v17 offset:57344
    ds_read_b64_tr_b16 a[54:55], v17 offset:58368
    ds_read_b64_tr_b16 a[56:57], v18 offset:49152
    ds_read_b64_tr_b16 a[58:59], v18 offset:50176
    ds_read_b64_tr_b16 a[60:61], v18 offset:57344
    ds_read_b64_tr_b16 a[62:63], v18 offset:58368
    ds_read_b128 a[40:43], v54 offset:10240
    ds_read_b128 a[44:47], v55 offset:10240
    ds_read_b128 a[32:35], v54 offset:8192
    ds_read_b128 a[36:39], v55 offset:8192
    s_waitcnt lgkmcnt(2)
    v_mfma_f32_16x16x32_bf16 v[132:135], a[48:51], a[40:43], 0
    s_add_u32 m0, s68, 57344
    s_mov_b32 s71, 221184
    ds_read_b128 a[24:27], v54 offset:6144
    ds_read_b128 a[28:31], v55 offset:6144
    v_mfma_f32_16x16x32_bf16 v[132:135], a[52:55], a[44:47], v[132:135]
    buffer_load_dwordx4 v11, s[28:31], s71 offen lds
    s_mul_i32 s69, s60, 5120
    v_mfma_f32_16x16x32_bf16 v[156:159], a[60:63], a[44:47], 0
    ds_read_b128 a[16:19], v54 offset:4096
    s_add_u32 s69, s69, 143360
    s_mul_i32 s63, s61, 14
    v_mfma_f32_16x16x32_bf16 v[156:159], a[56:59], a[40:43], v[156:159]
    ds_read_b128 a[20:23], v55 offset:4096
    s_add_u32 s63, s63, s62
    s_waitcnt lgkmcnt(4)
    v_mfma_f32_16x16x32_bf16 v[152:155], a[56:59], a[32:35], 0
    ds_read_b128 a[8:11], v54 offset:2048
    s_lshl_b32 s100, s63, 7
    s_add_u32 s100, s100, 32768
    v_mfma_f32_16x16x32_bf16 v[152:155], a[60:63], a[36:39], v[152:155]
    ds_read_b128 a[12:15], v55 offset:2048
    s_min_u32 s63, s63, 147
    s_and_b32 s64, s63, 1
    v_mfma_f32_16x16x32_bf16 v[128:131], a[52:55], a[36:39], 0
    buffer_load_dwordx4 v12, s[28:31], s71 offen offset:1024 lds
    s_lshl2_add_u32 s64, s64, s60
    v_mfma_f32_16x16x32_bf16 v[128:131], a[48:51], a[32:35], v[128:131]
    ds_read_b128 a[0:3], v54 offset:0
    s_lshr_b32 s63, s63, 1
    s_waitcnt lgkmcnt(5)
    v_mfma_f32_16x16x32_bf16 v[124:127], a[48:51], a[24:27], 0
    ds_read_b128 a[4:7], v55 offset:0
    s_mul_i32 s80, s64, 378880
    s_mul_i32 s65, s63, 5120
    v_mfma_f32_16x16x32_bf16 v[124:127], a[52:55], a[28:31], v[124:127]
    ds_read_b64_tr_b16 a[64:65], v15 offset:49152
    s_add_u32 s80, s80, s65
    s_mul_i32 s64, s64, 160
    v_mfma_f32_16x16x32_bf16 v[148:151], a[60:63], a[28:31], 0
    ds_read_b64_tr_b16 a[66:67], v15 offset:50176
    s_lshl_b32 s65, s63, 5
    s_sub_u32 s65, s65, 640
    v_mfma_f32_16x16x32_bf16 v[148:151], a[56:59], a[24:27], v[148:151]
    buffer_load_dwordx4 v13, s[28:31], s71 offen offset:2048 lds
    s_waitcnt lgkmcnt(6)
    v_mfma_f32_16x16x32_bf16 v[144:147], a[56:59], a[16:19], 0
    ds_read_b64_tr_b16 a[68:69], v15 offset:57344
    s_mul_i32 s77, s63, 160
    s_sub_u32 s77, s77, 2544
    v_mfma_f32_16x16x32_bf16 v[144:147], a[60:63], a[20:23], v[144:147]
    ds_read_b64_tr_b16 a[70:71], v15 offset:58368
    s_mov_b32 s50, 2211840
    s_mov_b32 s51, 0x20000
    v_mfma_f32_16x16x32_bf16 v[120:123], a[52:55], a[20:23], 0
    ds_read_b64_tr_b16 a[72:73], v16 offset:49152
    s_cmp_lt_u32 s63, 20
    s_cselect_b32 s65, s77, s65
    s_cselect_b32 s76, 20, 4
    v_mfma_f32_16x16x32_bf16 v[120:123], a[48:51], a[16:19], v[120:123]
    ds_read_b64_tr_b16 a[74:75], v16 offset:50176
    s_waitcnt lgkmcnt(8)
    v_mfma_f32_16x16x32_bf16 v[116:119], a[48:51], a[8:11], 0
    buffer_load_dwordx4 v14, s[28:31], s71 offen offset:3072 lds
    v_mfma_f32_16x16x32_bf16 v[116:119], a[52:55], a[12:15], v[116:119]
    ds_read_b64_tr_b16 a[76:77], v16 offset:57344
    ds_read_b64_tr_b16 a[78:79], v16 offset:58368
    v_mfma_f32_16x16x32_bf16 v[140:143], a[60:63], a[12:15], 0
    s_cmp_lt_u32 s63, 20
    s_cselect_b64 s[48:49], s[8:9], s[16:17]
    s_cmov_b32 s50, 819200
    s_lshl_b32 s101, s76, 2
    v_mfma_f32_16x16x32_bf16 v[140:143], a[56:59], a[8:11], v[140:143]
    s_mul_i32 s77, s63, 40
    s_waitcnt lgkmcnt(8)
    v_mfma_f32_16x16x32_bf16 v[136:139], a[56:59], a[0:3], 0
    s_add_u32 m0, s68, 40960
    s_cmp_lt_u32 s63, 16
    s_cselect_b32 s65, s77, s65
    s_cmov_b32 s76, 4
    s_cmov_b32 s101, 20
    v_mfma_f32_16x16x32_bf16 v[136:139], a[60:63], a[4:7], v[136:139]
    buffer_load_dwordx4 v11, s[32:35], s71 offen lds
    v_add_u32 v48, 0, v1
    v_mfma_f32_16x16x32_bf16 v[112:115], a[52:55], a[4:7], 0
    v_mul_u32_u24 v49, 6554, v48
    v_lshrrev_b32 v49, 16, v49
    v_mul_u32_u24 v50, 10, v49
    v_mfma_f32_16x16x32_bf16 v[112:115], a[48:51], a[0:3], v[112:115]
    s_waitcnt vmcnt(14) lgkmcnt(0)
    s_barrier
    v_mfma_f32_16x16x32_bf16 v[84:87], a[64:67], a[40:43], 0
    ds_read_b64_tr_b16 a[48:49], v17 offset:32768
    v_sub_u32 v48, v48, v50
    v_lshrrev_b32 v50, 4, v49
    v_mfma_f32_16x16x32_bf16 v[84:87], a[68:71], a[44:47], v[84:87]
    v_mul_u32_u24 v50, s101, v50
    v_bfe_u32 v51, v49, 2, 2
    v_mad_u32_u24 v50, v51, s76, v50
    v_mfma_f32_16x16x32_bf16 v[108:111], a[76:79], a[44:47], 0
    ds_read_b64_tr_b16 a[50:51], v17 offset:33792
    v_and_b32 v49, 3, v49
    v_add3_u32 v50, v50, v49, s65
    v_mfma_f32_16x16x32_bf16 v[108:111], a[72:75], a[40:43], v[108:111]
    buffer_load_dwordx4 v12, s[32:35], s71 offen offset:1024 lds
    v_mul_u32_u24 v50, 1280, v50
    v_mfma_f32_16x16x32_bf16 v[104:107], a[72:75], a[32:35], 0
    ds_read_b64_tr_b16 a[52:53], v17 offset:40960
    v_lshlrev_b32 v48, 4, v48
    v_add3_u32 v19, v48, v50, s64
    v_mfma_f32_16x16x32_bf16 v[104:107], a[76:79], a[36:39], v[104:107]
    v_add_u32 v48, 64, v1
    v_mul_u32_u24 v49, 6554, v48
    v_lshrrev_b32 v49, 16, v49
    v_mfma_f32_16x16x32_bf16 v[80:83], a[68:71], a[36:39], 0
    ds_read_b64_tr_b16 a[54:55], v17 offset:41984
    v_mul_u32_u24 v50, 10, v49
    v_sub_u32 v48, v48, v50
    v_mfma_f32_16x16x32_bf16 v[80:83], a[64:67], a[32:35], v[80:83]
    v_lshrrev_b32 v50, 4, v49
    v_mul_u32_u24 v50, s101, v50
    v_bfe_u32 v51, v49, 2, 2
    v_mfma_f32_16x16x32_bf16 v[76:79], a[64:67], a[24:27], 0
    buffer_load_dwordx4 v13, s[32:35], s71 offen offset:2048 lds
    v_mad_u32_u24 v50, v51, s76, v50
    v_mfma_f32_16x16x32_bf16 v[76:79], a[68:71], a[28:31], v[76:79]
    ds_read_b64_tr_b16 a[56:57], v18 offset:32768
    v_and_b32 v49, 3, v49
    v_add3_u32 v50, v50, v49, s65
    v_mfma_f32_16x16x32_bf16 v[100:103], a[76:79], a[28:31], 0
    v_mul_u32_u24 v50, 1280, v50
    v_lshlrev_b32 v48, 4, v48
    v_add3_u32 v20, v48, v50, s64
    v_mfma_f32_16x16x32_bf16 v[100:103], a[72:75], a[24:27], v[100:103]
    ds_read_b64_tr_b16 a[58:59], v18 offset:33792
    v_add_u32 v48, 128, v1
    v_mul_u32_u24 v49, 6554, v48
    v_mfma_f32_16x16x32_bf16 v[96:99], a[72:75], a[16:19], 0
    v_lshrrev_b32 v49, 16, v49
    v_mul_u32_u24 v50, 10, v49
    v_sub_u32 v48, v48, v50
    v_mfma_f32_16x16x32_bf16 v[96:99], a[76:79], a[20:23], v[96:99]
    buffer_load_dwordx4 v14, s[32:35], s71 offen offset:3072 lds
    v_lshrrev_b32 v50, 4, v49
    v_mfma_f32_16x16x32_bf16 v[72:75], a[68:71], a[20:23], 0
    ds_read_b64_tr_b16 a[60:61], v18 offset:40960
    v_mul_u32_u24 v50, s101, v50
    v_bfe_u32 v51, v49, 2, 2
    v_mfma_f32_16x16x32_bf16 v[72:75], a[64:67], a[16:19], v[72:75]
    v_mad_u32_u24 v50, v51, s76, v50
    v_and_b32 v49, 3, v49
    v_add3_u32 v50, v50, v49, s65
    v_mfma_f32_16x16x32_bf16 v[68:71], a[64:67], a[8:11], 0
    s_add_u32 m0, s67, 106496
    ds_read_b64_tr_b16 a[62:63], v18 offset:41984
    v_mul_u32_u24 v50, 1280, v50
    v_lshlrev_b32 v48, 4, v48
    v_mfma_f32_16x16x32_bf16 v[68:71], a[68:71], a[12:15], v[68:71]
    s_mov_b32 s70, 256
    v_add3_u32 v21, v48, v50, s64
    v_add_u32 v48, 192, v1
    v_mul_u32_u24 v49, 6554, v48
    v_mfma_f32_16x16x32_bf16 v[92:95], a[76:79], a[12:15], 0
    buffer_load_dwordx4 v5, s[24:27], s70 offen lds
    v_lshrrev_b32 v49, 16, v49
    v_mfma_f32_16x16x32_bf16 v[92:95], a[72:75], a[8:11], v[92:95]
    v_mul_u32_u24 v50, 10, v49
    v_sub_u32 v48, v48, v50
    v_lshrrev_b32 v50, 4, v49
    v_mfma_f32_16x16x32_bf16 v[88:91], a[72:75], a[0:3], 0
    v_mul_u32_u24 v50, s101, v50
    v_bfe_u32 v51, v49, 2, 2
    v_mad_u32_u24 v50, v51, s76, v50
    v_mfma_f32_16x16x32_bf16 v[88:91], a[76:79], a[4:7], v[88:91]
    v_and_b32 v49, 3, v49
    v_add3_u32 v50, v50, v49, s65
    v_mul_u32_u24 v50, 1280, v50
    v_mfma_f32_16x16x32_bf16 v[64:67], a[68:71], a[4:7], 0
    v_lshlrev_b32 v48, 4, v48
    v_add3_u32 v22, v48, v50, s64
    v_add_u32 v48, 256, v1
    v_mfma_f32_16x16x32_bf16 v[64:67], a[64:67], a[0:3], v[64:67]
    v_mul_u32_u24 v49, 6554, v48
    v_lshrrev_b32 v49, 16, v49
    s_waitcnt lgkmcnt(0)
    v_mfma_f32_16x16x32_bf16 v[228:231], a[48:51], a[40:43], 0
    s_add_u32 m0, s67, 110592
    ds_read_b64_tr_b16 a[64:65], v15 offset:32768
    v_mul_u32_u24 v50, 10, v49
    v_sub_u32 v48, v48, v50
    v_mfma_f32_16x16x32_bf16 v[228:231], a[52:55], a[44:47], v[228:231]
    buffer_load_dwordx4 v6, s[24:27], s70 offen lds
    v_lshrrev_b32 v50, 4, v49
    v_mfma_f32_16x16x32_bf16 v[252:255], a[60:63], a[44:47], 0
    ds_read_b64_tr_b16 a[66:67], v15 offset:33792
    v_mul_u32_u24 v50, s101, v50
    v_bfe_u32 v51, v49, 2, 2
    v_mfma_f32_16x16x32_bf16 v[252:255], a[56:59], a[40:43], v[252:255]
    v_mad_u32_u24 v50, v51, s76, v50
    v_and_b32 v49, 3, v49
    v_add3_u32 v50, v50, v49, s65
    v_mfma_f32_16x16x32_bf16 v[248:251], a[56:59], a[32:35], 0
    ds_read_b64_tr_b16 a[68:69], v15 offset:40960
    v_mul_u32_u24 v50, 1280, v50
    v_lshlrev_b32 v48, 4, v48
    v_mfma_f32_16x16x32_bf16 v[248:251], a[60:63], a[36:39], v[248:251]
    s_add_u32 m0, s67, 114688
    v_add3_u32 v23, v48, v50, s64
    v_lshrrev_b32 v48, 2, v1
    v_mul_u32_u24 v48, 160, v48
    v_mfma_f32_16x16x32_bf16 v[224:227], a[52:55], a[36:39], 0
    buffer_load_dwordx4 v7, s[24:27], s70 offen lds
    v_add_u32 v48, s69, v48
    v_mfma_f32_16x16x32_bf16 v[224:227], a[48:51], a[32:35], v[224:227]
    ds_read_b64_tr_b16 a[70:71], v15 offset:41984
    v_and_b32 v49, 3, v1
    v_lshl_add_u32 v58, v49, 4, v48
    v_mfma_f32_16x16x32_bf16 v[220:223], a[48:51], a[24:27], 0
    v_lshl_add_u32 v59, v49, 3, v48
    s_add_u32 s44, s22, 14680064
    s_addc_u32 s45, s23, 0
    v_mfma_f32_16x16x32_bf16 v[220:223], a[52:55], a[28:31], v[220:223]
    ds_read_b64_tr_b16 a[72:73], v16 offset:32768
    s_mov_b32 s46, 65536
    s_mov_b32 s47, 0x20000
    v_mfma_f32_16x16x32_bf16 v[244:247], a[60:63], a[28:31], 0
    s_add_u32 m0, s67, 118784
    s_mov_b32 s52, s20
    s_mov_b32 s53, s21
    s_mov_b32 s54, 256
    v_mfma_f32_16x16x32_bf16 v[244:247], a[56:59], a[24:27], v[244:247]
    buffer_load_dwordx4 v8, s[24:27], s70 offen lds
    s_mov_b32 s55, 0x20000
    v_mfma_f32_16x16x32_bf16 v[240:243], a[56:59], a[16:19], 0
    ds_read_b64_tr_b16 a[74:75], v16 offset:33792
    s_mov_b32 s36, s22
    s_mov_b32 s37, s23
    v_mfma_f32_16x16x32_bf16 v[240:243], a[60:63], a[20:23], v[240:243]
    s_mov_b32 s38, 9699328
    s_mov_b32 s39, 0x20000
    s_add_u32 s40, s22, 10485760
    s_addc_u32 s41, s23, 0
    v_mfma_f32_16x16x32_bf16 v[216:219], a[52:55], a[20:23], 0
    ds_read_b64_tr_b16 a[76:77], v16 offset:40960
    s_mov_b32 s42, 3031040
    s_mov_b32 s43, 0x20000
    v_mfma_f32_16x16x32_bf16 v[216:219], a[48:51], a[16:19], v[216:219]
    s_add_u32 m0, s67, 122880
    s_and_b32 s63, s2, 7
    s_lshr_b32 s64, s2, 3
    s_lshr_b32 s84, s63, 1
    v_mfma_f32_16x16x32_bf16 v[212:215], a[48:51], a[8:11], 0
    buffer_load_dwordx4 v9, s[24:27], s70 offen lds
    s_lshl_b32 s84, s84, 3
    v_mfma_f32_16x16x32_bf16 v[212:215], a[52:55], a[12:15], v[212:215]
    ds_read_b64_tr_b16 a[78:79], v16 offset:41984
    s_lshr_b32 s65, s64, 2
    s_add_u32 s84, s84, s65
    v_mfma_f32_16x16x32_bf16 v[236:239], a[60:63], a[12:15], 0
    s_and_b32 s85, s63, 1
    s_lshl_b32 s85, s85, 2
    s_and_b32 s65, s64, 3
    s_add_u32 s85, s85, s65
    v_mfma_f32_16x16x32_bf16 v[236:239], a[56:59], a[8:11], v[236:239]
    buffer_load_dword v24, v45, s[24:27], 0 offen offset:0
    s_mul_i32 s63, s60, 13
    s_add_u32 s63, s63, 20
    v_mfma_f32_16x16x32_bf16 v[232:235], a[56:59], a[0:3], 0
    s_add_u32 m0, s67, 126976
    buffer_load_dword v25, v45, s[24:27], 0 offen offset:128
    s_mul_i32 s64, s85, 378880
    s_mul_i32 s65, s63, 5120
    v_mfma_f32_16x16x32_bf16 v[232:235], a[60:63], a[4:7], v[232:235]
    s_mov_b64 exec, s[72:73]
    buffer_load_dwordx4 v10, s[24:27], s70 offen lds
    s_mov_b64 exec, -1
    buffer_load_dword v28, v45, s[24:27], 0 offen offset:512
    v_mfma_f32_16x16x32_bf16 v[208:211], a[52:55], a[4:7], 0
    s_add_u32 s87, s64, s65
    s_add_u32 s88, s64, s67
    s_mul_i32 s3, s84, 303104
    s_lshl_b32 s63, s63, 12
    v_mfma_f32_16x16x32_bf16 v[208:211], a[48:51], a[0:3], v[208:211]
    s_waitcnt vmcnt(13) lgkmcnt(0)
    s_barrier
    v_mfma_f32_16x16x32_bf16 v[180:183], a[64:67], a[40:43], 0
    buffer_load_dword v29, v45, s[24:27], 0 offen offset:640
    ds_read_b64_tr_b16 a[48:49], v17 offset:16384
    s_add_u32 s89, s3, s63
    v_mfma_f32_16x16x32_bf16 v[180:183], a[68:71], a[44:47], v[180:183]
    s_add_u32 m0, s68, 24576
    v_lshlrev_b32 v3, 4, v1
    v_add_u32 v4, 4096, v3
    v_mfma_f32_16x16x32_bf16 v[204:207], a[76:79], a[44:47], 0
    s_mov_b32 s71, 442368
    buffer_load_dword v30, v45, s[24:27], 0 offen offset:768
    ds_read_b64_tr_b16 a[50:51], v17 offset:17408
    v_mfma_f32_16x16x32_bf16 v[204:207], a[72:75], a[40:43], v[204:207]
    buffer_load_dwordx4 v11, s[28:31], s71 offen lds
    v_mfma_f32_16x16x32_bf16 v[200:203], a[72:75], a[32:35], 0
    buffer_load_dword v31, v45, s[24:27], 0 offen offset:896
    ds_read_b64_tr_b16 a[52:53], v17 offset:24576
    v_mfma_f32_16x16x32_bf16 v[200:203], a[76:79], a[36:39], v[200:203]
    ds_read_b128 a[40:43], v56 offset:10240
    v_mfma_f32_16x16x32_bf16 v[176:179], a[68:71], a[36:39], 0
    ds_read_b64_tr_b16 a[54:55], v17 offset:25600
    v_mfma_f32_16x16x32_bf16 v[176:179], a[64:67], a[32:35], v[176:179]
    buffer_load_dword v32, v45, s[24:27], 0 offen offset:1024
    ds_read_b128 a[44:47], v57 offset:10240
    v_mfma_f32_16x16x32_bf16 v[172:175], a[64:67], a[24:27], 0
    buffer_load_dwordx4 v12, s[28:31], s71 offen offset:1024 lds
    v_mfma_f32_16x16x32_bf16 v[172:175], a[68:71], a[28:31], v[172:175]
    buffer_load_dword v33, v45, s[24:27], 0 offen offset:1152
    ds_read_b64_tr_b16 a[56:57], v18 offset:16384
    v_mfma_f32_16x16x32_bf16 v[196:199], a[76:79], a[28:31], 0
    ds_read_b128 a[32:35], v56 offset:8192
    v_mfma_f32_16x16x32_bf16 v[196:199], a[72:75], a[24:27], v[196:199]
    ds_read_b64_tr_b16 a[58:59], v18 offset:17408
    v_mfma_f32_16x16x32_bf16 v[192:195], a[72:75], a[16:19], 0
    ds_read_b128 a[36:39], v57 offset:8192
    v_mfma_f32_16x16x32_bf16 v[192:195], a[76:79], a[20:23], v[192:195]
    buffer_load_dwordx4 v13, s[28:31], s71 offen offset:2048 lds
    v_mfma_f32_16x16x32_bf16 v[168:171], a[68:71], a[20:23], 0
    ds_read_b64_tr_b16 a[60:61], v18 offset:24576
    v_mfma_f32_16x16x32_bf16 v[168:171], a[64:67], a[16:19], v[168:171]
    ds_read_b128 a[24:27], v56 offset:6144
    v_mfma_f32_16x16x32_bf16 v[164:167], a[64:67], a[8:11], 0
    ds_read_b64_tr_b16 a[62:63], v18 offset:25600
    v_mfma_f32_16x16x32_bf16 v[164:167], a[68:71], a[12:15], v[164:167]
    ds_read_b128 a[28:31], v57 offset:6144
    v_mfma_f32_16x16x32_bf16 v[188:191], a[76:79], a[12:15], 0
    buffer_load_dwordx4 v14, s[28:31], s71 offen offset:3072 lds
    s_mov_b32 s66, 884736
    v_mfma_f32_16x16x32_bf16 v[188:191], a[72:75], a[8:11], v[188:191]
    buffer_load_dword a255, v52, s[56:59], s66 offen
    ds_read_b128 a[16:19], v56 offset:4096
    v_mfma_f32_16x16x32_bf16 v[184:187], a[72:75], a[0:3], 0
    ds_read_b128 a[20:23], v57 offset:4096
    v_mfma_f32_16x16x32_bf16 v[184:187], a[76:79], a[4:7], v[184:187]
    ds_read_b128 a[8:11], v56 offset:2048
    v_mfma_f32_16x16x32_bf16 v[160:163], a[68:71], a[4:7], 0
    ds_read_b128 a[12:15], v57 offset:2048
    v_mfma_f32_16x16x32_bf16 v[160:163], a[64:67], a[0:3], v[160:163]
    s_waitcnt lgkmcnt(5)
    v_mfma_f32_16x16x32_bf16 v[132:135], a[48:51], a[40:43], v[132:135]
    s_add_u32 m0, s68, 90112
    ds_read_b128 a[0:3], v56 offset:0
    v_mfma_f32_16x16x32_bf16 v[132:135], a[52:55], a[44:47], v[132:135]
    buffer_load_dwordx4 v11, s[32:35], s71 offen lds
    v_mfma_f32_16x16x32_bf16 v[156:159], a[60:63], a[44:47], v[156:159]
    ds_read_b128 a[4:7], v57 offset:0
    v_mfma_f32_16x16x32_bf16 v[156:159], a[56:59], a[40:43], v[156:159]
    ds_read_b64_tr_b16 a[64:65], v15 offset:16384
    v_mfma_f32_16x16x32_bf16 v[152:155], a[56:59], a[32:35], v[152:155]
    v_mfma_f32_16x16x32_bf16 v[152:155], a[60:63], a[36:39], v[152:155]
    ds_read_b64_tr_b16 a[66:67], v15 offset:17408
    v_mfma_f32_16x16x32_bf16 v[128:131], a[52:55], a[36:39], v[128:131]
    buffer_load_dwordx4 v12, s[32:35], s71 offen offset:1024 lds
    v_mfma_f32_16x16x32_bf16 v[128:131], a[48:51], a[32:35], v[128:131]
    ds_read_b64_tr_b16 a[68:69], v15 offset:24576
    s_waitcnt lgkmcnt(9)
    v_mfma_f32_16x16x32_bf16 v[124:127], a[48:51], a[24:27], v[124:127]
    v_mfma_f32_16x16x32_bf16 v[124:127], a[52:55], a[28:31], v[124:127]
    ds_read_b64_tr_b16 a[70:71], v15 offset:25600
    v_mfma_f32_16x16x32_bf16 v[148:151], a[60:63], a[28:31], v[148:151]
    v_mfma_f32_16x16x32_bf16 v[148:151], a[56:59], a[24:27], v[148:151]
    ds_read_b64_tr_b16 a[72:73], v16 offset:16384
    s_waitcnt lgkmcnt(9)
    v_mfma_f32_16x16x32_bf16 v[144:147], a[56:59], a[16:19], v[144:147]
    buffer_load_dwordx4 v13, s[32:35], s71 offen offset:2048 lds
    v_mfma_f32_16x16x32_bf16 v[144:147], a[60:63], a[20:23], v[144:147]
    ds_read_b64_tr_b16 a[74:75], v16 offset:17408
    v_mfma_f32_16x16x32_bf16 v[120:123], a[52:55], a[20:23], v[120:123]
    v_mfma_f32_16x16x32_bf16 v[120:123], a[48:51], a[16:19], v[120:123]
    ds_read_b64_tr_b16 a[76:77], v16 offset:24576
    s_waitcnt lgkmcnt(9)
    v_mfma_f32_16x16x32_bf16 v[116:119], a[48:51], a[8:11], v[116:119]
    v_mfma_f32_16x16x32_bf16 v[116:119], a[52:55], a[12:15], v[116:119]
    ds_read_b64_tr_b16 a[78:79], v16 offset:25600
    v_mfma_f32_16x16x32_bf16 v[140:143], a[60:63], a[12:15], v[140:143]
    buffer_load_dwordx4 v14, s[32:35], s71 offen offset:3072 lds
    v_mfma_f32_16x16x32_bf16 v[140:143], a[56:59], a[8:11], v[140:143]
    s_waitcnt lgkmcnt(8)
    v_mfma_f32_16x16x32_bf16 v[136:139], a[56:59], a[0:3], v[136:139]
    v_mfma_f32_16x16x32_bf16 v[136:139], a[60:63], a[4:7], v[136:139]
    v_mfma_f32_16x16x32_bf16 v[112:115], a[52:55], a[4:7], v[112:115]
    s_add_u32 m0, s68, 73728
    v_mfma_f32_16x16x32_bf16 v[112:115], a[48:51], a[0:3], v[112:115]
    s_mov_b32 s71, 663552
    s_waitcnt vmcnt(23) lgkmcnt(0)
    s_barrier
    v_mfma_f32_16x16x32_bf16 v[84:87], a[64:67], a[40:43], v[84:87]
    buffer_load_dwordx4 v11, s[28:31], s71 offen lds
    v_mfma_f32_16x16x32_bf16 v[84:87], a[68:71], a[44:47], v[84:87]
    ds_read_b64_tr_b16 a[48:49], v17 offset:0
    v_mfma_f32_16x16x32_bf16 v[108:111], a[76:79], a[44:47], v[108:111]
    v_mfma_f32_16x16x32_bf16 v[108:111], a[72:75], a[40:43], v[108:111]
    ds_read_b64_tr_b16 a[50:51], v17 offset:1024
    v_mfma_f32_16x16x32_bf16 v[104:107], a[72:75], a[32:35], v[104:107]
    s_add_u32 m0, s67, 0
    v_mfma_f32_16x16x32_bf16 v[104:107], a[76:79], a[36:39], v[104:107]
    s_mov_b32 s70, 384
    ds_read_b64_tr_b16 a[52:53], v17 offset:8192
    v_mfma_f32_16x16x32_bf16 v[80:83], a[68:71], a[36:39], v[80:83]
    buffer_load_dwordx4 v5, s[24:27], s70 offen lds
    v_mfma_f32_16x16x32_bf16 v[80:83], a[64:67], a[32:35], v[80:83]
    ds_read_b64_tr_b16 a[54:55], v17 offset:9216
    v_mfma_f32_16x16x32_bf16 v[76:79], a[64:67], a[24:27], v[76:79]
    v_mfma_f32_16x16x32_bf16 v[76:79], a[68:71], a[28:31], v[76:79]
    ds_read_b64_tr_b16 a[56:57], v18 offset:0
    v_mfma_f32_16x16x32_bf16 v[100:103], a[76:79], a[28:31], v[100:103]
    v_mfma_f32_16x16x32_bf16 v[100:103], a[72:75], a[24:27], v[100:103]
    s_add_u32 m0, s67, 4096
    ds_read_b64_tr_b16 a[58:59], v18 offset:1024
    v_mfma_f32_16x16x32_bf16 v[96:99], a[72:75], a[16:19], v[96:99]
    buffer_load_dwordx4 v6, s[24:27], s70 offen lds
    v_mfma_f32_16x16x32_bf16 v[96:99], a[76:79], a[20:23], v[96:99]
    ds_read_b64_tr_b16 a[60:61], v18 offset:8192
    v_mfma_f32_16x16x32_bf16 v[72:75], a[68:71], a[20:23], v[72:75]
    v_mfma_f32_16x16x32_bf16 v[72:75], a[64:67], a[16:19], v[72:75]
    ds_read_b64_tr_b16 a[62:63], v18 offset:9216
    v_mfma_f32_16x16x32_bf16 v[68:71], a[64:67], a[8:11], v[68:71]
    v_mfma_f32_16x16x32_bf16 v[68:71], a[68:71], a[12:15], v[68:71]
    s_add_u32 m0, s67, 8192
    v_mfma_f32_16x16x32_bf16 v[92:95], a[76:79], a[12:15], v[92:95]
    buffer_load_dwordx4 v7, s[24:27], s70 offen lds
    v_mfma_f32_16x16x32_bf16 v[92:95], a[72:75], a[8:11], v[92:95]
    v_mfma_f32_16x16x32_bf16 v[88:91], a[72:75], a[0:3], v[88:91]
    v_mfma_f32_16x16x32_bf16 v[88:91], a[76:79], a[4:7], v[88:91]
    v_mfma_f32_16x16x32_bf16 v[64:67], a[68:71], a[4:7], v[64:67]
    v_mfma_f32_16x16x32_bf16 v[64:67], a[64:67], a[0:3], v[64:67]
    s_waitcnt lgkmcnt(0)
    v_mfma_f32_16x16x32_bf16 v[228:231], a[48:51], a[40:43], v[228:231]
    s_add_u32 m0, s67, 12288
    ds_read_b64_tr_b16 a[64:65], v15 offset:0
    s_waitcnt vmcnt(11)
    v_lshlrev_b32 v34, 16, v24
    v_mfma_f32_16x16x32_bf16 v[228:231], a[52:55], a[44:47], v[228:231]
    buffer_load_dwordx4 v8, s[24:27], s70 offen lds
    v_and_b32 v24, 0xffff0000, v24
    v_mfma_f32_16x16x32_bf16 v[252:255], a[60:63], a[44:47], v[252:255]
    ds_read_b64_tr_b16 a[66:67], v15 offset:1024
    v_lshlrev_b32 v35, 16, v25
    v_and_b32 v25, 0xffff0000, v25
    v_mfma_f32_16x16x32_bf16 v[252:255], a[56:59], a[40:43], v[252:255]
    s_add_u32 m0, s67, 16384
    v_lshlrev_b32 v36, 16, v26
    v_and_b32 v26, 0xffff0000, v26
    v_lshlrev_b32 v37, 16, v27
    v_mfma_f32_16x16x32_bf16 v[248:251], a[56:59], a[32:35], v[248:251]
    buffer_load_dwordx4 v9, s[24:27], s70 offen lds
    v_and_b32 v27, 0xffff0000, v27
    v_mfma_f32_16x16x32_bf16 v[248:251], a[60:63], a[36:39], v[248:251]
    ds_read_b64_tr_b16 a[68:69], v15 offset:8192
    v_lshlrev_b32 v38, 16, v28
    v_and_b32 v28, 0xffff0000, v28
    v_mfma_f32_16x16x32_bf16 v[224:227], a[52:55], a[36:39], v[224:227]
    v_lshlrev_b32 v39, 16, v29
    v_and_b32 v29, 0xffff0000, v29
    v_lshlrev_b32 v40, 16, v30
    v_mfma_f32_16x16x32_bf16 v[224:227], a[48:51], a[32:35], v[224:227]
    s_add_u32 m0, s69, 0
    ds_read_b64_tr_b16 a[70:71], v15 offset:9216
    v_and_b32 v30, 0xffff0000, v30
    v_lshlrev_b32 v41, 16, v31
    v_mfma_f32_16x16x32_bf16 v[220:223], a[48:51], a[24:27], v[220:223]
    buffer_load_dwordx4 v19, s[48:51], 0 offen lds
    v_and_b32 v31, 0xffff0000, v31
    v_mfma_f32_16x16x32_bf16 v[220:223], a[52:55], a[28:31], v[220:223]
    ds_read_b64_tr_b16 a[72:73], v16 offset:0
    v_lshlrev_b32 v42, 16, v32
    v_and_b32 v32, 0xffff0000, v32
    v_mfma_f32_16x16x32_bf16 v[244:247], a[60:63], a[28:31], v[244:247]
    s_add_u32 m0, s67, 20480
    v_lshlrev_b32 v43, 16, v33
    v_and_b32 v33, 0xffff0000, v33
    v_add_f32 v45, v24, v25
    v_mfma_f32_16x16x32_bf16 v[244:247], a[56:59], a[24:27], v[244:247]
    s_mov_b64 exec, s[72:73]
    buffer_load_dwordx4 v10, s[24:27], s70 offen lds
    s_mov_b64 exec, -1
    v_add_f32 v46, v34, v35
    v_mfma_f32_16x16x32_bf16 v[240:243], a[56:59], a[16:19], v[240:243]
    ds_read_b64_tr_b16 a[74:75], v16 offset:1024
    v_add_f32 v45, v45, v26
    v_add_f32 v46, v46, v36
    v_mfma_f32_16x16x32_bf16 v[240:243], a[60:63], a[20:23], v[240:243]
    v_add_f32 v45, v45, v27
    v_add_f32 v46, v46, v37
    v_add_f32 v45, v45, v28
    v_mfma_f32_16x16x32_bf16 v[216:219], a[52:55], a[20:23], v[216:219]
    s_add_u32 m0, s68, 73728
    ds_read_b64_tr_b16 a[76:77], v16 offset:8192
    v_add_f32 v46, v46, v38
    v_add_f32 v45, v45, v29
    v_mfma_f32_16x16x32_bf16 v[216:219], a[48:51], a[16:19], v[216:219]
    buffer_load_dwordx4 v12, s[28:31], s71 offen offset:1024 lds
    v_add_f32 v46, v46, v39
    v_mfma_f32_16x16x32_bf16 v[212:215], a[48:51], a[8:11], v[212:215]
    ds_read_b64_tr_b16 a[78:79], v16 offset:9216
    v_add_f32 v45, v45, v30
    v_add_f32 v46, v46, v40
    v_mfma_f32_16x16x32_bf16 v[212:215], a[52:55], a[12:15], v[212:215]
    v_add_f32 v45, v45, v31
    v_add_f32 v46, v46, v41
    v_add_f32 v45, v45, v32
    v_mfma_f32_16x16x32_bf16 v[236:239], a[60:63], a[12:15], v[236:239]
    s_add_u32 m0, s69, 1024
    v_add_f32 v46, v46, v42
    v_add_f32 v45, v45, v33
    v_add_f32 v46, v46, v43
    v_mfma_f32_16x16x32_bf16 v[236:239], a[56:59], a[8:11], v[236:239]
    buffer_load_dwordx4 v20, s[48:51], 0 offen lds
    v_add_f32 v45, v45, v46
    v_mfma_f32_16x16x32_bf16 v[232:235], a[56:59], a[0:3], v[232:235]
    s_add_u32 m0, s68, 73728
    v_add_f32_dpp v45, v45, v45 row_ror:8 row_mask:0xf bank_mask:0xf
    s_nop 1
    v_add_f32_dpp v45, v45, v45 row_ror:4 row_mask:0xf bank_mask:0xf
    v_mfma_f32_16x16x32_bf16 v[232:235], a[60:63], a[4:7], v[232:235]
    buffer_load_dwordx4 v13, s[28:31], s71 offen offset:2048 lds
    v_add_f32_dpp v45, v45, v45 row_ror:2 row_mask:0xf bank_mask:0xf
    v_mfma_f32_16x16x32_bf16 v[208:211], a[52:55], a[4:7], v[208:211]
    s_nop 0
    v_add_f32_dpp v45, v45, v45 row_ror:1 row_mask:0xf bank_mask:0xf
    v_mov_b32 v46, v45
    v_mfma_f32_16x16x32_bf16 v[208:211], a[48:51], a[0:3], v[208:211]
    s_waitcnt vmcnt(16) lgkmcnt(0)
    s_barrier
    v_mfma_f32_16x16x32_bf16 v[180:183], a[64:67], a[40:43], v[180:183]
    ds_read_b64_tr_b16 a[48:49], v62 offset:0
    v_permlane16_swap_b32 v45, v46
    v_mfma_f32_16x16x32_bf16 v[180:183], a[68:71], a[44:47], v[180:183]
    s_add_u32 m0, s69, 2048
    v_add_f32 v45, v45, v46
    v_mul_f32 v45, 0x3acccccd, v45
    v_sub_f32 v24, v24, v45
    v_mfma_f32_16x16x32_bf16 v[204:207], a[76:79], a[44:47], v[204:207]
    buffer_load_dwordx4 v21, s[48:51], 0 offen lds
    v_sub_f32 v25, v25, v45
    v_mfma_f32_16x16x32_bf16 v[204:207], a[72:75], a[40:43], v[204:207]
    ds_read_b64_tr_b16 a[50:51], v62 offset:1024
    v_sub_f32 v26, v26, v45
    v_sub_f32 v27, v27, v45
    v_mfma_f32_16x16x32_bf16 v[200:203], a[72:75], a[32:35], v[200:203]
    s_add_u32 m0, s68, 73728
    ds_read_b128 a[40:43], v54 offset:10240
    v_sub_f32 v28, v28, v45
    v_sub_f32 v29, v29, v45
    v_mfma_f32_16x16x32_bf16 v[200:203], a[76:79], a[36:39], v[200:203]
    buffer_load_dwordx4 v14, s[28:31], s71 offen offset:3072 lds
    v_sub_f32 v30, v30, v45
    v_mfma_f32_16x16x32_bf16 v[176:179], a[68:71], a[36:39], v[176:179]
    ds_read_b64_tr_b16 a[52:53], v62 offset:8192
    v_sub_f32 v31, v31, v45
    v_sub_f32 v32, v32, v45
    v_mfma_f32_16x16x32_bf16 v[176:179], a[64:67], a[32:35], v[176:179]
    ds_read_b128 a[44:47], v55 offset:10240
    v_sub_f32 v33, v33, v45
    v_sub_f32 v34, v34, v45
    v_mfma_f32_16x16x32_bf16 v[172:175], a[64:67], a[24:27], v[172:175]
    s_add_u32 m0, s68, 57344
    ds_read_b64_tr_b16 a[54:55], v62 offset:9216
    v_sub_f32 v35, v35, v45
    v_sub_f32 v36, v36, v45
    v_mfma_f32_16x16x32_bf16 v[172:175], a[68:71], a[28:31], v[172:175]
    buffer_load_dwordx4 v11, s[32:35], s71 offen lds
    v_sub_f32 v37, v37, v45
    v_mfma_f32_16x16x32_bf16 v[196:199], a[76:79], a[28:31], v[196:199]
    ds_read_b64_tr_b16 a[56:57], v63 offset:0
    v_sub_f32 v38, v38, v45
    v_sub_f32 v39, v39, v45
    v_mfma_f32_16x16x32_bf16 v[196:199], a[72:75], a[24:27], v[196:199]
    ds_read_b128 a[32:35], v54 offset:8192
    v_sub_f32 v40, v40, v45
    v_sub_f32 v41, v41, v45
    v_mfma_f32_16x16x32_bf16 v[192:195], a[72:75], a[16:19], v[192:195]
    s_add_u32 m0, s69, 3072
    ds_read_b64_tr_b16 a[58:59], v63 offset:1024
L_pg0:
    s_cbranch_execz L_pg4
    v_sub_f32 v42, v42, v45
    v_sub_f32 v43, v43, v45
    v_mfma_f32_16x16x32_bf16 v[192:195], a[76:79], a[20:23], v[192:195]
    buffer_load_dwordx4 v22, s[48:51], 0 offen lds
    v_cvt_pk_bf16_f32 v47, v45, v45
    v_mfma_f32_16x16x32_bf16 v[168:171], a[68:71], a[20:23], v[168:171]
    ds_read_b64_tr_b16 a[60:61], v63 offset:8192
    v_mul_f32 v45, v24, v24
    v_mul_f32 v46, v25, v25
    v_mfma_f32_16x16x32_bf16 v[168:171], a[64:67], a[16:19], v[168:171]
    s_add_u32 m0, s68, 57344
    ds_read_b128 a[36:39], v55 offset:8192
    v_fmac_f32 v45, v26, v26
    v_fmac_f32 v46, v27, v27
    v_mfma_f32_16x16x32_bf16 v[164:167], a[64:67], a[8:11], v[164:167]
    buffer_load_dwordx4 v12, s[32:35], s71 offen offset:1024 lds
    v_fmac_f32 v45, v28, v28
    v_mfma_f32_16x16x32_bf16 v[164:167], a[68:71], a[12:15], v[164:167]
    ds_read_b64_tr_b16 a[62:63], v63 offset:9216
    v_fmac_f32 v46, v29, v29
    v_fmac_f32 v45, v30, v30
    v_mfma_f32_16x16x32_bf16 v[188:191], a[76:79], a[12:15], v[188:191]
    ds_read_b128 a[24:27], v54 offset:6144
    v_fmac_f32 v46, v31, v31
    v_fmac_f32 v45, v32, v32
    v_mfma_f32_16x16x32_bf16 v[188:191], a[72:75], a[8:11], v[188:191]
    s_add_u32 m0, s69, 4096
    ds_read_b128 a[28:31], v55 offset:6144
    v_fmac_f32 v46, v33, v33
    v_fmac_f32 v45, v34, v34
    v_mfma_f32_16x16x32_bf16 v[184:187], a[72:75], a[0:3], v[184:187]
    buffer_load_dwordx4 v23, s[48:51], 0 offen lds
    v_fmac_f32 v46, v35, v35
    v_mfma_f32_16x16x32_bf16 v[184:187], a[76:79], a[4:7], v[184:187]
    ds_read_b128 a[16:19], v54 offset:4096
    v_fmac_f32 v45, v36, v36
    v_fmac_f32 v46, v37, v37
    v_mfma_f32_16x16x32_bf16 v[160:163], a[68:71], a[4:7], v[160:163]
    ds_read_b128 a[20:23], v55 offset:4096
    v_fmac_f32 v45, v38, v38
    v_fmac_f32 v46, v39, v39
    v_mfma_f32_16x16x32_bf16 v[160:163], a[64:67], a[0:3], v[160:163]
    ds_read_b128 a[8:11], v54 offset:2048
    v_fmac_f32 v45, v40, v40
    s_waitcnt lgkmcnt(5)
    v_mfma_f32_16x16x32_bf16 v[132:135], a[48:51], a[40:43], v[132:135]
    s_add_u32 m0, s68, 57344
    ds_read_b128 a[12:15], v55 offset:2048
    v_fmac_f32 v46, v41, v41
    v_fmac_f32 v45, v42, v42
    v_mfma_f32_16x16x32_bf16 v[132:135], a[52:55], a[44:47], v[132:135]
    buffer_load_dwordx4 v13, s[32:35], s71 offen offset:2048 lds
    v_fmac_f32 v46, v43, v43
    v_mfma_f32_16x16x32_bf16 v[156:159], a[60:63], a[44:47], v[156:159]
    ds_read_b128 a[0:3], v54 offset:0
    v_lshlrev_b32 v47, 16, v47
    v_add_f32 v45, v45, v46
    v_mfma_f32_16x16x32_bf16 v[156:159], a[56:59], a[40:43], v[156:159]
    ds_read_b128 a[4:7], v55 offset:0
    v_add_f32_dpp v45, v45, v45 row_ror:8 row_mask:0xf bank_mask:0xf
    v_mfma_f32_16x16x32_bf16 v[152:155], a[56:59], a[32:35], v[152:155]
    ds_read_b64_tr_b16 a[64:65], v60 offset:0
    v_add_f32_dpp v45, v45, v45 row_ror:4 row_mask:0xf bank_mask:0xf
    v_mfma_f32_16x16x32_bf16 v[152:155], a[60:63], a[36:39], v[152:155]
    ds_read_b64_tr_b16 a[66:67], v60 offset:1024
    v_add_f32_dpp v45, v45, v45 row_ror:2 row_mask:0xf bank_mask:0xf
    v_mfma_f32_16x16x32_bf16 v[128:131], a[52:55], a[36:39], v[128:131]
    buffer_load_dwordx4 v14, s[32:35], s71 offen offset:3072 lds
    v_add_f32_dpp v45, v45, v45 row_ror:1 row_mask:0xf bank_mask:0xf
    v_mfma_f32_16x16x32_bf16 v[128:131], a[48:51], a[32:35], v[128:131]
    ds_read_b64_tr_b16 a[68:69], v60 offset:8192
    v_mov_b32 v46, v45
    s_waitcnt lgkmcnt(9)
    v_mfma_f32_16x16x32_bf16 v[124:127], a[48:51], a[24:27], v[124:127]
    v_permlane16_swap_b32 v45, v46
    v_add_f32 v45, v45, v46
    v_mfma_f32_16x16x32_bf16 v[124:127], a[52:55], a[28:31], v[124:127]
    ds_read_b64_tr_b16 a[70:71], v60 offset:9216
    v_mul_f32 v45, 0x3acccccd, v45
    v_cvt_pk_bf16_f32 v45, v45, v45
    v_mfma_f32_16x16x32_bf16 v[148:151], a[60:63], a[28:31], v[148:151]
    s_add_u32 m0, s68, 40960
    v_lshlrev_b32 v45, 16, v45
    v_add_f32 v45, 0x3727c5ac, v45
    v_cvt_pk_bf16_f32 v45, v45, v45
    v_mfma_f32_16x16x32_bf16 v[148:151], a[56:59], a[24:27], v[148:151]
    s_mov_b32 s71, 884736
    ds_read_b64_tr_b16 a[72:73], v61 offset:0
    v_lshlrev_b32 v45, 16, v45
    s_waitcnt lgkmcnt(9)
    v_mfma_f32_16x16x32_bf16 v[144:147], a[56:59], a[16:19], v[144:147]
    buffer_load_dwordx4 v11, s[28:31], s71 offen lds
    v_sqrt_f32 v45, v45
    v_mfma_f32_16x16x32_bf16 v[144:147], a[60:63], a[20:23], v[144:147]
    ds_read_b64_tr_b16 a[74:75], v61 offset:1024
    v_cvt_pk_bf16_f32 v45, v45, v45
    v_lshlrev_b32 v45, 16, v45
    v_mfma_f32_16x16x32_bf16 v[120:123], a[52:55], a[20:23], v[120:123]
    v_rcp_f32 v45, v45
    v_lshlrev_b32 v44, 2, v44
    v_mfma_f32_16x16x32_bf16 v[120:123], a[48:51], a[16:19], v[120:123]
    ds_read_b64_tr_b16 a[76:77], v61 offset:8192
    v_and_b32 v24, 31, v0
    s_waitcnt lgkmcnt(9)
    v_mfma_f32_16x16x32_bf16 v[116:119], a[48:51], a[8:11], v[116:119]
    v_mov_b32 v25, 2147418112
    v_cmp_eq_u32 vcc, 0, v24
    v_lshl_add_u32 v44, v24, 13, v44
    v_mfma_f32_16x16x32_bf16 v[116:119], a[52:55], a[12:15], v[116:119]
    ds_read_b64_tr_b16 a[78:79], v61 offset:9216
    v_cndmask_b32 v45, v45, v47, vcc
    v_cmp_gt_u32 vcc, 2, v24
    v_mfma_f32_16x16x32_bf16 v[140:143], a[60:63], a[12:15], v[140:143]
    buffer_load_dwordx4 v12, s[28:31], s71 offen offset:1024 lds
    s_nop 0
    v_mfma_f32_16x16x32_bf16 v[140:143], a[56:59], a[8:11], v[140:143]
    v_cndmask_b32 v44, v25, v44, vcc
    buffer_store_dword v45, v44, s[44:47], 0 offen sc1
    s_waitcnt lgkmcnt(8)
    v_mfma_f32_16x16x32_bf16 v[136:139], a[56:59], a[0:3], v[136:139]
    buffer_load_dword v53, off, s[52:55], 0 sc1
    v_mfma_f32_16x16x32_bf16 v[136:139], a[60:63], a[4:7], v[136:139]
    v_mfma_f32_16x16x32_bf16 v[112:115], a[52:55], a[4:7], v[112:115]
    v_mfma_f32_16x16x32_bf16 v[112:115], a[48:51], a[0:3], v[112:115]
    s_waitcnt vmcnt(23) lgkmcnt(0)
    s_barrier
    v_mfma_f32_16x16x32_bf16 v[84:87], a[64:67], a[40:43], v[84:87]
    buffer_load_dwordx4 v13, s[28:31], s71 offen offset:2048 lds
    v_mfma_f32_16x16x32_bf16 v[84:87], a[68:71], a[44:47], v[84:87]
    ds_read_b64_tr_b16 a[48:49], v17 offset:49152
    s_waitcnt vmcnt(7)
    v_mfma_f32_16x16x32_bf16 v[108:111], a[76:79], a[44:47], v[108:111]
    ds_read_b64_tr_b16 a[160:161], v58 offset:0
    ds_read_b64_tr_b16 a[162:163], v58 offset:2560
    v_mfma_f32_16x16x32_bf16 v[108:111], a[72:75], a[40:43], v[108:111]
    ds_read_b64_tr_b16 a[50:51], v17 offset:50176
    ds_read_b64_tr_b16 a[164:165], v58 offset:8
    v_mfma_f32_16x16x32_bf16 v[104:107], a[72:75], a[32:35], v[104:107]
    s_add_u32 m0, s67, 106496
    ds_read_b64_tr_b16 a[166:167], v58 offset:2568
    ds_read_b64_tr_b16 a[168:169], v58 offset:64
    v_mfma_f32_16x16x32_bf16 v[104:107], a[76:79], a[36:39], v[104:107]
    s_mov_b32 s70, 512
    ds_read_b64_tr_b16 a[52:53], v17 offset:57344
    ds_read_b64_tr_b16 a[170:171], v58 offset:2624
    v_mfma_f32_16x16x32_bf16 v[80:83], a[68:71], a[36:39], v[80:83]
    buffer_load_dwordx4 v5, s[24:27], s70 offen lds
    v_mfma_f32_16x16x32_bf16 v[80:83], a[64:67], a[32:35], v[80:83]
    ds_read_b64_tr_b16 a[54:55], v17 offset:58368
    ds_read_b64_tr_b16 a[172:173], v58 offset:72
    v_mfma_f32_16x16x32_bf16 v[76:79], a[64:67], a[24:27], v[76:79]
    ds_read_b64_tr_b16 a[174:175], v58 offset:2632
    ds_read_b64_tr_b16 a[176:177], v59 offset:128
    v_mfma_f32_16x16x32_bf16 v[76:79], a[68:71], a[28:31], v[76:79]
    ds_read_b64_tr_b16 a[56:57], v18 offset:49152
    ds_read_b64_tr_b16 a[178:179], v59 offset:2688
    v_mfma_f32_16x16x32_bf16 v[100:103], a[76:79], a[28:31], v[100:103]
    v_mfma_f32_16x16x32_bf16 v[100:103], a[72:75], a[24:27], v[100:103]
    s_add_u32 m0, s67, 110592
    ds_read_b64_tr_b16 a[58:59], v18 offset:50176
    v_mfma_f32_16x16x32_bf16 v[96:99], a[72:75], a[16:19], v[96:99]
    buffer_load_dwordx4 v6, s[24:27], s70 offen lds
    v_mfma_f32_16x16x32_bf16 v[96:99], a[76:79], a[20:23], v[96:99]
    ds_read_b64_tr_b16 a[60:61], v18 offset:57344
    v_mfma_f32_16x16x32_bf16 v[72:75], a[68:71], a[20:23], v[72:75]
    v_mfma_f32_16x16x32_bf16 v[72:75], a[64:67], a[16:19], v[72:75]
    ds_read_b64_tr_b16 a[62:63], v18 offset:58368
    v_mfma_f32_16x16x32_bf16 v[68:71], a[64:67], a[8:11], v[68:71]
    v_mfma_f32_16x16x32_bf16 v[68:71], a[68:71], a[12:15], v[68:71]
    s_add_u32 m0, s67, 114688
    v_mfma_f32_16x16x32_bf16 v[92:95], a[76:79], a[12:15], v[92:95]
    buffer_load_dwordx4 v7, s[24:27], s70 offen lds
    v_mfma_f32_16x16x32_bf16 v[92:95], a[72:75], a[8:11], v[92:95]
    v_mfma_f32_16x16x32_bf16 v[88:91], a[72:75], a[0:3], v[88:91]
    v_mfma_f32_16x16x32_bf16 v[88:91], a[76:79], a[4:7], v[88:91]
    v_mfma_f32_16x16x32_bf16 v[64:67], a[68:71], a[4:7], v[64:67]
    v_mfma_f32_16x16x32_bf16 v[64:67], a[64:67], a[0:3], v[64:67]
    s_waitcnt lgkmcnt(0)
    v_mfma_f32_16x16x32_bf16 v[228:231], a[48:51], a[40:43], v[228:231]
    s_add_u32 m0, s67, 118784
    ds_read_b64_tr_b16 a[64:65], v15 offset:49152
    v_mfma_f32_16x16x32_bf16 v[228:231], a[52:55], a[44:47], v[228:231]
    buffer_load_dwordx4 v8, s[24:27], s70 offen lds
    v_mfma_f32_16x16x32_bf16 v[252:255], a[60:63], a[44:47], v[252:255]
    ds_read_b64_tr_b16 a[66:67], v15 offset:50176
    v_mfma_f32_16x16x32_bf16 v[252:255], a[56:59], a[40:43], v[252:255]
    v_mfma_f32_16x16x32_bf16 v[248:251], a[56:59], a[32:35], v[248:251]
    s_add_u32 m0, s67, 122880
    ds_read_b64_tr_b16 a[68:69], v15 offset:57344
    v_mfma_f32_16x16x32_bf16 v[248:251], a[60:63], a[36:39], v[248:251]
    buffer_load_dwordx4 v9, s[24:27], s70 offen lds
    v_mfma_f32_16x16x32_bf16 v[224:227], a[52:55], a[36:39], v[224:227]
    ds_read_b64_tr_b16 a[70:71], v15 offset:58368
    v_mfma_f32_16x16x32_bf16 v[224:227], a[48:51], a[32:35], v[224:227]
    v_mfma_f32_16x16x32_bf16 v[220:223], a[48:51], a[24:27], v[220:223]
    s_add_u32 m0, s67, 126976
    ds_read_b64_tr_b16 a[72:73], v16 offset:49152
    v_mfma_f32_16x16x32_bf16 v[220:223], a[52:55], a[28:31], v[220:223]
    s_mov_b64 exec, s[72:73]
    buffer_load_dwordx4 v10, s[24:27], s70 offen lds
    s_mov_b64 exec, -1
    v_mfma_f32_16x16x32_bf16 v[244:247], a[60:63], a[28:31], v[244:247]
    ds_read_b64_tr_b16 a[74:75], v16 offset:50176
    v_mfma_f32_16x16x32_bf16 v[244:247], a[56:59], a[24:27], v[244:247]
    v_mfma_f32_16x16x32_bf16 v[240:243], a[56:59], a[16:19], v[240:243]
    ds_read_b64_tr_b16 a[76:77], v16 offset:57344
    v_mfma_f32_16x16x32_bf16 v[240:243], a[60:63], a[20:23], v[240:243]
    buffer_store_dwordx4 a[160:163], v3, s[40:43], s80 offen sc1
    v_mfma_f32_16x16x32_bf16 v[216:219], a[52:55], a[20:23], v[216:219]
    ds_read_b64_tr_b16 a[78:79], v16 offset:58368
    v_mfma_f32_16x16x32_bf16 v[216:219], a[48:51], a[16:19], v[216:219]
    v_mfma_f32_16x16x32_bf16 v[212:215], a[48:51], a[8:11], v[212:215]
    v_mfma_f32_16x16x32_bf16 v[212:215], a[52:55], a[12:15], v[212:215]
    s_add_u32 m0, s68, 40960
    v_mfma_f32_16x16x32_bf16 v[236:239], a[60:63], a[12:15], v[236:239]
    buffer_load_dwordx4 v14, s[28:31], s71 offen offset:3072 lds
    v_mfma_f32_16x16x32_bf16 v[236:239], a[56:59], a[8:11], v[236:239]
    v_mfma_f32_16x16x32_bf16 v[232:235], a[56:59], a[0:3], v[232:235]
    s_add_u32 m0, s68, 24576
    v_mfma_f32_16x16x32_bf16 v[232:235], a[60:63], a[4:7], v[232:235]
    buffer_load_dwordx4 v11, s[32:35], s71 offen lds
    v_mfma_f32_16x16x32_bf16 v[208:211], a[52:55], a[4:7], v[208:211]
    v_mfma_f32_16x16x32_bf16 v[208:211], a[48:51], a[0:3], v[208:211]
    s_waitcnt lgkmcnt(0)
    s_barrier
    v_mfma_f32_16x16x32_bf16 v[180:183], a[64:67], a[40:43], v[180:183]
    ds_read_b64_tr_b16 a[48:49], v17 offset:32768
    v_mfma_f32_16x16x32_bf16 v[180:183], a[68:71], a[44:47], v[180:183]
    v_mfma_f32_16x16x32_bf16 v[204:207], a[76:79], a[44:47], v[204:207]
    buffer_load_dwordx4 v12, s[32:35], s71 offen offset:1024 lds
    v_mfma_f32_16x16x32_bf16 v[204:207], a[72:75], a[40:43], v[204:207]
    ds_read_b64_tr_b16 a[50:51], v17 offset:33792
    v_mfma_f32_16x16x32_bf16 v[200:203], a[72:75], a[32:35], v[200:203]
    ds_read_b128 a[40:43], v56 offset:10240
    v_mfma_f32_16x16x32_bf16 v[200:203], a[76:79], a[36:39], v[200:203]
    ds_read_b64_tr_b16 a[52:53], v17 offset:40960
    v_mfma_f32_16x16x32_bf16 v[176:179], a[68:71], a[36:39], v[176:179]
    buffer_store_dwordx4 a[164:167], v3, s[40:43], s80 offen offset:1024 sc1
    v_mfma_f32_16x16x32_bf16 v[176:179], a[64:67], a[32:35], v[176:179]
    ds_read_b64_tr_b16 a[54:55], v17 offset:41984
    v_mfma_f32_16x16x32_bf16 v[172:175], a[64:67], a[24:27], v[172:175]
    ds_read_b128 a[44:47], v57 offset:10240
    v_mfma_f32_16x16x32_bf16 v[172:175], a[68:71], a[28:31], v[172:175]
    ds_read_b64_tr_b16 a[56:57], v18 offset:32768
    v_mfma_f32_16x16x32_bf16 v[196:199], a[76:79], a[28:31], v[196:199]
    ds_read_b128 a[32:35], v56 offset:8192
    v_mfma_f32_16x16x32_bf16 v[196:199], a[72:75], a[24:27], v[196:199]
    buffer_load_dwordx4 v13, s[32:35], s71 offen offset:2048 lds
    v_mfma_f32_16x16x32_bf16 v[192:195], a[72:75], a[16:19], v[192:195]
    ds_read_b64_tr_b16 a[58:59], v18 offset:33792
    v_mfma_f32_16x16x32_bf16 v[192:195], a[76:79], a[20:23], v[192:195]
    ds_read_b128 a[36:39], v57 offset:8192
    v_mfma_f32_16x16x32_bf16 v[168:171], a[68:71], a[20:23], v[168:171]
    ds_read_b64_tr_b16 a[60:61], v18 offset:40960
    v_mfma_f32_16x16x32_bf16 v[168:171], a[64:67], a[16:19], v[168:171]
    buffer_load_dwordx4 v14, s[32:35], s71 offen offset:3072 lds
    v_mfma_f32_16x16x32_bf16 v[164:167], a[64:67], a[8:11], v[164:167]
    ds_read_b64_tr_b16 a[62:63], v18 offset:41984
    v_mfma_f32_16x16x32_bf16 v[164:167], a[68:71], a[12:15], v[164:167]
    ds_read_b128 a[24:27], v56 offset:6144
    v_mfma_f32_16x16x32_bf16 v[188:191], a[76:79], a[12:15], v[188:191]
    ds_read_b128 a[28:31], v57 offset:6144
    v_mfma_f32_16x16x32_bf16 v[188:191], a[72:75], a[8:11], v[188:191]
    buffer_store_dwordx4 a[168:171], v3, s[40:43], s80 offen offset:2048 sc1
    v_mfma_f32_16x16x32_bf16 v[184:187], a[72:75], a[0:3], v[184:187]
    ds_read_b128 a[16:19], v56 offset:4096
    v_mfma_f32_16x16x32_bf16 v[184:187], a[76:79], a[4:7], v[184:187]
    ds_read_b128 a[20:23], v57 offset:4096
    v_mfma_f32_16x16x32_bf16 v[160:163], a[68:71], a[4:7], v[160:163]
    ds_read_b128 a[8:11], v56 offset:2048
    v_mfma_f32_16x16x32_bf16 v[160:163], a[64:67], a[0:3], v[160:163]
    s_add_u32 m0, s68, 90112
    ds_read_b128 a[12:15], v57 offset:2048
    s_waitcnt lgkmcnt(6)
    v_mfma_f32_16x16x32_bf16 v[132:135], a[48:51], a[40:43], v[132:135]
    s_mov_b32 s71, 1105920
    ds_read_b128 a[0:3], v56 offset:0
    v_mfma_f32_16x16x32_bf16 v[132:135], a[52:55], a[44:47], v[132:135]
    buffer_load_dwordx4 v11, s[28:31], s71 offen lds
    v_mfma_f32_16x16x32_bf16 v[156:159], a[60:63], a[44:47], v[156:159]
    ds_read_b128 a[4:7], v57 offset:0
    v_mfma_f32_16x16x32_bf16 v[156:159], a[56:59], a[40:43], v[156:159]
    ds_read_b64_tr_b16 a[64:65], v15 offset:32768
    v_mfma_f32_16x16x32_bf16 v[152:155], a[56:59], a[32:35], v[152:155]
    v_mfma_f32_16x16x32_bf16 v[152:155], a[60:63], a[36:39], v[152:155]
    buffer_load_dwordx4 v12, s[28:31], s71 offen offset:1024 lds
    v_mfma_f32_16x16x32_bf16 v[128:131], a[52:55], a[36:39], v[128:131]
    ds_read_b64_tr_b16 a[66:67], v15 offset:33792
    v_mfma_f32_16x16x32_bf16 v[128:131], a[48:51], a[32:35], v[128:131]
    ds_read_b64_tr_b16 a[68:69], v15 offset:40960
    s_waitcnt lgkmcnt(9)
    v_mfma_f32_16x16x32_bf16 v[124:127], a[48:51], a[24:27], v[124:127]
    v_mfma_f32_16x16x32_bf16 v[124:127], a[52:55], a[28:31], v[124:127]
    ds_read_b64_tr_b16 a[70:71], v15 offset:41984
    v_mfma_f32_16x16x32_bf16 v[148:151], a[60:63], a[28:31], v[148:151]
    buffer_load_dwordx4 v13, s[28:31], s71 offen offset:2048 lds
    v_mfma_f32_16x16x32_bf16 v[148:151], a[56:59], a[24:27], v[148:151]
    ds_read_b64_tr_b16 a[72:73], v16 offset:32768
    s_waitcnt lgkmcnt(9)
    v_mfma_f32_16x16x32_bf16 v[144:147], a[56:59], a[16:19], v[144:147]
    v_mfma_f32_16x16x32_bf16 v[144:147], a[60:63], a[20:23], v[144:147]
    ds_read_b64_tr_b16 a[74:75], v16 offset:33792
    v_mfma_f32_16x16x32_bf16 v[120:123], a[52:55], a[20:23], v[120:123]
    v_mfma_f32_16x16x32_bf16 v[120:123], a[48:51], a[16:19], v[120:123]
    buffer_load_dwordx4 v14, s[28:31], s71 offen offset:3072 lds
    s_waitcnt lgkmcnt(8)
    v_mfma_f32_16x16x32_bf16 v[116:119], a[48:51], a[8:11], v[116:119]
    ds_read_b64_tr_b16 a[76:77], v16 offset:40960
    v_mfma_f32_16x16x32_bf16 v[116:119], a[52:55], a[12:15], v[116:119]
    ds_read_b64_tr_b16 a[78:79], v16 offset:41984
    v_mfma_f32_16x16x32_bf16 v[140:143], a[60:63], a[12:15], v[140:143]
    v_mfma_f32_16x16x32_bf16 v[140:143], a[56:59], a[8:11], v[140:143]
    buffer_store_dwordx4 a[172:175], v3, s[40:43], s80 offen offset:3072 sc1
    s_waitcnt lgkmcnt(8)
    v_mfma_f32_16x16x32_bf16 v[136:139], a[56:59], a[0:3], v[136:139]
    v_mfma_f32_16x16x32_bf16 v[136:139], a[60:63], a[4:7], v[136:139]
    v_mfma_f32_16x16x32_bf16 v[112:115], a[52:55], a[4:7], v[112:115]
    v_mfma_f32_16x16x32_bf16 v[112:115], a[48:51], a[0:3], v[112:115]
    s_waitcnt vmcnt(24) lgkmcnt(0)
    s_barrier
    v_mfma_f32_16x16x32_bf16 v[84:87], a[64:67], a[40:43], v[84:87]
    buffer_store_dwordx4 a[176:179], v4, s[40:43], s80 offen sc1
    v_mfma_f32_16x16x32_bf16 v[84:87], a[68:71], a[44:47], v[84:87]
    ds_read_b64_tr_b16 a[48:49], v17 offset:16384
    v_mfma_f32_16x16x32_bf16 v[108:111], a[76:79], a[44:47], v[108:111]
    v_mfma_f32_16x16x32_bf16 v[108:111], a[72:75], a[40:43], v[108:111]
    s_add_u32 m0, s67, 0
    ds_read_b64_tr_b16 a[50:51], v17 offset:17408
    v_mfma_f32_16x16x32_bf16 v[104:107], a[72:75], a[32:35], v[104:107]
    s_mov_b32 s70, 640
    v_mfma_f32_16x16x32_bf16 v[104:107], a[76:79], a[36:39], v[104:107]
    buffer_load_dwordx4 v5, s[24:27], s70 offen lds
    v_mfma_f32_16x16x32_bf16 v[80:83], a[68:71], a[36:39], v[80:83]
    ds_read_b64_tr_b16 a[52:53], v17 offset:24576
    v_mfma_f32_16x16x32_bf16 v[80:83], a[64:67], a[32:35], v[80:83]
    v_mfma_f32_16x16x32_bf16 v[76:79], a[64:67], a[24:27], v[76:79]
    s_add_u32 m0, s67, 4096
    ds_read_b64_tr_b16 a[54:55], v17 offset:25600
    v_mfma_f32_16x16x32_bf16 v[76:79], a[68:71], a[28:31], v[76:79]
    buffer_load_dwordx4 v6, s[24:27], s70 offen lds
    v_mfma_f32_16x16x32_bf16 v[100:103], a[76:79], a[28:31], v[100:103]
    ds_read_b64_tr_b16 a[56:57], v18 offset:16384
    v_mfma_f32_16x16x32_bf16 v[100:103], a[72:75], a[24:27], v[100:103]
    v_mfma_f32_16x16x32_bf16 v[96:99], a[72:75], a[16:19], v[96:99]
    ds_read_b64_tr_b16 a[58:59], v18 offset:17408
    v_mfma_f32_16x16x32_bf16 v[96:99], a[76:79], a[20:23], v[96:99]
    s_add_u32 m0, s67, 8192
    v_mfma_f32_16x16x32_bf16 v[72:75], a[68:71], a[20:23], v[72:75]
    buffer_load_dwordx4 v7, s[24:27], s70 offen lds
    v_mfma_f32_16x16x32_bf16 v[72:75], a[64:67], a[16:19], v[72:75]
    ds_read_b64_tr_b16 a[60:61], v18 offset:24576
    v_mfma_f32_16x16x32_bf16 v[68:71], a[64:67], a[8:11], v[68:71]
    v_mfma_f32_16x16x32_bf16 v[68:71], a[68:71], a[12:15], v[68:71]
    ds_read_b64_tr_b16 a[62:63], v18 offset:25600
    v_mfma_f32_16x16x32_bf16 v[92:95], a[76:79], a[12:15], v[92:95]
    s_add_u32 m0, s67, 12288
    v_mfma_f32_16x16x32_bf16 v[92:95], a[72:75], a[8:11], v[92:95]
    buffer_load_dwordx4 v8, s[24:27], s70 offen lds
    v_mfma_f32_16x16x32_bf16 v[88:91], a[72:75], a[0:3], v[88:91]
    v_mfma_f32_16x16x32_bf16 v[88:91], a[76:79], a[4:7], v[88:91]
    v_mfma_f32_16x16x32_bf16 v[64:67], a[68:71], a[4:7], v[64:67]
    v_mfma_f32_16x16x32_bf16 v[64:67], a[64:67], a[0:3], v[64:67]
    s_waitcnt lgkmcnt(0)
    v_mfma_f32_16x16x32_bf16 v[228:231], a[48:51], a[40:43], v[228:231]
    s_add_u32 m0, s67, 16384
    ds_read_b64_tr_b16 a[64:65], v15 offset:16384
    v_mfma_f32_16x16x32_bf16 v[228:231], a[52:55], a[44:47], v[228:231]
    buffer_load_dwordx4 v9, s[24:27], s70 offen lds
    v_mfma_f32_16x16x32_bf16 v[252:255], a[60:63], a[44:47], v[252:255]
    ds_read_b64_tr_b16 a[66:67], v15 offset:17408
    v_mfma_f32_16x16x32_bf16 v[252:255], a[56:59], a[40:43], v[252:255]
    v_mfma_f32_16x16x32_bf16 v[248:251], a[56:59], a[32:35], v[248:251]
    ds_read_b64_tr_b16 a[68:69], v15 offset:24576
    v_mfma_f32_16x16x32_bf16 v[248:251], a[60:63], a[36:39], v[248:251]
    s_add_u32 m0, s67, 20480
    s_waitcnt vmcnt(26)
    v_cmp_ne_u32 vcc, 1, v53
    v_mfma_f32_16x16x32_bf16 v[224:227], a[52:55], a[36:39], v[224:227]
    s_mov_b64 exec, s[72:73]
    buffer_load_dwordx4 v10, s[24:27], s70 offen lds
    s_mov_b64 exec, -1
    v_mfma_f32_16x16x32_bf16 v[224:227], a[48:51], a[32:35], v[224:227]
    ds_read_b64_tr_b16 a[70:71], v15 offset:25600
    v_mfma_f32_16x16x32_bf16 v[220:223], a[48:51], a[24:27], v[220:223]
    s_nop 0
    s_cbranch_vccnz L_spin_glur
L_back_glur:
    v_mfma_f32_16x16x32_bf16 v[220:223], a[52:55], a[28:31], v[220:223]
    ds_read_b64_tr_b16 a[72:73], v16 offset:16384
    v_mfma_f32_16x16x32_bf16 v[244:247], a[60:63], a[28:31], v[244:247]
    v_mfma_f32_16x16x32_bf16 v[244:247], a[56:59], a[24:27], v[244:247]
    s_add_u32 m0, s68, 73728
    ds_read_b64_tr_b16 a[74:75], v16 offset:17408
    v_mfma_f32_16x16x32_bf16 v[240:243], a[56:59], a[16:19], v[240:243]
    buffer_load_dwordx4 v11, s[32:35], s71 offen lds
    v_mfma_f32_16x16x32_bf16 v[240:243], a[60:63], a[20:23], v[240:243]
    ds_read_b64_tr_b16 a[76:77], v16 offset:24576
    v_mfma_f32_16x16x32_bf16 v[216:219], a[52:55], a[20:23], v[216:219]
    v_mfma_f32_16x16x32_bf16 v[216:219], a[48:51], a[16:19], v[216:219]
    ds_read_b64_tr_b16 a[78:79], v16 offset:25600
    v_mfma_f32_16x16x32_bf16 v[212:215], a[48:51], a[8:11], v[212:215]
    v_mfma_f32_16x16x32_bf16 v[212:215], a[52:55], a[12:15], v[212:215]
    v_mfma_f32_16x16x32_bf16 v[236:239], a[60:63], a[12:15], v[236:239]
    buffer_load_dwordx4 v12, s[32:35], s71 offen offset:1024 lds
    v_mfma_f32_16x16x32_bf16 v[236:239], a[56:59], a[8:11], v[236:239]
    v_mfma_f32_16x16x32_bf16 v[232:235], a[56:59], a[0:3], v[232:235]
    v_mfma_f32_16x16x32_bf16 v[232:235], a[60:63], a[4:7], v[232:235]
    v_mfma_f32_16x16x32_bf16 v[208:211], a[52:55], a[4:7], v[208:211]
    v_mfma_f32_16x16x32_bf16 v[208:211], a[48:51], a[0:3], v[208:211]
    s_waitcnt vmcnt(8) lgkmcnt(0)
    s_barrier
    v_mfma_f32_16x16x32_bf16 v[180:183], a[64:67], a[40:43], v[180:183]
    buffer_load_dwordx4 v13, s[32:35], s71 offen offset:2048 lds
    v_mfma_f32_16x16x32_bf16 v[180:183], a[68:71], a[44:47], v[180:183]
    ds_read_b64_tr_b16 a[48:49], v17 offset:0
    s_lshr_b32 s63, s2, 3
    v_mfma_f32_16x16x32_bf16 v[204:207], a[76:79], a[44:47], v[204:207]
    s_lshl_b32 s63, s63, 5
    s_and_b32 s64, s2, 7
    s_add_u32 s63, s63, s64
    v_mfma_f32_16x16x32_bf16 v[204:207], a[72:75], a[40:43], v[204:207]
    ds_read_b64_tr_b16 a[50:51], v17 offset:1024
    s_lshl2_add_u32 s63, s63, 20480
    v_mfma_f32_16x16x32_bf16 v[200:203], a[72:75], a[32:35], v[200:203]
    ds_read_b128 a[40:43], v54 offset:10240
    v_cmp_eq_u32 vcc, 0, v0
    v_mfma_f32_16x16x32_bf16 v[200:203], a[76:79], a[36:39], v[200:203]
    ds_read_b64_tr_b16 a[52:53], v17 offset:8192
    v_mov_b32 v48, s63
    v_mfma_f32_16x16x32_bf16 v[176:179], a[68:71], a[36:39], v[176:179]
    buffer_load_dwordx4 v14, s[32:35], s71 offen offset:3072 lds
    v_mfma_f32_16x16x32_bf16 v[176:179], a[64:67], a[32:35], v[176:179]
    ds_read_b64_tr_b16 a[54:55], v17 offset:9216
    v_mov_b32 v49, 2147418112
    v_mfma_f32_16x16x32_bf16 v[172:175], a[64:67], a[24:27], v[172:175]
    ds_read_b128 a[44:47], v55 offset:10240
    v_cndmask_b32 v48, v49, v48, vcc
    v_mfma_f32_16x16x32_bf16 v[172:175], a[68:71], a[28:31], v[172:175]
    ds_read_b64_tr_b16 a[56:57], v18 offset:0
    v_mov_b32 v49, 1
    v_mfma_f32_16x16x32_bf16 v[196:199], a[76:79], a[28:31], v[196:199]
    s_add_u32 m0, s68, 57344
    ds_read_b128 a[32:35], v54 offset:8192
    buffer_store_dword v49, v48, s[44:47], 0 offen sc1
    v_mfma_f32_16x16x32_bf16 v[196:199], a[72:75], a[24:27], v[196:199]
    s_mov_b32 s71, 1327104
    ds_read_b64_tr_b16 a[58:59], v18 offset:1024
    v_mfma_f32_16x16x32_bf16 v[192:195], a[72:75], a[16:19], v[192:195]
    buffer_load_dwordx4 v11, s[28:31], s71 offen lds
    v_mfma_f32_16x16x32_bf16 v[192:195], a[76:79], a[20:23], v[192:195]
    ds_read_b64_tr_b16 a[60:61], v18 offset:8192
    v_mfma_f32_16x16x32_bf16 v[168:171], a[68:71], a[20:23], v[168:171]
    ds_read_b128 a[36:39], v55 offset:8192
    v_mfma_f32_16x16x32_bf16 v[168:171], a[64:67], a[16:19], v[168:171]
    ds_read_b64_tr_b16 a[62:63], v18 offset:9216
    v_mfma_f32_16x16x32_bf16 v[164:167], a[64:67], a[8:11], v[164:167]
    ds_read_b128 a[24:27], v54 offset:6144
    v_mfma_f32_16x16x32_bf16 v[164:167], a[68:71], a[12:15], v[164:167]
    ds_read_b128 a[28:31], v55 offset:6144
    v_mfma_f32_16x16x32_bf16 v[188:191], a[76:79], a[12:15], v[188:191]
    buffer_load_dwordx4 v12, s[28:31], s71 offen offset:1024 lds
    v_mfma_f32_16x16x32_bf16 v[188:191], a[72:75], a[8:11], v[188:191]
    ds_read_b128 a[16:19], v54 offset:4096
    v_mfma_f32_16x16x32_bf16 v[184:187], a[72:75], a[0:3], v[184:187]
    ds_read_b128 a[20:23], v55 offset:4096
    v_mfma_f32_16x16x32_bf16 v[184:187], a[76:79], a[4:7], v[184:187]
    ds_read_b128 a[8:11], v54 offset:2048
    v_mfma_f32_16x16x32_bf16 v[160:163], a[68:71], a[4:7], v[160:163]
    ds_read_b128 a[12:15], v55 offset:2048
    v_mfma_f32_16x16x32_bf16 v[160:163], a[64:67], a[0:3], v[160:163]
    s_waitcnt lgkmcnt(6)
    v_mfma_f32_16x16x32_bf16 v[132:135], a[48:51], a[40:43], v[132:135]
    ds_read_b128 a[0:3], v54 offset:0
    v_mfma_f32_16x16x32_bf16 v[132:135], a[52:55], a[44:47], v[132:135]
    buffer_load_dwordx4 v13, s[28:31], s71 offen offset:2048 lds
    v_mfma_f32_16x16x32_bf16 v[156:159], a[60:63], a[44:47], v[156:159]
    ds_read_b128 a[4:7], v55 offset:0
    v_mfma_f32_16x16x32_bf16 v[156:159], a[56:59], a[40:43], v[156:159]
    ds_read_b64_tr_b16 a[64:65], v15 offset:0
    v_mfma_f32_16x16x32_bf16 v[152:155], a[56:59], a[32:35], v[152:155]
    v_mfma_f32_16x16x32_bf16 v[152:155], a[60:63], a[36:39], v[152:155]
    ds_read_b64_tr_b16 a[66:67], v15 offset:1024
    v_mfma_f32_16x16x32_bf16 v[128:131], a[52:55], a[36:39], v[128:131]
    buffer_load_dwordx4 v14, s[28:31], s71 offen offset:3072 lds
    v_mfma_f32_16x16x32_bf16 v[128:131], a[48:51], a[32:35], v[128:131]
    ds_read_b64_tr_b16 a[68:69], v15 offset:8192
    s_waitcnt lgkmcnt(9)
    v_mfma_f32_16x16x32_bf16 v[124:127], a[48:51], a[24:27], v[124:127]
    v_mfma_f32_16x16x32_bf16 v[124:127], a[52:55], a[28:31], v[124:127]
    ds_read_b64_tr_b16 a[70:71], v15 offset:9216
    v_mfma_f32_16x16x32_bf16 v[148:151], a[60:63], a[28:31], v[148:151]
    v_mfma_f32_16x16x32_bf16 v[148:151], a[56:59], a[24:27], v[148:151]
    ds_read_b64_tr_b16 a[72:73], v16 offset:0
    s_waitcnt lgkmcnt(9)
    v_mfma_f32_16x16x32_bf16 v[144:147], a[56:59], a[16:19], v[144:147]
    v_mfma_f32_16x16x32_bf16 v[144:147], a[60:63], a[20:23], v[144:147]
    ds_read_b64_tr_b16 a[74:75], v16 offset:1024
    v_mfma_f32_16x16x32_bf16 v[120:123], a[52:55], a[20:23], v[120:123]
    v_mfma_f32_16x16x32_bf16 v[120:123], a[48:51], a[16:19], v[120:123]
    ds_read_b64_tr_b16 a[76:77], v16 offset:8192
    s_waitcnt lgkmcnt(9)
    v_mfma_f32_16x16x32_bf16 v[116:119], a[48:51], a[8:11], v[116:119]
    v_mfma_f32_16x16x32_bf16 v[116:119], a[52:55], a[12:15], v[116:119]
    ds_read_b64_tr_b16 a[78:79], v16 offset:9216
    v_mfma_f32_16x16x32_bf16 v[140:143], a[60:63], a[12:15], v[140:143]
    v_mfma_f32_16x16x32_bf16 v[140:143], a[56:59], a[8:11], v[140:143]
    s_waitcnt lgkmcnt(8)
    v_mfma_f32_16x16x32_bf16 v[136:139], a[56:59], a[0:3], v[136:139]
    v_mfma_f32_16x16x32_bf16 v[136:139], a[60:63], a[4:7], v[136:139]
    v_mfma_f32_16x16x32_bf16 v[112:115], a[52:55], a[4:7], v[112:115]
    v_mfma_f32_16x16x32_bf16 v[112:115], a[48:51], a[0:3], v[112:115]
    s_waitcnt lgkmcnt(0)
    s_barrier
    v_mfma_f32_16x16x32_bf16 v[84:87], a[64:67], a[40:43], v[84:87]
    ds_read_b64_tr_b16 a[48:49], v62 offset:0
    v_mfma_f32_16x16x32_bf16 v[84:87], a[68:71], a[44:47], v[84:87]
    v_mfma_f32_16x16x32_bf16 v[108:111], a[76:79], a[44:47], v[108:111]
    ds_read_b64_tr_b16 a[50:51], v62 offset:1024
    v_mfma_f32_16x16x32_bf16 v[108:111], a[72:75], a[40:43], v[108:111]
    v_mfma_f32_16x16x32_bf16 v[104:107], a[72:75], a[32:35], v[104:107]
    s_add_u32 m0, s67, 106496
    ds_read_b64_tr_b16 a[52:53], v62 offset:8192
    v_mfma_f32_16x16x32_bf16 v[104:107], a[76:79], a[36:39], v[104:107]
    s_mov_b32 s70, 768
    v_mfma_f32_16x16x32_bf16 v[80:83], a[68:71], a[36:39], v[80:83]
    buffer_load_dwordx4 v5, s[24:27], s70 offen lds
    v_mfma_f32_16x16x32_bf16 v[80:83], a[64:67], a[32:35], v[80:83]
    ds_read_b64_tr_b16 a[54:55], v62 offset:9216
    v_mfma_f32_16x16x32_bf16 v[76:79], a[64:67], a[24:27], v[76:79]
    v_mfma_f32_16x16x32_bf16 v[76:79], a[68:71], a[28:31], v[76:79]
    ds_read_b64_tr_b16 a[56:57], v63 offset:0
    v_mfma_f32_16x16x32_bf16 v[100:103], a[76:79], a[28:31], v[100:103]
    v_mfma_f32_16x16x32_bf16 v[100:103], a[72:75], a[24:27], v[100:103]
    s_add_u32 m0, s67, 110592
    ds_read_b64_tr_b16 a[58:59], v63 offset:1024
    v_mfma_f32_16x16x32_bf16 v[96:99], a[72:75], a[16:19], v[96:99]
    buffer_load_dwordx4 v6, s[24:27], s70 offen lds
    v_mfma_f32_16x16x32_bf16 v[96:99], a[76:79], a[20:23], v[96:99]
    ds_read_b64_tr_b16 a[60:61], v63 offset:8192
    v_mfma_f32_16x16x32_bf16 v[72:75], a[68:71], a[20:23], v[72:75]
    v_mfma_f32_16x16x32_bf16 v[72:75], a[64:67], a[16:19], v[72:75]
    ds_read_b64_tr_b16 a[62:63], v63 offset:9216
    v_mfma_f32_16x16x32_bf16 v[68:71], a[64:67], a[8:11], v[68:71]
    v_mfma_f32_16x16x32_bf16 v[68:71], a[68:71], a[12:15], v[68:71]
    s_add_u32 m0, s67, 114688
    v_mfma_f32_16x16x32_bf16 v[92:95], a[76:79], a[12:15], v[92:95]
    buffer_load_dwordx4 v7, s[24:27], s70 offen lds
    v_mfma_f32_16x16x32_bf16 v[92:95], a[72:75], a[8:11], v[92:95]
    v_mfma_f32_16x16x32_bf16 v[88:91], a[72:75], a[0:3], v[88:91]
    v_mfma_f32_16x16x32_bf16 v[88:91], a[76:79], a[4:7], v[88:91]
    v_mfma_f32_16x16x32_bf16 v[64:67], a[68:71], a[4:7], v[64:67]
    v_mfma_f32_16x16x32_bf16 v[64:67], a[64:67], a[0:3], v[64:67]
    s_waitcnt lgkmcnt(0)
    v_mfma_f32_16x16x32_bf16 v[228:231], a[48:51], a[40:43], v[228:231]
    s_add_u32 m0, s67, 118784
L_pg1:
    s_cbranch_execz L_pg5
    ds_read_b64_tr_b16 a[64:65], v60 offset:0
    v_mfma_f32_16x16x32_bf16 v[228:231], a[52:55], a[44:47], v[228:231]
    buffer_load_dwordx4 v8, s[24:27], s70 offen lds
    v_mfma_f32_16x16x32_bf16 v[252:255], a[60:63], a[44:47], v[252:255]
    ds_read_b64_tr_b16 a[66:67], v60 offset:1024
    v_mfma_f32_16x16x32_bf16 v[252:255], a[56:59], a[40:43], v[252:255]
    v_mfma_f32_16x16x32_bf16 v[248:251], a[56:59], a[32:35], v[248:251]
    ds_read_b64_tr_b16 a[68:69], v60 offset:8192
    v_mfma_f32_16x16x32_bf16 v[248:251], a[60:63], a[36:39], v[248:251]
    s_add_u32 m0, s67, 122880
    v_mfma_f32_16x16x32_bf16 v[224:227], a[52:55], a[36:39], v[224:227]
    buffer_load_dwordx4 v9, s[24:27], s70 offen lds
    v_mfma_f32_16x16x32_bf16 v[224:227], a[48:51], a[32:35], v[224:227]
    ds_read_b64_tr_b16 a[70:71], v60 offset:9216
    v_mfma_f32_16x16x32_bf16 v[220:223], a[48:51], a[24:27], v[220:223]
    v_mfma_f32_16x16x32_bf16 v[220:223], a[52:55], a[28:31], v[220:223]
    ds_read_b64_tr_b16 a[72:73], v61 offset:0
    v_mfma_f32_16x16x32_bf16 v[244:247], a[60:63], a[28:31], v[244:247]
    v_mfma_f32_16x16x32_bf16 v[244:247], a[56:59], a[24:27], v[244:247]
    s_add_u32 m0, s67, 126976
    ds_read_b64_tr_b16 a[74:75], v61 offset:1024
    v_mfma_f32_16x16x32_bf16 v[240:243], a[56:59], a[16:19], v[240:243]
    s_mov_b64 exec, s[72:73]
    buffer_load_dwordx4 v10, s[24:27], s70 offen lds
    s_mov_b64 exec, -1
    v_mfma_f32_16x16x32_bf16 v[240:243], a[60:63], a[20:23], v[240:243]
    ds_read_b64_tr_b16 a[76:77], v61 offset:8192
    v_mfma_f32_16x16x32_bf16 v[216:219], a[52:55], a[20:23], v[216:219]
    v_mfma_f32_16x16x32_bf16 v[216:219], a[48:51], a[16:19], v[216:219]
    ds_read_b64_tr_b16 a[78:79], v61 offset:9216
    v_mfma_f32_16x16x32_bf16 v[212:215], a[48:51], a[8:11], v[212:215]
    v_mfma_f32_16x16x32_bf16 v[212:215], a[52:55], a[12:15], v[212:215]
    s_add_u32 m0, s68, 40960
    v_mfma_f32_16x16x32_bf16 v[236:239], a[60:63], a[12:15], v[236:239]
    buffer_load_dwordx4 v11, s[32:35], s71 offen lds
    v_mfma_f32_16x16x32_bf16 v[236:239], a[56:59], a[8:11], v[236:239]
    v_mfma_f32_16x16x32_bf16 v[232:235], a[56:59], a[0:3], v[232:235]
    v_mfma_f32_16x16x32_bf16 v[232:235], a[60:63], a[4:7], v[232:235]
    v_mfma_f32_16x16x32_bf16 v[208:211], a[52:55], a[4:7], v[208:211]
    v_mfma_f32_16x16x32_bf16 v[208:211], a[48:51], a[0:3], v[208:211]
    s_waitcnt vmcnt(16) lgkmcnt(0)
    s_barrier
    v_mfma_f32_16x16x32_bf16 v[180:183], a[64:67], a[40:43], v[180:183]
    buffer_load_dwordx4 v12, s[32:35], s71 offen offset:1024 lds
    v_mfma_f32_16x16x32_bf16 v[180:183], a[68:71], a[44:47], v[180:183]
    ds_read_b64_tr_b16 a[48:49], v17 offset:49152
    v_mfma_f32_16x16x32_bf16 v[204:207], a[76:79], a[44:47], v[204:207]
    v_mfma_f32_16x16x32_bf16 v[204:207], a[72:75], a[40:43], v[204:207]
    ds_read_b64_tr_b16 a[50:51], v17 offset:50176
    v_mfma_f32_16x16x32_bf16 v[200:203], a[72:75], a[32:35], v[200:203]
    ds_read_b128 a[40:43], v56 offset:10240
    v_mfma_f32_16x16x32_bf16 v[200:203], a[76:79], a[36:39], v[200:203]
    ds_read_b64_tr_b16 a[52:53], v17 offset:57344
    v_mfma_f32_16x16x32_bf16 v[176:179], a[68:71], a[36:39], v[176:179]
    buffer_load_dwordx4 v13, s[32:35], s71 offen offset:2048 lds
    v_mfma_f32_16x16x32_bf16 v[176:179], a[64:67], a[32:35], v[176:179]
    ds_read_b64_tr_b16 a[54:55], v17 offset:58368
    v_mfma_f32_16x16x32_bf16 v[172:175], a[64:67], a[24:27], v[172:175]
    ds_read_b128 a[44:47], v57 offset:10240
    v_mfma_f32_16x16x32_bf16 v[172:175], a[68:71], a[28:31], v[172:175]
    ds_read_b64_tr_b16 a[56:57], v18 offset:49152
    v_mfma_f32_16x16x32_bf16 v[196:199], a[76:79], a[28:31], v[196:199]
    ds_read_b128 a[32:35], v56 offset:8192
    v_mfma_f32_16x16x32_bf16 v[196:199], a[72:75], a[24:27], v[196:199]
    ds_read_b64_tr_b16 a[58:59], v18 offset:50176
    v_mfma_f32_16x16x32_bf16 v[192:195], a[72:75], a[16:19], v[192:195]
    buffer_load_dwordx4 v14, s[32:35], s71 offen offset:3072 lds
    v_mfma_f32_16x16x32_bf16 v[192:195], a[76:79], a[20:23], v[192:195]
    ds_read_b64_tr_b16 a[60:61], v18 offset:57344
    v_mfma_f32_16x16x32_bf16 v[168:171], a[68:71], a[20:23], v[168:171]
    ds_read_b128 a[36:39], v57 offset:8192
    v_mfma_f32_16x16x32_bf16 v[168:171], a[64:67], a[16:19], v[168:171]
    ds_read_b64_tr_b16 a[62:63], v18 offset:58368
    v_mfma_f32_16x16x32_bf16 v[164:167], a[64:67], a[8:11], v[164:167]
    s_add_u32 m0, s68, 24576
    ds_read_b128 a[24:27], v56 offset:6144
    v_mfma_f32_16x16x32_bf16 v[164:167], a[68:71], a[12:15], v[164:167]
    s_mov_b32 s71, 1548288
    ds_read_b128 a[28:31], v57 offset:6144
    v_mfma_f32_16x16x32_bf16 v[188:191], a[76:79], a[12:15], v[188:191]
    buffer_load_dwordx4 v11, s[28:31], s71 offen lds
    v_mfma_f32_16x16x32_bf16 v[188:191], a[72:75], a[8:11], v[188:191]
    ds_read_b128 a[16:19], v56 offset:4096
    v_mfma_f32_16x16x32_bf16 v[184:187], a[72:75], a[0:3], v[184:187]
    ds_read_b128 a[20:23], v57 offset:4096
    v_mfma_f32_16x16x32_bf16 v[184:187], a[76:79], a[4:7], v[184:187]
    ds_read_b128 a[8:11], v56 offset:2048
    v_mfma_f32_16x16x32_bf16 v[160:163], a[68:71], a[4:7], v[160:163]
    ds_read_b128 a[12:15], v57 offset:2048
    v_mfma_f32_16x16x32_bf16 v[160:163], a[64:67], a[0:3], v[160:163]
    s_waitcnt lgkmcnt(6)
    v_mfma_f32_16x16x32_bf16 v[132:135], a[48:51], a[40:43], v[132:135]
    ds_read_b128 a[0:3], v56 offset:0
    v_mfma_f32_16x16x32_bf16 v[132:135], a[52:55], a[44:47], v[132:135]
    buffer_load_dwordx4 v12, s[28:31], s71 offen offset:1024 lds
    v_mfma_f32_16x16x32_bf16 v[156:159], a[60:63], a[44:47], v[156:159]
    ds_read_b128 a[4:7], v57 offset:0
    v_mfma_f32_16x16x32_bf16 v[156:159], a[56:59], a[40:43], v[156:159]
    ds_read_b64_tr_b16 a[64:65], v15 offset:49152
    v_mfma_f32_16x16x32_bf16 v[152:155], a[56:59], a[32:35], v[152:155]
    v_mfma_f32_16x16x32_bf16 v[152:155], a[60:63], a[36:39], v[152:155]
    ds_read_b64_tr_b16 a[66:67], v15 offset:50176
    v_mfma_f32_16x16x32_bf16 v[128:131], a[52:55], a[36:39], v[128:131]
    buffer_load_dwordx4 v13, s[28:31], s71 offen offset:2048 lds
    v_mfma_f32_16x16x32_bf16 v[128:131], a[48:51], a[32:35], v[128:131]
    ds_read_b64_tr_b16 a[68:69], v15 offset:57344
    s_waitcnt lgkmcnt(9)
    v_mfma_f32_16x16x32_bf16 v[124:127], a[48:51], a[24:27], v[124:127]
    v_mfma_f32_16x16x32_bf16 v[124:127], a[52:55], a[28:31], v[124:127]
    ds_read_b64_tr_b16 a[70:71], v15 offset:58368
    v_mfma_f32_16x16x32_bf16 v[148:151], a[60:63], a[28:31], v[148:151]
    v_mfma_f32_16x16x32_bf16 v[148:151], a[56:59], a[24:27], v[148:151]
    ds_read_b64_tr_b16 a[72:73], v16 offset:49152
    s_waitcnt lgkmcnt(9)
    v_mfma_f32_16x16x32_bf16 v[144:147], a[56:59], a[16:19], v[144:147]
    buffer_load_dwordx4 v14, s[28:31], s71 offen offset:3072 lds
    v_mfma_f32_16x16x32_bf16 v[144:147], a[60:63], a[20:23], v[144:147]
    ds_read_b64_tr_b16 a[74:75], v16 offset:50176
    v_mfma_f32_16x16x32_bf16 v[120:123], a[52:55], a[20:23], v[120:123]
    v_mfma_f32_16x16x32_bf16 v[120:123], a[48:51], a[16:19], v[120:123]
    ds_read_b64_tr_b16 a[76:77], v16 offset:57344
    s_waitcnt lgkmcnt(9)
    v_mfma_f32_16x16x32_bf16 v[116:119], a[48:51], a[8:11], v[116:119]
    v_mfma_f32_16x16x32_bf16 v[116:119], a[52:55], a[12:15], v[116:119]
    ds_read_b64_tr_b16 a[78:79], v16 offset:58368
    v_mfma_f32_16x16x32_bf16 v[140:143], a[60:63], a[12:15], v[140:143]
    v_mfma_f32_16x16x32_bf16 v[140:143], a[56:59], a[8:11], v[140:143]
    s_waitcnt lgkmcnt(8)
    v_mfma_f32_16x16x32_bf16 v[136:139], a[56:59], a[0:3], v[136:139]
    v_mfma_f32_16x16x32_bf16 v[136:139], a[60:63], a[4:7], v[136:139]
    v_mfma_f32_16x16x32_bf16 v[112:115], a[52:55], a[4:7], v[112:115]
    v_mfma_f32_16x16x32_bf16 v[112:115], a[48:51], a[0:3], v[112:115]
    s_waitcnt vmcnt(19) lgkmcnt(0)
    s_barrier
    v_mfma_f32_16x16x32_bf16 v[84:87], a[64:67], a[40:43], v[84:87]
    ds_read_b64_tr_b16 a[48:49], v17 offset:32768
    v_mfma_f32_16x16x32_bf16 v[84:87], a[68:71], a[44:47], v[84:87]
    v_mfma_f32_16x16x32_bf16 v[108:111], a[76:79], a[44:47], v[108:111]
    ds_read_b64_tr_b16 a[50:51], v17 offset:33792
    v_mfma_f32_16x16x32_bf16 v[108:111], a[72:75], a[40:43], v[108:111]
    v_mfma_f32_16x16x32_bf16 v[104:107], a[72:75], a[32:35], v[104:107]
    s_add_u32 m0, s67, 0
    ds_read_b64_tr_b16 a[52:53], v17 offset:40960
    v_mfma_f32_16x16x32_bf16 v[104:107], a[76:79], a[36:39], v[104:107]
    s_mov_b32 s70, 896
    v_mfma_f32_16x16x32_bf16 v[80:83], a[68:71], a[36:39], v[80:83]
    buffer_load_dwordx4 v5, s[24:27], s70 offen lds
    v_mfma_f32_16x16x32_bf16 v[80:83], a[64:67], a[32:35], v[80:83]
    ds_read_b64_tr_b16 a[54:55], v17 offset:41984
    v_mfma_f32_16x16x32_bf16 v[76:79], a[64:67], a[24:27], v[76:79]
    v_mfma_f32_16x16x32_bf16 v[76:79], a[68:71], a[28:31], v[76:79]
    ds_read_b64_tr_b16 a[56:57], v18 offset:32768
    v_mfma_f32_16x16x32_bf16 v[100:103], a[76:79], a[28:31], v[100:103]
    v_mfma_f32_16x16x32_bf16 v[100:103], a[72:75], a[24:27], v[100:103]
    s_add_u32 m0, s67, 4096
    ds_read_b64_tr_b16 a[58:59], v18 offset:33792
    v_mfma_f32_16x16x32_bf16 v[96:99], a[72:75], a[16:19], v[96:99]
    buffer_load_dwordx4 v6, s[24:27], s70 offen lds
    v_mfma_f32_16x16x32_bf16 v[96:99], a[76:79], a[20:23], v[96:99]
    ds_read_b64_tr_b16 a[60:61], v18 offset:40960
    v_mfma_f32_16x16x32_bf16 v[72:75], a[68:71], a[20:23], v[72:75]
    v_mfma_f32_16x16x32_bf16 v[72:75], a[64:67], a[16:19], v[72:75]
    ds_read_b64_tr_b16 a[62:63], v18 offset:41984
    v_mfma_f32_16x16x32_bf16 v[68:71], a[64:67], a[8:11], v[68:71]
    v_mfma_f32_16x16x32_bf16 v[68:71], a[68:71], a[12:15], v[68:71]
    s_add_u32 m0, s67, 8192
    v_mfma_f32_16x16x32_bf16 v[92:95], a[76:79], a[12:15], v[92:95]
    buffer_load_dwordx4 v7, s[24:27], s70 offen lds
    v_mfma_f32_16x16x32_bf16 v[92:95], a[72:75], a[8:11], v[92:95]
    v_mfma_f32_16x16x32_bf16 v[88:91], a[72:75], a[0:3], v[88:91]
    v_mfma_f32_16x16x32_bf16 v[88:91], a[76:79], a[4:7], v[88:91]
    v_mfma_f32_16x16x32_bf16 v[64:67], a[68:71], a[4:7], v[64:67]
    v_mfma_f32_16x16x32_bf16 v[64:67], a[64:67], a[0:3], v[64:67]
    s_waitcnt lgkmcnt(0)
    v_mfma_f32_16x16x32_bf16 v[228:231], a[48:51], a[40:43], v[228:231]
    s_add_u32 m0, s67, 12288
    ds_read_b64_tr_b16 a[64:65], v15 offset:32768
    v_mfma_f32_16x16x32_bf16 v[228:231], a[52:55], a[44:47], v[228:231]
    buffer_load_dwordx4 v8, s[24:27], s70 offen lds
    v_mfma_f32_16x16x32_bf16 v[252:255], a[60:63], a[44:47], v[252:255]
    ds_read_b64_tr_b16 a[66:67], v15 offset:33792
    v_mfma_f32_16x16x32_bf16 v[252:255], a[56:59], a[40:43], v[252:255]
    v_mfma_f32_16x16x32_bf16 v[248:251], a[56:59], a[32:35], v[248:251]
    ds_read_b64_tr_b16 a[68:69], v15 offset:40960
    v_mfma_f32_16x16x32_bf16 v[248:251], a[60:63], a[36:39], v[248:251]
    s_add_u32 m0, s67, 16384
    v_mfma_f32_16x16x32_bf16 v[224:227], a[52:55], a[36:39], v[224:227]
    buffer_load_dwordx4 v9, s[24:27], s70 offen lds
    v_mfma_f32_16x16x32_bf16 v[224:227], a[48:51], a[32:35], v[224:227]
    ds_read_b64_tr_b16 a[70:71], v15 offset:41984
    v_mfma_f32_16x16x32_bf16 v[220:223], a[48:51], a[24:27], v[220:223]
    v_mfma_f32_16x16x32_bf16 v[220:223], a[52:55], a[28:31], v[220:223]
    ds_read_b64_tr_b16 a[72:73], v16 offset:32768
    v_mfma_f32_16x16x32_bf16 v[244:247], a[60:63], a[28:31], v[244:247]
    v_mfma_f32_16x16x32_bf16 v[244:247], a[56:59], a[24:27], v[244:247]
    s_add_u32 m0, s67, 20480
    ds_read_b64_tr_b16 a[74:75], v16 offset:33792
    v_mfma_f32_16x16x32_bf16 v[240:243], a[56:59], a[16:19], v[240:243]
    s_mov_b64 exec, s[72:73]
    buffer_load_dwordx4 v10, s[24:27], s70 offen lds
    s_mov_b64 exec, -1
    v_mfma_f32_16x16x32_bf16 v[240:243], a[60:63], a[20:23], v[240:243]
    ds_read_b64_tr_b16 a[76:77], v16 offset:40960
    v_mfma_f32_16x16x32_bf16 v[216:219], a[52:55], a[20:23], v[216:219]
    v_mfma_f32_16x16x32_bf16 v[216:219], a[48:51], a[16:19], v[216:219]
    ds_read_b64_tr_b16 a[78:79], v16 offset:41984
    v_mfma_f32_16x16x32_bf16 v[212:215], a[48:51], a[8:11], v[212:215]
    v_mfma_f32_16x16x32_bf16 v[212:215], a[52:55], a[12:15], v[212:215]
    s_add_u32 m0, s68, 90112
    v_mfma_f32_16x16x32_bf16 v[236:239], a[60:63], a[12:15], v[236:239]
    buffer_load_dwordx4 v11, s[32:35], s71 offen lds
    v_mfma_f32_16x16x32_bf16 v[236:239], a[56:59], a[8:11], v[236:239]
    v_mfma_f32_16x16x32_bf16 v[232:235], a[56:59], a[0:3], v[232:235]
    v_mfma_f32_16x16x32_bf16 v[232:235], a[60:63], a[4:7], v[232:235]
    v_mfma_f32_16x16x32_bf16 v[208:211], a[52:55], a[4:7], v[208:211]
    v_mfma_f32_16x16x32_bf16 v[208:211], a[48:51], a[0:3], v[208:211]
    s_waitcnt vmcnt(15) lgkmcnt(0)
    s_barrier
    v_mfma_f32_16x16x32_bf16 v[180:183], a[64:67], a[40:43], v[180:183]
    buffer_load_dwordx4 v12, s[32:35], s71 offen offset:1024 lds
    v_mfma_f32_16x16x32_bf16 v[180:183], a[68:71], a[44:47], v[180:183]
    ds_read_b64_tr_b16 a[48:49], v17 offset:16384
    v_mfma_f32_16x16x32_bf16 v[204:207], a[76:79], a[44:47], v[204:207]
    v_mfma_f32_16x16x32_bf16 v[204:207], a[72:75], a[40:43], v[204:207]
    ds_read_b64_tr_b16 a[50:51], v17 offset:17408
    v_mfma_f32_16x16x32_bf16 v[200:203], a[72:75], a[32:35], v[200:203]
    ds_read_b128 a[40:43], v54 offset:10240
    v_mfma_f32_16x16x32_bf16 v[200:203], a[76:79], a[36:39], v[200:203]
    ds_read_b64_tr_b16 a[52:53], v17 offset:24576
    v_mfma_f32_16x16x32_bf16 v[176:179], a[68:71], a[36:39], v[176:179]
    buffer_load_dwordx4 v13, s[32:35], s71 offen offset:2048 lds
    v_mfma_f32_16x16x32_bf16 v[176:179], a[64:67], a[32:35], v[176:179]
    ds_read_b64_tr_b16 a[54:55], v17 offset:25600
    v_mfma_f32_16x16x32_bf16 v[172:175], a[64:67], a[24:27], v[172:175]
    ds_read_b128 a[44:47], v55 offset:10240
    v_mfma_f32_16x16x32_bf16 v[172:175], a[68:71], a[28:31], v[172:175]
    ds_read_b64_tr_b16 a[56:57], v18 offset:16384
    v_mfma_f32_16x16x32_bf16 v[196:199], a[76:79], a[28:31], v[196:199]
    ds_read_b128 a[32:35], v54 offset:8192
    v_mfma_f32_16x16x32_bf16 v[196:199], a[72:75], a[24:27], v[196:199]
    ds_read_b64_tr_b16 a[58:59], v18 offset:17408
    v_mfma_f32_16x16x32_bf16 v[192:195], a[72:75], a[16:19], v[192:195]
    buffer_load_dwordx4 v14, s[32:35], s71 offen offset:3072 lds
    v_mfma_f32_16x16x32_bf16 v[192:195], a[76:79], a[20:23], v[192:195]
    ds_read_b64_tr_b16 a[60:61], v18 offset:24576
    v_mfma_f32_16x16x32_bf16 v[168:171], a[68:71], a[20:23], v[168:171]
    ds_read_b128 a[36:39], v55 offset:8192
    v_mfma_f32_16x16x32_bf16 v[168:171], a[64:67], a[16:19], v[168:171]
    ds_read_b64_tr_b16 a[62:63], v18 offset:25600
    v_mfma_f32_16x16x32_bf16 v[164:167], a[64:67], a[8:11], v[164:167]
    s_add_u32 m0, s68, 73728
    ds_read_b128 a[24:27], v54 offset:6144
    v_mfma_f32_16x16x32_bf16 v[164:167], a[68:71], a[12:15], v[164:167]
    s_mov_b32 s71, 1769472
    ds_read_b128 a[28:31], v55 offset:6144
    v_mfma_f32_16x16x32_bf16 v[188:191], a[76:79], a[12:15], v[188:191]
    buffer_load_dwordx4 v11, s[28:31], s71 offen lds
    v_mfma_f32_16x16x32_bf16 v[188:191], a[72:75], a[8:11], v[188:191]
    ds_read_b128 a[16:19], v54 offset:4096
    v_mfma_f32_16x16x32_bf16 v[184:187], a[72:75], a[0:3], v[184:187]
    ds_read_b128 a[20:23], v55 offset:4096
    v_mfma_f32_16x16x32_bf16 v[184:187], a[76:79], a[4:7], v[184:187]
    ds_read_b128 a[8:11], v54 offset:2048
    v_mfma_f32_16x16x32_bf16 v[160:163], a[68:71], a[4:7], v[160:163]
    ds_read_b128 a[12:15], v55 offset:2048
    v_mfma_f32_16x16x32_bf16 v[160:163], a[64:67], a[0:3], v[160:163]
    s_waitcnt lgkmcnt(6)
    v_mfma_f32_16x16x32_bf16 v[132:135], a[48:51], a[40:43], v[132:135]
    ds_read_b128 a[0:3], v54 offset:0
    v_lshrrev_b32 v48, 1, v1
    v_mfma_f32_16x16x32_bf16 v[132:135], a[52:55], a[44:47], v[132:135]
    buffer_load_dwordx4 v12, s[28:31], s71 offen offset:1024 lds
    v_mfma_f32_16x16x32_bf16 v[156:159], a[60:63], a[44:47], v[156:159]
    ds_read_b128 a[4:7], v55 offset:0
    v_lshlrev_b32 v48, 3, v48
    v_mfma_f32_16x16x32_bf16 v[156:159], a[56:59], a[40:43], v[156:159]
    ds_read_b64_tr_b16 a[64:65], v15 offset:16384
    v_mfma_f32_16x16x32_bf16 v[152:155], a[56:59], a[32:35], v[152:155]
    v_and_or_b32 v48, v1, 1, v48
    s_lshl_b32 s63, s60, 16
    v_mfma_f32_16x16x32_bf16 v[152:155], a[60:63], a[36:39], v[152:155]
    ds_read_b64_tr_b16 a[66:67], v15 offset:17408
    s_add_u32 s63, s63, 20480
    v_mfma_f32_16x16x32_bf16 v[128:131], a[52:55], a[36:39], v[128:131]
    buffer_load_dwordx4 v13, s[28:31], s71 offen offset:2048 lds
    v_mfma_f32_16x16x32_bf16 v[128:131], a[48:51], a[32:35], v[128:131]
    ds_read_b64_tr_b16 a[68:69], v15 offset:24576
    s_waitcnt lgkmcnt(9)
    v_mfma_f32_16x16x32_bf16 v[124:127], a[48:51], a[24:27], v[124:127]
    v_lshl_add_u32 v48, v48, 4, s63
    s_cmp_eq_u32 s60, 0
    s_cselect_b32 s83, 1, 0
    v_mfma_f32_16x16x32_bf16 v[124:127], a[52:55], a[28:31], v[124:127]
    ds_read_b64_tr_b16 a[70:71], v15 offset:25600
    buffer_load_dwordx4 v[24:27], v48, s[44:47], 0 offen sc1
    v_mfma_f32_16x16x32_bf16 v[148:151], a[60:63], a[28:31], v[148:151]
    v_mfma_f32_16x16x32_bf16 v[148:151], a[56:59], a[24:27], v[148:151]
    ds_read_b64_tr_b16 a[72:73], v16 offset:16384
    s_waitcnt lgkmcnt(9)
    v_mfma_f32_16x16x32_bf16 v[144:147], a[56:59], a[16:19], v[144:147]
    buffer_load_dwordx4 v14, s[28:31], s71 offen offset:3072 lds
    v_mfma_f32_16x16x32_bf16 v[144:147], a[60:63], a[20:23], v[144:147]
    ds_read_b64_tr_b16 a[74:75], v16 offset:17408
    v_mfma_f32_16x16x32_bf16 v[120:123], a[52:55], a[20:23], v[120:123]
    v_mfma_f32_16x16x32_bf16 v[120:123], a[48:51], a[16:19], v[120:123]
    ds_read_b64_tr_b16 a[76:77], v16 offset:24576
    s_waitcnt lgkmcnt(9)
    v_mfma_f32_16x16x32_bf16 v[116:119], a[48:51], a[8:11], v[116:119]
    v_mfma_f32_16x16x32_bf16 v[116:119], a[52:55], a[12:15], v[116:119]
    ds_read_b64_tr_b16 a[78:79], v16 offset:25600
    v_mfma_f32_16x16x32_bf16 v[140:143], a[60:63], a[12:15], v[140:143]
    v_mfma_f32_16x16x32_bf16 v[140:143], a[56:59], a[8:11], v[140:143]
    s_waitcnt lgkmcnt(8)
    v_mfma_f32_16x16x32_bf16 v[136:139], a[56:59], a[0:3], v[136:139]
    v_mfma_f32_16x16x32_bf16 v[136:139], a[60:63], a[4:7], v[136:139]
    v_mfma_f32_16x16x32_bf16 v[112:115], a[52:55], a[4:7], v[112:115]
    v_mfma_f32_16x16x32_bf16 v[112:115], a[48:51], a[0:3], v[112:115]
    s_waitcnt vmcnt(19) lgkmcnt(0)
    s_barrier
    v_mfma_f32_16x16x32_bf16 v[84:87], a[64:67], a[40:43], v[84:87]
    ds_read_b64_tr_b16 a[48:49], v17 offset:0
    v_mfma_f32_16x16x32_bf16 v[84:87], a[68:71], a[44:47], v[84:87]
    v_mfma_f32_16x16x32_bf16 v[108:111], a[76:79], a[44:47], v[108:111]
    ds_read_b64_tr_b16 a[50:51], v17 offset:1024
    v_mfma_f32_16x16x32_bf16 v[108:111], a[72:75], a[40:43], v[108:111]
    v_mfma_f32_16x16x32_bf16 v[104:107], a[72:75], a[32:35], v[104:107]
    s_add_u32 m0, s67, 106496
    ds_read_b64_tr_b16 a[52:53], v17 offset:8192
    v_mfma_f32_16x16x32_bf16 v[104:107], a[76:79], a[36:39], v[104:107]
    s_mov_b32 s70, 1024
    v_mfma_f32_16x16x32_bf16 v[80:83], a[68:71], a[36:39], v[80:83]
    buffer_load_dwordx4 v5, s[24:27], s70 offen lds
    v_mfma_f32_16x16x32_bf16 v[80:83], a[64:67], a[32:35], v[80:83]
    ds_read_b64_tr_b16 a[54:55], v17 offset:9216
    v_mfma_f32_16x16x32_bf16 v[76:79], a[64:67], a[24:27], v[76:79]
    v_mfma_f32_16x16x32_bf16 v[76:79], a[68:71], a[28:31], v[76:79]
    ds_read_b64_tr_b16 a[56:57], v18 offset:0
    v_mfma_f32_16x16x32_bf16 v[100:103], a[76:79], a[28:31], v[100:103]
    v_mfma_f32_16x16x32_bf16 v[100:103], a[72:75], a[24:27], v[100:103]
    s_add_u32 m0, s67, 110592
    ds_read_b64_tr_b16 a[58:59], v18 offset:1024
    v_mfma_f32_16x16x32_bf16 v[96:99], a[72:75], a[16:19], v[96:99]
    buffer_load_dwordx4 v6, s[24:27], s70 offen lds
    v_mfma_f32_16x16x32_bf16 v[96:99], a[76:79], a[20:23], v[96:99]
    ds_read_b64_tr_b16 a[60:61], v18 offset:8192
    v_mfma_f32_16x16x32_bf16 v[72:75], a[68:71], a[20:23], v[72:75]
    v_mfma_f32_16x16x32_bf16 v[72:75], a[64:67], a[16:19], v[72:75]
    ds_read_b64_tr_b16 a[62:63], v18 offset:9216
    v_mfma_f32_16x16x32_bf16 v[68:71], a[64:67], a[8:11], v[68:71]
    v_mfma_f32_16x16x32_bf16 v[68:71], a[68:71], a[12:15], v[68:71]
    s_add_u32 m0, s67, 114688
    v_mfma_f32_16x16x32_bf16 v[92:95], a[76:79], a[12:15], v[92:95]
    buffer_load_dwordx4 v7, s[24:27], s70 offen lds
    v_mfma_f32_16x16x32_bf16 v[92:95], a[72:75], a[8:11], v[92:95]
    v_mfma_f32_16x16x32_bf16 v[88:91], a[72:75], a[0:3], v[88:91]
    v_mfma_f32_16x16x32_bf16 v[88:91], a[76:79], a[4:7], v[88:91]
    v_mfma_f32_16x16x32_bf16 v[64:67], a[68:71], a[4:7], v[64:67]
    v_mfma_f32_16x16x32_bf16 v[64:67], a[64:67], a[0:3], v[64:67]
    s_waitcnt lgkmcnt(0)
    v_mfma_f32_16x16x32_bf16 v[228:231], a[48:51], a[40:43], v[228:231]
    s_add_u32 m0, s67, 118784
    ds_read_b64_tr_b16 a[64:65], v15 offset:0
    v_mfma_f32_16x16x32_bf16 v[228:231], a[52:55], a[44:47], v[228:231]
    buffer_load_dwordx4 v8, s[24:27], s70 offen lds
    v_mfma_f32_16x16x32_bf16 v[252:255], a[60:63], a[44:47], v[252:255]
    ds_read_b64_tr_b16 a[66:67], v15 offset:1024
    v_mfma_f32_16x16x32_bf16 v[252:255], a[56:59], a[40:43], v[252:255]
    s_add_u32 m0, s67, 122880
    v_mfma_f32_16x16x32_bf16 v[248:251], a[56:59], a[32:35], v[248:251]
    buffer_load_dwordx4 v9, s[24:27], s70 offen lds
    v_mfma_f32_16x16x32_bf16 v[248:251], a[60:63], a[36:39], v[248:251]
    ds_read_b64_tr_b16 a[68:69], v15 offset:8192
    v_mfma_f32_16x16x32_bf16 v[224:227], a[52:55], a[36:39], v[224:227]
    v_mfma_f32_16x16x32_bf16 v[224:227], a[48:51], a[32:35], v[224:227]
    s_add_u32 m0, s67, 126976
    ds_read_b64_tr_b16 a[70:71], v15 offset:9216
    v_mfma_f32_16x16x32_bf16 v[220:223], a[48:51], a[24:27], v[220:223]
    s_mov_b64 exec, s[72:73]
    buffer_load_dwordx4 v10, s[24:27], s70 offen lds
    s_mov_b64 exec, -1
    v_mfma_f32_16x16x32_bf16 v[220:223], a[52:55], a[28:31], v[220:223]
    ds_read_b64_tr_b16 a[72:73], v16 offset:0
    v_mfma_f32_16x16x32_bf16 v[244:247], a[60:63], a[28:31], v[244:247]
    s_waitcnt vmcnt(7)
    v_and_b32 v24, v24, v25
    v_mfma_f32_16x16x32_bf16 v[244:247], a[56:59], a[24:27], v[244:247]
    s_add_u32 m0, s68, 57344
    ds_read_b64_tr_b16 a[74:75], v16 offset:1024
    v_and_b32 v26, v26, v27
    v_mfma_f32_16x16x32_bf16 v[240:243], a[56:59], a[16:19], v[240:243]
    buffer_load_dwordx4 v11, s[32:35], s71 offen lds
    v_mfma_f32_16x16x32_bf16 v[240:243], a[60:63], a[20:23], v[240:243]
    ds_read_b64_tr_b16 a[76:77], v16 offset:8192
    v_and_b32 v24, v24, v26
    v_mfma_f32_16x16x32_bf16 v[216:219], a[52:55], a[20:23], v[216:219]
    v_cmp_ne_u32 vcc, s83, v24
    v_mfma_f32_16x16x32_bf16 v[216:219], a[48:51], a[16:19], v[216:219]
    ds_read_b64_tr_b16 a[78:79], v16 offset:9216
    v_mfma_f32_16x16x32_bf16 v[212:215], a[48:51], a[8:11], v[212:215]
    buffer_load_dwordx4 v12, s[32:35], s71 offen offset:1024 lds
    v_mfma_f32_16x16x32_bf16 v[212:215], a[52:55], a[12:15], v[212:215]
    s_nop 0
    s_cbranch_vccnz L_spin_glue
L_back_glue:
    v_mfma_f32_16x16x32_bf16 v[236:239], a[60:63], a[12:15], v[236:239]
    s_mul_i32 s63, s61, 188
    s_lshr_b32 s64, s60, 1
    s_mul_i32 s64, s64, 96
    v_mfma_f32_16x16x32_bf16 v[236:239], a[56:59], a[8:11], v[236:239]
    s_add_u32 s65, s63, 188
    s_min_u32 s65, s65, 2048
    s_add_u32 s63, s63, s64
    v_mfma_f32_16x16x32_bf16 v[232:235], a[56:59], a[0:3], v[232:235]
    buffer_load_dwordx4 v13, s[32:35], s71 offen offset:2048 lds
    v_mfma_f32_16x16x32_bf16 v[232:235], a[60:63], a[4:7], v[232:235]
    s_and_b32 s64, s60, 1
    s_add_u32 s64, s64, s62
    s_cmp_eq_u32 s64, 14
    s_cselect_b32 s65, 0, s65
    v_mfma_f32_16x16x32_bf16 v[208:211], a[52:55], a[4:7], v[208:211]
    s_mov_b32 s64, 303104
    v_and_b32 v52, 48, v0
    v_mov_b32 v53, 2147418112
    v_mfma_f32_16x16x32_bf16 v[208:211], a[48:51], a[0:3], v[208:211]
    s_waitcnt lgkmcnt(0)
    s_barrier
    v_mfma_f32_16x16x32_bf16 v[180:183], a[64:67], a[40:43], v[180:183]
    buffer_load_dwordx4 v14, s[32:35], s71 offen offset:3072 lds
    v_mfma_f32_16x16x32_bf16 v[180:183], a[68:71], a[44:47], v[180:183]
    ds_read_b64_tr_b16 a[48:49], v62 offset:0
    v_and_b32 v48, 15, v0
    v_mfma_f32_16x16x32_bf16 v[204:207], a[76:79], a[44:47], v[204:207]
    s_add_u32 m0, s68, 40960
    v_add_u32 v48, s63, v48
    v_cmp_gt_u32 vcc, s65, v48
    v_mfma_f32_16x16x32_bf16 v[204:207], a[72:75], a[40:43], v[204:207]
    s_mov_b32 s71, 1990656
    ds_read_b64_tr_b16 a[50:51], v62 offset:1024
    v_lshrrev_b32 v49, 6, v48
    v_mfma_f32_16x16x32_bf16 v[200:203], a[72:75], a[32:35], v[200:203]
    buffer_load_dwordx4 v11, s[28:31], s71 offen lds
    v_mfma_f32_16x16x32_bf16 v[200:203], a[76:79], a[36:39], v[200:203]
    ds_read_b64_tr_b16 a[52:53], v62 offset:8192
    v_mul_lo_u32 v49, v49, s64
    v_mfma_f32_16x16x32_bf16 v[176:179], a[68:71], a[36:39], v[176:179]
    ds_read_b128 a[40:43], v56 offset:10240
    v_bfe_u32 v50, v48, 4, 2
    v_mfma_f32_16x16x32_bf16 v[176:179], a[64:67], a[32:35], v[176:179]
    ds_read_b64_tr_b16 a[54:55], v62 offset:9216
    v_lshl_add_u32 v49, v50, 10, v49
    v_mfma_f32_16x16x32_bf16 v[172:175], a[64:67], a[24:27], v[172:175]
    buffer_load_dwordx4 v12, s[28:31], s71 offen offset:1024 lds
    v_mfma_f32_16x16x32_bf16 v[172:175], a[68:71], a[28:31], v[172:175]
    ds_read_b64_tr_b16 a[56:57], v63 offset:0
    v_and_or_b32 v50, v48, 15, v52
    v_mfma_f32_16x16x32_bf16 v[196:199], a[76:79], a[28:31], v[196:199]
    ds_read_b128 a[44:47], v57 offset:10240
    v_lshl_add_u32 v49, v50, 4, v49
    v_mfma_f32_16x16x32_bf16 v[196:199], a[72:75], a[24:27], v[196:199]
    ds_read_b64_tr_b16 a[58:59], v63 offset:1024
    v_cndmask_b32 v28, v53, v49, vcc
    v_mfma_f32_16x16x32_bf16 v[192:195], a[72:75], a[16:19], v[192:195]
    buffer_load_dwordx4 v13, s[28:31], s71 offen offset:2048 lds
    v_mfma_f32_16x16x32_bf16 v[192:195], a[76:79], a[20:23], v[192:195]
    ds_read_b64_tr_b16 a[60:61], v63 offset:8192
    v_min_u32 v49, 2047, v48
    v_mfma_f32_16x16x32_bf16 v[168:171], a[68:71], a[20:23], v[168:171]
    ds_read_b128 a[32:35], v56 offset:8192
    v_lshlrev_b32 v24, 2, v49
    v_mfma_f32_16x16x32_bf16 v[168:171], a[64:67], a[16:19], v[168:171]
    ds_read_b64_tr_b16 a[62:63], v63 offset:9216
    v_add_u32 v48, 16, v48
    v_mfma_f32_16x16x32_bf16 v[164:167], a[64:67], a[8:11], v[164:167]
    buffer_load_dwordx4 v14, s[28:31], s71 offen offset:3072 lds
    v_mfma_f32_16x16x32_bf16 v[164:167], a[68:71], a[12:15], v[164:167]
    ds_read_b128 a[36:39], v57 offset:8192
    v_cmp_gt_u32 vcc, s65, v48
    v_mfma_f32_16x16x32_bf16 v[188:191], a[76:79], a[12:15], v[188:191]
    s_add_u32 m0, s67, 131072
    ds_read_b128 a[24:27], v56 offset:6144
    v_lshrrev_b32 v49, 6, v48
    v_mfma_f32_16x16x32_bf16 v[188:191], a[72:75], a[8:11], v[188:191]
    s_add_u32 s86, s88, 69632
    ds_read_b128 a[28:31], v57 offset:6144
    v_mul_lo_u32 v49, v49, s64
    v_mfma_f32_16x16x32_bf16 v[184:187], a[72:75], a[0:3], v[184:187]
    buffer_load_dwordx4 v3, s[40:43], s86 offen sc1 lds
    v_mfma_f32_16x16x32_bf16 v[184:187], a[76:79], a[4:7], v[184:187]
    ds_read_b128 a[16:19], v56 offset:4096
    v_bfe_u32 v50, v48, 4, 2
    v_mfma_f32_16x16x32_bf16 v[160:163], a[68:71], a[4:7], v[160:163]
    ds_read_b128 a[20:23], v57 offset:4096
    v_lshl_add_u32 v49, v50, 10, v49
    v_mfma_f32_16x16x32_bf16 v[160:163], a[64:67], a[0:3], v[160:163]
    s_add_u32 m0, s67, 135168
    ds_read_b128 a[8:11], v56 offset:2048
    s_waitcnt lgkmcnt(6)
    v_mfma_f32_16x16x32_bf16 v[132:135], a[48:51], a[40:43], v[132:135]
    s_add_u32 s86, s88, 73728
    ds_read_b128 a[12:15], v57 offset:2048
    v_and_or_b32 v50, v48, 15, v52
    v_mfma_f32_16x16x32_bf16 v[132:135], a[52:55], a[44:47], v[132:135]
    buffer_load_dwordx4 v3, s[40:43], s86 offen sc1 lds
    v_mfma_f32_16x16x32_bf16 v[156:159], a[60:63], a[44:47], v[156:159]
    s_add_u32 m0, s67, 139264
    ds_read_b128 a[0:3], v56 offset:0
    v_lshl_add_u32 v49, v50, 4, v49
    v_mfma_f32_16x16x32_bf16 v[156:159], a[56:59], a[40:43], v[156:159]
    s_add_u32 s86, s88, 77824
    ds_read_b128 a[4:7], v57 offset:0
    s_waitcnt lgkmcnt(8)
    v_mfma_f32_16x16x32_bf16 v[152:155], a[56:59], a[32:35], v[152:155]
    buffer_load_dwordx4 v3, s[40:43], s86 offen sc1 lds
    v_mfma_f32_16x16x32_bf16 v[152:155], a[60:63], a[36:39], v[152:155]
    ds_read_b64_tr_b16 a[64:65], v60 offset:0
    v_cndmask_b32 v29, v53, v49, vcc
    v_mfma_f32_16x16x32_bf16 v[128:131], a[52:55], a[36:39], v[128:131]
    s_add_u32 m0, s67, 143360
    ds_read_b64_tr_b16 a[66:67], v60 offset:1024
    v_min_u32 v49, 2047, v48
    v_mfma_f32_16x16x32_bf16 v[128:131], a[48:51], a[32:35], v[128:131]
    s_add_u32 s86, s88, 81920
    ds_read_b64_tr_b16 a[68:69], v60 offset:8192
    s_waitcnt lgkmcnt(9)
    v_mfma_f32_16x16x32_bf16 v[124:127], a[48:51], a[24:27], v[124:127]
    buffer_load_dwordx4 v3, s[40:43], s86 offen sc1 lds
    v_mfma_f32_16x16x32_bf16 v[124:127], a[52:55], a[28:31], v[124:127]
    ds_read_b64_tr_b16 a[70:71], v60 offset:9216
    v_lshlrev_b32 v25, 2, v49
    v_mfma_f32_16x16x32_bf16 v[148:151], a[60:63], a[28:31], v[148:151]
    s_add_u32 m0, s67, 147456
    v_add_u32 v48, 16, v48
    v_cmp_gt_u32 vcc, s65, v48
    v_mfma_f32_16x16x32_bf16 v[148:151], a[56:59], a[24:27], v[148:151]
    s_add_u32 s86, s88, 86016
    ds_read_b64_tr_b16 a[72:73], v61 offset:0
    s_waitcnt lgkmcnt(9)
    v_mfma_f32_16x16x32_bf16 v[144:147], a[56:59], a[16:19], v[144:147]
    buffer_load_dwordx4 v3, s[40:43], s86 offen sc1 lds
    v_mfma_f32_16x16x32_bf16 v[144:147], a[60:63], a[20:23], v[144:147]
    ds_read_b64_tr_b16 a[74:75], v61 offset:1024
    v_lshrrev_b32 v49, 6, v48
    v_mfma_f32_16x16x32_bf16 v[120:123], a[52:55], a[20:23], v[120:123]
    s_add_u32 m0, s67, 151552
    v_mul_lo_u32 v49, v49, s64
    v_bfe_u32 v50, v48, 4, 2
L_pg2:
    s_cbranch_execz L_ret
    v_mfma_f32_16x16x32_bf16 v[120:123], a[48:51], a[16:19], v[120:123]
    s_add_u32 s86, s88, 90112
    ds_read_b64_tr_b16 a[76:77], v61 offset:8192
    s_waitcnt lgkmcnt(9)
    v_mfma_f32_16x16x32_bf16 v[116:119], a[48:51], a[8:11], v[116:119]
    buffer_load_dwordx4 v3, s[40:43], s86 offen sc1 lds
    v_mfma_f32_16x16x32_bf16 v[116:119], a[52:55], a[12:15], v[116:119]
    ds_read_b64_tr_b16 a[78:79], v61 offset:9216
    v_lshl_add_u32 v49, v50, 10, v49
    v_mfma_f32_16x16x32_bf16 v[140:143], a[60:63], a[12:15], v[140:143]
    s_add_u32 m0, s67, 155648
    v_and_or_b32 v50, v48, 15, v52
    v_lshl_add_u32 v49, v50, 4, v49
    v_mfma_f32_16x16x32_bf16 v[140:143], a[56:59], a[8:11], v[140:143]
    s_add_u32 s86, s88, 94208
    v_cndmask_b32 v30, v53, v49, vcc
    s_waitcnt lgkmcnt(8)
    v_mfma_f32_16x16x32_bf16 v[136:139], a[56:59], a[0:3], v[136:139]
    buffer_load_dwordx4 v3, s[40:43], s86 offen sc1 lds
    v_mfma_f32_16x16x32_bf16 v[136:139], a[60:63], a[4:7], v[136:139]
    v_min_u32 v49, 2047, v48
    v_lshlrev_b32 v26, 2, v49
    v_mfma_f32_16x16x32_bf16 v[112:115], a[52:55], a[4:7], v[112:115]
    s_add_u32 m0, s67, 159744
    v_add_u32 v48, 16, v48
    v_cmp_gt_u32 vcc, s65, v48
    v_mfma_f32_16x16x32_bf16 v[112:115], a[48:51], a[0:3], v[112:115]
    s_add_u32 s86, s88, 98304
    s_waitcnt lgkmcnt(0)
    s_barrier
    v_mfma_f32_16x16x32_bf16 v[84:87], a[64:67], a[40:43], v[84:87]
    buffer_load_dwordx4 v3, s[40:43], s86 offen sc1 lds
    v_mfma_f32_16x16x32_bf16 v[84:87], a[68:71], a[44:47], v[84:87]
    ds_read_b64_tr_b16 a[48:49], v17 offset:49152
    v_lshrrev_b32 v49, 6, v48
    v_mfma_f32_16x16x32_bf16 v[108:111], a[76:79], a[44:47], v[108:111]
    s_add_u32 m0, s67, 0
    v_mul_lo_u32 v49, v49, s64
    v_bfe_u32 v50, v48, 4, 2
    v_mfma_f32_16x16x32_bf16 v[108:111], a[72:75], a[40:43], v[108:111]
    s_mov_b32 s70, 1152
    ds_read_b64_tr_b16 a[50:51], v17 offset:50176
    v_lshl_add_u32 v49, v50, 10, v49
    v_mfma_f32_16x16x32_bf16 v[104:107], a[72:75], a[32:35], v[104:107]
    buffer_load_dwordx4 v5, s[24:27], s70 offen lds
    v_mfma_f32_16x16x32_bf16 v[104:107], a[76:79], a[36:39], v[104:107]
    ds_read_b64_tr_b16 a[52:53], v17 offset:57344
    v_and_or_b32 v50, v48, 15, v52
    v_mfma_f32_16x16x32_bf16 v[80:83], a[68:71], a[36:39], v[80:83]
    v_lshl_add_u32 v49, v50, 4, v49
    v_cndmask_b32 v31, v53, v49, vcc
    v_mfma_f32_16x16x32_bf16 v[80:83], a[64:67], a[32:35], v[80:83]
    s_add_u32 m0, s67, 4096
    ds_read_b64_tr_b16 a[54:55], v17 offset:58368
    v_min_u32 v49, 2047, v48
    v_mfma_f32_16x16x32_bf16 v[76:79], a[64:67], a[24:27], v[76:79]
    buffer_load_dwordx4 v6, s[24:27], s70 offen lds
    v_mfma_f32_16x16x32_bf16 v[76:79], a[68:71], a[28:31], v[76:79]
    ds_read_b64_tr_b16 a[56:57], v18 offset:49152
    v_lshlrev_b32 v27, 2, v49
    v_mfma_f32_16x16x32_bf16 v[100:103], a[76:79], a[28:31], v[100:103]
    v_add_u32 v48, 16, v48
    v_cmp_gt_u32 vcc, s65, v48
    v_mfma_f32_16x16x32_bf16 v[100:103], a[72:75], a[24:27], v[100:103]
    s_add_u32 m0, s67, 8192
    ds_read_b64_tr_b16 a[58:59], v18 offset:50176
    v_lshrrev_b32 v49, 6, v48
    v_mfma_f32_16x16x32_bf16 v[96:99], a[72:75], a[16:19], v[96:99]
    buffer_load_dwordx4 v7, s[24:27], s70 offen lds
    v_mfma_f32_16x16x32_bf16 v[96:99], a[76:79], a[20:23], v[96:99]
    ds_read_b64_tr_b16 a[60:61], v18 offset:57344
    v_mul_lo_u32 v49, v49, s64
    v_mfma_f32_16x16x32_bf16 v[72:75], a[68:71], a[20:23], v[72:75]
    v_bfe_u32 v50, v48, 4, 2
    v_lshl_add_u32 v49, v50, 10, v49
    v_mfma_f32_16x16x32_bf16 v[72:75], a[64:67], a[16:19], v[72:75]
    s_add_u32 m0, s67, 12288
    ds_read_b64_tr_b16 a[62:63], v18 offset:58368
    v_and_or_b32 v50, v48, 15, v52
    v_mfma_f32_16x16x32_bf16 v[68:71], a[64:67], a[8:11], v[68:71]
    buffer_load_dwordx4 v8, s[24:27], s70 offen lds
    v_mfma_f32_16x16x32_bf16 v[68:71], a[68:71], a[12:15], v[68:71]
    v_lshl_add_u32 v49, v50, 4, v49
    v_cndmask_b32 v32, v53, v49, vcc
    v_mfma_f32_16x16x32_bf16 v[92:95], a[76:79], a[12:15], v[92:95]
    v_min_u32 v49, 2047, v48
    v_lshlrev_b32 v34, 2, v49
    v_mfma_f32_16x16x32_bf16 v[92:95], a[72:75], a[8:11], v[92:95]
    s_add_u32 m0, s67, 16384
    v_add_u32 v48, 16, v48
    v_cmp_gt_u32 vcc, s65, v48
    v_mfma_f32_16x16x32_bf16 v[88:91], a[72:75], a[0:3], v[88:91]
    buffer_load_dwordx4 v9, s[24:27], s70 offen lds
    v_mfma_f32_16x16x32_bf16 v[88:91], a[76:79], a[4:7], v[88:91]
    v_lshrrev_b32 v49, 6, v48
    v_mul_lo_u32 v49, v49, s64
    v_mfma_f32_16x16x32_bf16 v[64:67], a[68:71], a[4:7], v[64:67]
    v_bfe_u32 v50, v48, 4, 2
    v_lshl_add_u32 v49, v50, 10, v49
    v_mfma_f32_16x16x32_bf16 v[64:67], a[64:67], a[0:3], v[64:67]
    v_and_or_b32 v50, v48, 15, v52
    s_waitcnt lgkmcnt(0)
    v_mfma_f32_16x16x32_bf16 v[228:231], a[48:51], a[40:43], v[228:231]
    s_add_u32 m0, s67, 20480
    ds_read_b64_tr_b16 a[64:65], v15 offset:49152
    v_lshl_add_u32 v49, v50, 4, v49
    v_mfma_f32_16x16x32_bf16 v[228:231], a[52:55], a[44:47], v[228:231]
    s_mov_b64 exec, s[72:73]
    buffer_load_dwordx4 v10, s[24:27], s70 offen lds
    s_mov_b64 exec, -1
    v_mfma_f32_16x16x32_bf16 v[252:255], a[60:63], a[44:47], v[252:255]
    ds_read_b64_tr_b16 a[66:67], v15 offset:50176
    v_cndmask_b32 v33, v53, v49, vcc
    v_mfma_f32_16x16x32_bf16 v[252:255], a[56:59], a[40:43], v[252:255]
    s_add_u32 m0, s68, 24576
    v_min_u32 v49, 2047, v48
    v_lshlrev_b32 v35, 2, v49
    v_mfma_f32_16x16x32_bf16 v[248:251], a[56:59], a[32:35], v[248:251]
    buffer_load_dwordx4 v11, s[32:35], s71 offen lds
    v_mfma_f32_16x16x32_bf16 v[248:251], a[60:63], a[36:39], v[248:251]
    ds_read_b64_tr_b16 a[68:69], v15 offset:57344
    v_mfma_f32_16x16x32_bf16 v[224:227], a[52:55], a[36:39], v[224:227]
    v_mfma_f32_16x16x32_bf16 v[224:227], a[48:51], a[32:35], v[224:227]
    ds_read_b64_tr_b16 a[70:71], v15 offset:58368
    v_mfma_f32_16x16x32_bf16 v[220:223], a[48:51], a[24:27], v[220:223]
    buffer_load_dwordx4 v12, s[32:35], s71 offen offset:1024 lds
    v_mfma_f32_16x16x32_bf16 v[220:223], a[52:55], a[28:31], v[220:223]
    ds_read_b64_tr_b16 a[72:73], v16 offset:49152
    v_mfma_f32_16x16x32_bf16 v[244:247], a[60:63], a[28:31], v[244:247]
    v_mfma_f32_16x16x32_bf16 v[244:247], a[56:59], a[24:27], v[244:247]
    ds_read_b64_tr_b16 a[74:75], v16 offset:50176
    v_mfma_f32_16x16x32_bf16 v[240:243], a[56:59], a[16:19], v[240:243]
    buffer_load_dwordx4 v13, s[32:35], s71 offen offset:2048 lds
    v_mfma_f32_16x16x32_bf16 v[240:243], a[60:63], a[20:23], v[240:243]
    ds_read_b64_tr_b16 a[76:77], v16 offset:57344
    v_mfma_f32_16x16x32_bf16 v[216:219], a[52:55], a[20:23], v[216:219]
    v_mfma_f32_16x16x32_bf16 v[216:219], a[48:51], a[16:19], v[216:219]
    ds_read_b64_tr_b16 a[78:79], v16 offset:58368
    v_mfma_f32_16x16x32_bf16 v[212:215], a[48:51], a[8:11], v[212:215]
    buffer_load_dwordx4 v14, s[32:35], s71 offen offset:3072 lds
    v_mfma_f32_16x16x32_bf16 v[212:215], a[52:55], a[12:15], v[212:215]
    v_mfma_f32_16x16x32_bf16 v[236:239], a[60:63], a[12:15], v[236:239]
    v_mfma_f32_16x16x32_bf16 v[236:239], a[56:59], a[8:11], v[236:239]
    v_mfma_f32_16x16x32_bf16 v[232:235], a[56:59], a[0:3], v[232:235]
    buffer_load_dword v24, v24, s[44:47], 0 offen sc1
    v_mfma_f32_16x16x32_bf16 v[232:235], a[60:63], a[4:7], v[232:235]
    v_mfma_f32_16x16x32_bf16 v[208:211], a[52:55], a[4:7], v[208:211]
    v_mfma_f32_16x16x32_bf16 v[208:211], a[48:51], a[0:3], v[208:211]
    s_waitcnt vmcnt(27) lgkmcnt(0)
    s_barrier
    v_mfma_f32_16x16x32_bf16 v[180:183], a[64:67], a[40:43], v[180:183]
    buffer_load_dword v25, v25, s[44:47], 0 offen sc1
    v_mfma_f32_16x16x32_bf16 v[180:183], a[68:71], a[44:47], v[180:183]
    ds_read_b64_tr_b16 a[48:49], v17 offset:32768
    v_mfma_f32_16x16x32_bf16 v[204:207], a[76:79], a[44:47], v[204:207]
    s_add_u32 m0, s67, 90112
    v_mfma_f32_16x16x32_bf16 v[204:207], a[72:75], a[40:43], v[204:207]
    s_add_u32 s86, s88, 28672
    ds_read_b64_tr_b16 a[50:51], v17 offset:33792
    v_mfma_f32_16x16x32_bf16 v[200:203], a[72:75], a[32:35], v[200:203]
    buffer_load_dwordx4 v3, s[40:43], s86 offen sc1 lds
    v_mfma_f32_16x16x32_bf16 v[200:203], a[76:79], a[36:39], v[200:203]
    ds_read_b64_tr_b16 a[52:53], v17 offset:40960
    v_mfma_f32_16x16x32_bf16 v[176:179], a[68:71], a[36:39], v[176:179]
    s_add_u32 m0, s67, 94208
    ds_read_b128 a[40:43], v54 offset:10240
    v_mfma_f32_16x16x32_bf16 v[176:179], a[64:67], a[32:35], v[176:179]
    s_add_u32 s86, s88, 32768
    ds_read_b64_tr_b16 a[54:55], v17 offset:41984
    v_mfma_f32_16x16x32_bf16 v[172:175], a[64:67], a[24:27], v[172:175]
    buffer_load_dwordx4 v3, s[40:43], s86 offen sc1 lds
    v_mfma_f32_16x16x32_bf16 v[172:175], a[68:71], a[28:31], v[172:175]
    ds_read_b64_tr_b16 a[56:57], v18 offset:32768
    v_mfma_f32_16x16x32_bf16 v[196:199], a[76:79], a[28:31], v[196:199]
    s_add_u32 m0, s67, 98304
    ds_read_b128 a[44:47], v55 offset:10240
    v_mfma_f32_16x16x32_bf16 v[196:199], a[72:75], a[24:27], v[196:199]
    s_add_u32 s86, s88, 36864
    ds_read_b64_tr_b16 a[58:59], v18 offset:33792
    v_mfma_f32_16x16x32_bf16 v[192:195], a[72:75], a[16:19], v[192:195]
    buffer_load_dwordx4 v3, s[40:43], s86 offen sc1 lds
    v_mfma_f32_16x16x32_bf16 v[192:195], a[76:79], a[20:23], v[192:195]
    ds_read_b64_tr_b16 a[60:61], v18 offset:40960
    v_mfma_f32_16x16x32_bf16 v[168:171], a[68:71], a[20:23], v[168:171]
    s_add_u32 m0, s67, 102400
    ds_read_b128 a[32:35], v54 offset:8192
    v_mfma_f32_16x16x32_bf16 v[168:171], a[64:67], a[16:19], v[168:171]
    s_add_u32 s86, s88, 40960
    ds_read_b64_tr_b16 a[62:63], v18 offset:41984
    v_mfma_f32_16x16x32_bf16 v[164:167], a[64:67], a[8:11], v[164:167]
    buffer_load_dwordx4 v3, s[40:43], s86 offen sc1 lds
    v_mfma_f32_16x16x32_bf16 v[164:167], a[68:71], a[12:15], v[164:167]
    ds_read_b128 a[36:39], v55 offset:8192
    v_mfma_f32_16x16x32_bf16 v[188:191], a[76:79], a[12:15], v[188:191]
    ds_read_b128 a[24:27], v54 offset:6144
    v_mfma_f32_16x16x32_bf16 v[188:191], a[72:75], a[8:11], v[188:191]
    s_add_u32 s86, s87, 0
    ds_read_b128 a[28:31], v55 offset:6144
    v_mfma_f32_16x16x32_bf16 v[184:187], a[72:75], a[0:3], v[184:187]
    buffer_load_dwordx4 a[88:91], v3, s[40:43], s86 offen sc1
    v_mfma_f32_16x16x32_bf16 v[184:187], a[76:79], a[4:7], v[184:187]
    ds_read_b128 a[16:19], v54 offset:4096
    v_mfma_f32_16x16x32_bf16 v[160:163], a[68:71], a[4:7], v[160:163]
    ds_read_b128 a[20:23], v55 offset:4096
    v_mfma_f32_16x16x32_bf16 v[160:163], a[64:67], a[0:3], v[160:163]
    ds_read_b128 a[8:11], v54 offset:2048
    s_waitcnt lgkmcnt(6)
    v_mfma_f32_16x16x32_bf16 v[132:135], a[48:51], a[40:43], v[132:135]
    ds_read_b128 a[12:15], v55 offset:2048
    v_mfma_f32_16x16x32_bf16 v[132:135], a[52:55], a[44:47], v[132:135]
    buffer_load_dword v26, v26, s[44:47], 0 offen sc1
    v_mfma_f32_16x16x32_bf16 v[156:159], a[60:63], a[44:47], v[156:159]
    ds_read_b128 a[0:3], v54 offset:0
    v_mfma_f32_16x16x32_bf16 v[156:159], a[56:59], a[40:43], v[156:159]
    ds_read_b128 a[4:7], v55 offset:0
    s_waitcnt lgkmcnt(8)
    v_mfma_f32_16x16x32_bf16 v[152:155], a[56:59], a[32:35], v[152:155]
    buffer_load_dword v27, v27, s[44:47], 0 offen sc1
    v_mfma_f32_16x16x32_bf16 v[152:155], a[60:63], a[36:39], v[152:155]
    ds_read_b64_tr_b16 a[64:65], v15 offset:32768
    v_mfma_f32_16x16x32_bf16 v[128:131], a[52:55], a[36:39], v[128:131]
    ds_read_b64_tr_b16 a[66:67], v15 offset:33792
    v_mfma_f32_16x16x32_bf16 v[128:131], a[48:51], a[32:35], v[128:131]
    ds_read_b64_tr_b16 a[68:69], v15 offset:40960
    s_waitcnt lgkmcnt(9)
    v_mfma_f32_16x16x32_bf16 v[124:127], a[48:51], a[24:27], v[124:127]
    buffer_load_dwordx4 a[92:95], v3, s[40:43], s86 offen offset:1024 sc1
    v_mfma_f32_16x16x32_bf16 v[124:127], a[52:55], a[28:31], v[124:127]
    ds_read_b64_tr_b16 a[70:71], v15 offset:41984
    v_mfma_f32_16x16x32_bf16 v[148:151], a[60:63], a[28:31], v[148:151]
    v_mfma_f32_16x16x32_bf16 v[148:151], a[56:59], a[24:27], v[148:151]
    ds_read_b64_tr_b16 a[72:73], v16 offset:32768
    s_waitcnt lgkmcnt(9)
    v_mfma_f32_16x16x32_bf16 v[144:147], a[56:59], a[16:19], v[144:147]
    buffer_load_dwordx4 a[96:99], v3, s[40:43], s86 offen offset:2048 sc1
    v_mfma_f32_16x16x32_bf16 v[144:147], a[60:63], a[20:23], v[144:147]
    ds_read_b64_tr_b16 a[74:75], v16 offset:33792
    v_mfma_f32_16x16x32_bf16 v[120:123], a[52:55], a[20:23], v[120:123]
    v_mfma_f32_16x16x32_bf16 v[120:123], a[48:51], a[16:19], v[120:123]
    ds_read_b64_tr_b16 a[76:77], v16 offset:40960
    s_waitcnt lgkmcnt(9)
    v_mfma_f32_16x16x32_bf16 v[116:119], a[48:51], a[8:11], v[116:119]
    buffer_load_dwordx4 a[100:103], v3, s[40:43], s86 offen offset:3072 sc1
    v_mfma_f32_16x16x32_bf16 v[116:119], a[52:55], a[12:15], v[116:119]
    ds_read_b64_tr_b16 a[78:79], v16 offset:41984
    v_mfma_f32_16x16x32_bf16 v[140:143], a[60:63], a[12:15], v[140:143]
    v_mfma_f32_16x16x32_bf16 v[140:143], a[56:59], a[8:11], v[140:143]
    s_waitcnt lgkmcnt(8)
    v_mfma_f32_16x16x32_bf16 v[136:139], a[56:59], a[0:3], v[136:139]
    buffer_load_dwordx4 a[104:107], v4, s[40:43], s86 offen sc1
    v_mfma_f32_16x16x32_bf16 v[136:139], a[60:63], a[4:7], v[136:139]
    v_mfma_f32_16x16x32_bf16 v[112:115], a[52:55], a[4:7], v[112:115]
    v_mfma_f32_16x16x32_bf16 v[112:115], a[48:51], a[0:3], v[112:115]
    s_add_u32 s86, s87, 5120
    s_waitcnt vmcnt(35) lgkmcnt(0)
    s_barrier
    v_mfma_f32_16x16x32_bf16 v[84:87], a[64:67], a[40:43], v[84:87]
    buffer_load_dwordx4 a[108:111], v3, s[40:43], s86 offen sc1
    v_mfma_f32_16x16x32_bf16 v[84:87], a[68:71], a[44:47], v[84:87]
    ds_read_b64_tr_b16 a[48:49], v17 offset:16384
    v_mfma_f32_16x16x32_bf16 v[108:111], a[76:79], a[44:47], v[108:111]
    s_add_u32 m0, s67, 73728
    v_mfma_f32_16x16x32_bf16 v[108:111], a[72:75], a[40:43], v[108:111]
    s_add_u32 s86, s88, 12288
    ds_read_b64_tr_b16 a[50:51], v17 offset:17408
    v_mfma_f32_16x16x32_bf16 v[104:107], a[72:75], a[32:35], v[104:107]
    buffer_load_dwordx4 v3, s[40:43], s86 offen sc1 lds
    v_mfma_f32_16x16x32_bf16 v[104:107], a[76:79], a[36:39], v[104:107]
    ds_read_b64_tr_b16 a[52:53], v17 offset:24576
    v_mfma_f32_16x16x32_bf16 v[80:83], a[68:71], a[36:39], v[80:83]
    s_add_u32 m0, s67, 77824
    v_mfma_f32_16x16x32_bf16 v[80:83], a[64:67], a[32:35], v[80:83]
    s_add_u32 s86, s88, 16384
    ds_read_b64_tr_b16 a[54:55], v17 offset:25600
    v_mfma_f32_16x16x32_bf16 v[76:79], a[64:67], a[24:27], v[76:79]
    buffer_load_dwordx4 v3, s[40:43], s86 offen sc1 lds
    v_mfma_f32_16x16x32_bf16 v[76:79], a[68:71], a[28:31], v[76:79]
    ds_read_b64_tr_b16 a[56:57], v18 offset:16384
    v_mfma_f32_16x16x32_bf16 v[100:103], a[76:79], a[28:31], v[100:103]
    s_add_u32 m0, s67, 81920
    v_mfma_f32_16x16x32_bf16 v[100:103], a[72:75], a[24:27], v[100:103]
    s_add_u32 s86, s88, 20480
    ds_read_b64_tr_b16 a[58:59], v18 offset:17408
    v_mfma_f32_16x16x32_bf16 v[96:99], a[72:75], a[16:19], v[96:99]
    buffer_load_dwordx4 v3, s[40:43], s86 offen sc1 lds
    v_mfma_f32_16x16x32_bf16 v[96:99], a[76:79], a[20:23], v[96:99]
    ds_read_b64_tr_b16 a[60:61], v18 offset:24576
    v_mfma_f32_16x16x32_bf16 v[72:75], a[68:71], a[20:23], v[72:75]
    s_add_u32 m0, s67, 86016
    v_mfma_f32_16x16x32_bf16 v[72:75], a[64:67], a[16:19], v[72:75]
    s_add_u32 s86, s88, 24576
    ds_read_b64_tr_b16 a[62:63], v18 offset:25600
    v_mfma_f32_16x16x32_bf16 v[68:71], a[64:67], a[8:11], v[68:71]
    buffer_load_dwordx4 v3, s[40:43], s86 offen sc1 lds
    v_mfma_f32_16x16x32_bf16 v[68:71], a[68:71], a[12:15], v[68:71]
    v_mfma_f32_16x16x32_bf16 v[92:95], a[76:79], a[12:15], v[92:95]
    s_add_u32 m0, s67, 106496
    v_mfma_f32_16x16x32_bf16 v[92:95], a[72:75], a[8:11], v[92:95]
    s_add_u32 s86, s88, 45056
    v_mfma_f32_16x16x32_bf16 v[88:91], a[72:75], a[0:3], v[88:91]
    buffer_load_dwordx4 v3, s[40:43], s86 offen sc1 lds
    v_mfma_f32_16x16x32_bf16 v[88:91], a[76:79], a[4:7], v[88:91]
    v_mfma_f32_16x16x32_bf16 v[64:67], a[68:71], a[4:7], v[64:67]
    v_mfma_f32_16x16x32_bf16 v[64:67], a[64:67], a[0:3], v[64:67]
    s_waitcnt lgkmcnt(0)
    v_mfma_f32_16x16x32_bf16 v[228:231], a[48:51], a[40:43], v[228:231]
    ds_read_b64_tr_b16 a[64:65], v15 offset:16384
    s_and_b32 s63, s60, 1
    v_mfma_f32_16x16x32_bf16 v[228:231], a[52:55], a[44:47], v[228:231]
    buffer_load_dword v34, v34, s[44:47], 0 offen sc1
    v_mfma_f32_16x16x32_bf16 v[252:255], a[60:63], a[44:47], v[252:255]
    ds_read_b64_tr_b16 a[66:67], v15 offset:17408
    s_lshl_b32 s64, s63, 9
    v_mfma_f32_16x16x32_bf16 v[252:255], a[56:59], a[40:43], v[252:255]
    v_and_b32 v6, 48, v0
    v_add_u32 v6, s64, v6
    v_mfma_f32_16x16x32_bf16 v[248:251], a[56:59], a[32:35], v[248:251]
    buffer_load_dword v35, v35, s[44:47], 0 offen sc1
    v_mfma_f32_16x16x32_bf16 v[248:251], a[60:63], a[36:39], v[248:251]
    ds_read_b64_tr_b16 a[68:69], v15 offset:24576
    s_lshl1_add_u32 s63, s62, s63
    v_mfma_f32_16x16x32_bf16 v[224:227], a[52:55], a[36:39], v[224:227]
    s_add_u32 m0, s67, 110592
    s_lshl_b32 s63, s63, 13
    s_add_u32 s63, s63, 81920
    v_mfma_f32_16x16x32_bf16 v[224:227], a[48:51], a[32:35], v[224:227]
    s_add_u32 s86, s88, 49152
    ds_read_b64_tr_b16 a[70:71], v15 offset:25600
    s_add_u32 s64, s63, 4096
    v_mfma_f32_16x16x32_bf16 v[220:223], a[48:51], a[24:27], v[220:223]
    buffer_load_dwordx4 v3, s[40:43], s86 offen sc1 lds
    v_mfma_f32_16x16x32_bf16 v[220:223], a[52:55], a[28:31], v[220:223]
    ds_read_b64_tr_b16 a[72:73], v16 offset:16384
    s_cmp_ge_u32 s60, 2
    s_cselect_b32 s74, 0x80008000, 0
    v_mfma_f32_16x16x32_bf16 v[244:247], a[60:63], a[28:31], v[244:247]
    s_add_u32 m0, s67, 114688
    s_mov_b32 s75, s74
    v_lshlrev_b32 v5, 4, v0
    v_mfma_f32_16x16x32_bf16 v[244:247], a[56:59], a[24:27], v[244:247]
    s_add_u32 s86, s88, 53248
    ds_read_b64_tr_b16 a[74:75], v16 offset:17408
    v_add_u32 v5, 4096, v5
    v_mfma_f32_16x16x32_bf16 v[240:243], a[56:59], a[16:19], v[240:243]
    buffer_load_dwordx4 v3, s[40:43], s86 offen sc1 lds
    v_mfma_f32_16x16x32_bf16 v[240:243], a[60:63], a[20:23], v[240:243]
    ds_read_b64_tr_b16 a[76:77], v16 offset:24576
    v_cndmask_b32 v5, v5, v6, s[74:75]
    v_mfma_f32_16x16x32_bf16 v[216:219], a[52:55], a[20:23], v[216:219]
    s_add_u32 m0, s67, 118784
    v_mfma_f32_16x16x32_bf16 v[216:219], a[48:51], a[16:19], v[216:219]
    s_add_u32 s86, s88, 57344
    ds_read_b64_tr_b16 a[78:79], v16 offset:25600
    v_mfma_f32_16x16x32_bf16 v[212:215], a[48:51], a[8:11], v[212:215]
    buffer_load_dwordx4 v3, s[40:43], s86 offen sc1 lds
    v_mfma_f32_16x16x32_bf16 v[212:215], a[52:55], a[12:15], v[212:215]
    v_mfma_f32_16x16x32_bf16 v[236:239], a[60:63], a[12:15], v[236:239]
    s_add_u32 m0, s67, 122880
    v_mfma_f32_16x16x32_bf16 v[236:239], a[56:59], a[8:11], v[236:239]
    s_add_u32 s86, s88, 61440
    v_mfma_f32_16x16x32_bf16 v[232:235], a[56:59], a[0:3], v[232:235]
    buffer_load_dwordx4 v3, s[40:43], s86 offen sc1 lds
    v_mfma_f32_16x16x32_bf16 v[232:235], a[60:63], a[4:7], v[232:235]
    v_mfma_f32_16x16x32_bf16 v[208:211], a[52:55], a[4:7], v[208:211]
    s_add_u32 m0, s67, 126976
    v_mfma_f32_16x16x32_bf16 v[208:211], a[48:51], a[0:3], v[208:211]
    s_add_u32 s86, s88, 65536
    s_waitcnt vmcnt(25) lgkmcnt(0)
    s_barrier
    v_mfma_f32_16x16x32_bf16 v[180:183], a[64:67], a[40:43], v[180:183]
    buffer_load_dwordx4 v3, s[40:43], s86 offen sc1 lds
    v_mfma_f32_16x16x32_bf16 v[180:183], a[68:71], a[44:47], v[180:183]
    ds_read_b64_tr_b16 a[48:49], v17 offset:0
    v_mfma_f32_16x16x32_bf16 v[204:207], a[76:79], a[44:47], v[204:207]
    v_mfma_f32_16x16x32_bf16 v[204:207], a[72:75], a[40:43], v[204:207]
    s_add_u32 s86, s87, 5120
    ds_read_b64_tr_b16 a[50:51], v17 offset:1024
    v_mfma_f32_16x16x32_bf16 v[200:203], a[72:75], a[32:35], v[200:203]
    buffer_load_dwordx4 a[112:115], v3, s[40:43], s86 offen offset:1024 sc1
    v_mfma_f32_16x16x32_bf16 v[200:203], a[76:79], a[36:39], v[200:203]
    ds_read_b64_tr_b16 a[52:53], v17 offset:8192
    v_mfma_f32_16x16x32_bf16 v[176:179], a[68:71], a[36:39], v[176:179]
    ds_read_b128 a[40:43], v56 offset:10240
    v_mfma_f32_16x16x32_bf16 v[176:179], a[64:67], a[32:35], v[176:179]
    ds_read_b64_tr_b16 a[54:55], v17 offset:9216
    v_mfma_f32_16x16x32_bf16 v[172:175], a[64:67], a[24:27], v[172:175]
    buffer_load_dwordx4 a[116:119], v3, s[40:43], s86 offen offset:2048 sc1
    v_mfma_f32_16x16x32_bf16 v[172:175], a[68:71], a[28:31], v[172:175]
    ds_read_b64_tr_b16 a[56:57], v18 offset:0
    v_mfma_f32_16x16x32_bf16 v[196:199], a[76:79], a[28:31], v[196:199]
    ds_read_b128 a[44:47], v57 offset:10240
    v_mfma_f32_16x16x32_bf16 v[196:199], a[72:75], a[24:27], v[196:199]
    ds_read_b64_tr_b16 a[58:59], v18 offset:1024
    v_mfma_f32_16x16x32_bf16 v[192:195], a[72:75], a[16:19], v[192:195]
    buffer_load_dwordx4 a[120:123], v3, s[40:43], s86 offen offset:3072 sc1
    v_mfma_f32_16x16x32_bf16 v[192:195], a[76:79], a[20:23], v[192:195]
    ds_read_b64_tr_b16 a[60:61], v18 offset:8192
    v_mfma_f32_16x16x32_bf16 v[168:171], a[68:71], a[20:23], v[168:171]
    ds_read_b128 a[32:35], v56 offset:8192
    v_mfma_f32_16x16x32_bf16 v[168:171], a[64:67], a[16:19], v[168:171]
    ds_read_b64_tr_b16 a[62:63], v18 offset:9216
    v_mfma_f32_16x16x32_bf16 v[164:167], a[64:67], a[8:11], v[164:167]
    buffer_load_dwordx4 a[124:127], v4, s[40:43], s86 offen sc1
    v_mfma_f32_16x16x32_bf16 v[164:167], a[68:71], a[12:15], v[164:167]
    ds_read_b128 a[36:39], v57 offset:8192
    v_mfma_f32_16x16x32_bf16 v[188:191], a[76:79], a[12:15], v[188:191]
    ds_read_b128 a[24:27], v56 offset:6144
    v_mfma_f32_16x16x32_bf16 v[188:191], a[72:75], a[8:11], v[188:191]
    s_add_u32 s86, s87, 10240
    ds_read_b128 a[28:31], v57 offset:6144
    v_mfma_f32_16x16x32_bf16 v[184:187], a[72:75], a[0:3], v[184:187]
    buffer_load_dwordx4 a[128:131], v3, s[40:43], s86 offen sc1
    v_mfma_f32_16x16x32_bf16 v[184:187], a[76:79], a[4:7], v[184:187]
    ds_read_b128 a[16:19], v56 offset:4096
    v_mfma_f32_16x16x32_bf16 v[160:163], a[68:71], a[4:7], v[160:163]
    ds_read_b128 a[20:23], v57 offset:4096
    v_mfma_f32_16x16x32_bf16 v[160:163], a[64:67], a[0:3], v[160:163]
    ds_read_b128 a[8:11], v56 offset:2048
    s_waitcnt lgkmcnt(6)
    v_mfma_f32_16x16x32_bf16 v[132:135], a[48:51], a[40:43], v[132:135]
    ds_read_b128 a[12:15], v57 offset:2048
    v_mfma_f32_16x16x32_bf16 v[132:135], a[52:55], a[44:47], v[132:135]
    buffer_load_dwordx4 a[132:135], v3, s[40:43], s86 offen offset:1024 sc1
    v_mfma_f32_16x16x32_bf16 v[156:159], a[60:63], a[44:47], v[156:159]
    ds_read_b128 a[0:3], v56 offset:0
    v_mfma_f32_16x16x32_bf16 v[156:159], a[56:59], a[40:43], v[156:159]
    ds_read_b128 a[4:7], v57 offset:0
    s_waitcnt lgkmcnt(8)
    v_mfma_f32_16x16x32_bf16 v[152:155], a[56:59], a[32:35], v[152:155]
    buffer_load_dwordx4 a[136:139], v3, s[40:43], s86 offen offset:2048 sc1
    v_mfma_f32_16x16x32_bf16 v[152:155], a[60:63], a[36:39], v[152:155]
    ds_read_b64_tr_b16 a[64:65], v62 offset:0
    v_mfma_f32_16x16x32_bf16 v[128:131], a[52:55], a[36:39], v[128:131]
    ds_read_b64_tr_b16 a[66:67], v62 offset:1024
    v_mfma_f32_16x16x32_bf16 v[128:131], a[48:51], a[32:35], v[128:131]
    ds_read_b64_tr_b16 a[68:69], v62 offset:8192
    s_waitcnt lgkmcnt(9)
    v_mfma_f32_16x16x32_bf16 v[124:127], a[48:51], a[24:27], v[124:127]
    buffer_load_dwordx4 a[140:143], v3, s[40:43], s86 offen offset:3072 sc1
    v_mfma_f32_16x16x32_bf16 v[124:127], a[52:55], a[28:31], v[124:127]
    ds_read_b64_tr_b16 a[70:71], v62 offset:9216
    v_mfma_f32_16x16x32_bf16 v[148:151], a[60:63], a[28:31], v[148:151]
    v_mfma_f32_16x16x32_bf16 v[148:151], a[56:59], a[24:27], v[148:151]
    ds_read_b64_tr_b16 a[72:73], v63 offset:0
    s_waitcnt lgkmcnt(9)
    v_mfma_f32_16x16x32_bf16 v[144:147], a[56:59], a[16:19], v[144:147]
    buffer_load_dwordx4 a[144:147], v4, s[40:43], s86 offen sc1
    v_mfma_f32_16x16x32_bf16 v[144:147], a[60:63], a[20:23], v[144:147]
    ds_read_b64_tr_b16 a[74:75], v63 offset:1024
    v_mfma_f32_16x16x32_bf16 v[120:123], a[52:55], a[20:23], v[120:123]
    v_mfma_f32_16x16x32_bf16 v[120:123], a[48:51], a[16:19], v[120:123]
    s_add_u32 s86, s87, 15360
    ds_read_b64_tr_b16 a[76:77], v63 offset:8192
    s_waitcnt lgkmcnt(9)
    v_mfma_f32_16x16x32_bf16 v[116:119], a[48:51], a[8:11], v[116:119]
    buffer_load_dwordx4 a[148:151], v3, s[40:43], s86 offen sc1
    v_mfma_f32_16x16x32_bf16 v[116:119], a[52:55], a[12:15], v[116:119]
    ds_read_b64_tr_b16 a[78:79], v63 offset:9216
    v_mfma_f32_16x16x32_bf16 v[140:143], a[60:63], a[12:15], v[140:143]
    v_mfma_f32_16x16x32_bf16 v[140:143], a[56:59], a[8:11], v[140:143]
    s_waitcnt lgkmcnt(8)
    v_mfma_f32_16x16x32_bf16 v[136:139], a[56:59], a[0:3], v[136:139]
    buffer_load_dwordx4 a[152:155], v3, s[40:43], s86 offen offset:1024 sc1
    v_mfma_f32_16x16x32_bf16 v[136:139], a[60:63], a[4:7], v[136:139]
    v_mfma_f32_16x16x32_bf16 v[112:115], a[52:55], a[4:7], v[112:115]
    v_mfma_f32_16x16x32_bf16 v[112:115], a[48:51], a[0:3], v[112:115]
    s_barrier
    s_waitcnt lgkmcnt(0)
    v_mfma_f32_16x16x32_bf16 v[228:231], a[64:67], a[40:43], v[228:231]
    buffer_load_dwordx4 a[156:159], v3, s[40:43], s86 offen offset:2048 sc1
    v_mfma_f32_16x16x32_bf16 v[228:231], a[68:71], a[44:47], v[228:231]
    ds_write_b128 v5, v[132:135] offset:128
    v_mfma_f32_16x16x32_bf16 v[252:255], a[76:79], a[44:47], v[252:255]
    ds_read_b64_tr_b16 a[48:49], v15 offset:0
    v_mfma_f32_16x16x32_bf16 v[252:255], a[72:75], a[40:43], v[252:255]
    v_mfma_f32_16x16x32_bf16 v[248:251], a[72:75], a[32:35], v[248:251]
    buffer_load_dwordx4 a[160:163], v3, s[40:43], s86 offen offset:3072 sc1
    v_mfma_f32_16x16x32_bf16 v[248:251], a[76:79], a[36:39], v[248:251]
    ds_write_b128 v5, v[156:159] offset:192
    v_mfma_f32_16x16x32_bf16 v[224:227], a[68:71], a[36:39], v[224:227]
    ds_read_b64_tr_b16 a[50:51], v15 offset:1024
    v_mfma_f32_16x16x32_bf16 v[224:227], a[64:67], a[32:35], v[224:227]
    ds_read_b64_tr_b16 a[52:53], v15 offset:8192
    v_mfma_f32_16x16x32_bf16 v[220:223], a[64:67], a[24:27], v[220:223]
    buffer_load_dwordx4 a[164:167], v4, s[40:43], s86 offen sc1
    v_mfma_f32_16x16x32_bf16 v[220:223], a[68:71], a[28:31], v[220:223]
    ds_read_b64_tr_b16 a[54:55], v15 offset:9216
    v_mfma_f32_16x16x32_bf16 v[244:247], a[76:79], a[28:31], v[244:247]
    ds_write_b128 v5, v[228:231] offset:384
    v_mfma_f32_16x16x32_bf16 v[244:247], a[72:75], a[24:27], v[244:247]
    s_add_u32 s86, s87, 20480
    ds_read_b64_tr_b16 a[56:57], v16 offset:0
    v_mfma_f32_16x16x32_bf16 v[240:243], a[72:75], a[16:19], v[240:243]
    buffer_load_dwordx4 a[168:171], v3, s[40:43], s86 offen sc1
    v_mfma_f32_16x16x32_bf16 v[240:243], a[76:79], a[20:23], v[240:243]
    ds_write_b128 v5, v[252:255] offset:448
    v_mfma_f32_16x16x32_bf16 v[216:219], a[68:71], a[20:23], v[216:219]
    ds_read_b64_tr_b16 a[58:59], v16 offset:1024
    ds_read_b64_tr_b16 a[60:61], v16 offset:8192
    v_mfma_f32_16x16x32_bf16 v[216:219], a[64:67], a[16:19], v[216:219]
    s_waitcnt vmcnt(20)
    v_xor_b32 v24, 0x80000000, v24
    v_xor_b32 v25, 0x80000000, v25
    v_mfma_f32_16x16x32_bf16 v[212:215], a[64:67], a[8:11], v[212:215]
    buffer_load_dwordx4 a[172:175], v3, s[40:43], s86 offen offset:1024 sc1
    v_xor_b32 v26, 0x80000000, v26
    v_xor_b32 v27, 0x80000000, v27
    v_mfma_f32_16x16x32_bf16 v[212:215], a[68:71], a[12:15], v[212:215]
    v_xor_b32 v34, 0x80000000, v34
    v_xor_b32 v35, 0x80000000, v35
    ds_read_b64_tr_b16 a[62:63], v16 offset:9216
    v_mfma_f32_16x16x32_bf16 v[236:239], a[76:79], a[12:15], v[236:239]
    v_mfma_f32_16x16x32_bf16 v[236:239], a[72:75], a[8:11], v[236:239]
    s_waitcnt lgkmcnt(3)
    s_barrier
    v_mfma_f32_16x16x32_bf16 v[232:235], a[72:75], a[0:3], v[232:235]
    buffer_load_dwordx4 a[176:179], v3, s[40:43], s86 offen offset:2048 sc1
    ds_read_b128 v[44:47], v6 offset:128
    v_mfma_f32_16x16x32_bf16 v[232:235], a[76:79], a[4:7], v[232:235]
    ds_read_b128 v[16:19], v6 offset:384
    v_mfma_f32_16x16x32_bf16 v[208:211], a[68:71], a[4:7], v[208:211]
    ds_read_b128 v[48:51], v6 offset:192
    v_mfma_f32_16x16x32_bf16 v[208:211], a[64:67], a[0:3], v[208:211]
    ds_read_b128 v[20:23], v6 offset:448
    s_waitcnt lgkmcnt(4)
    v_mfma_f32_16x16x32_bf16 v[84:87], a[48:51], a[40:43], v[84:87]
    ds_read_b64_tr_b16 a[64:65], v60 offset:0
    v_mfma_f32_16x16x32_bf16 v[84:87], a[52:55], a[44:47], v[84:87]
    buffer_load_dwordx4 a[180:183], v3, s[40:43], s86 offen offset:3072 sc1
    v_mfma_f32_16x16x32_bf16 v[108:111], a[60:63], a[44:47], v[108:111]
    ds_read_b64_tr_b16 a[66:67], v60 offset:1024
    v_mfma_f32_16x16x32_bf16 v[108:111], a[56:59], a[40:43], v[108:111]
    v_mfma_f32_16x16x32_bf16 v[104:107], a[56:59], a[32:35], v[104:107]
    s_waitcnt lgkmcnt(4)
    v_fmac_f32 v132, v44, v35
    v_fmac_f32 v133, v45, v35
    v_fmac_f32 v134, v46, v35
    v_fmac_f32 v135, v47, v35
    v_mfma_f32_16x16x32_bf16 v[104:107], a[60:63], a[36:39], v[104:107]
    v_fmac_f32 v228, v16, v35
    v_fmac_f32 v229, v17, v35
    v_fmac_f32 v230, v18, v35
    v_fmac_f32 v231, v19, v35
    ds_read_b64_tr_b16 a[68:69], v60 offset:8192
    v_mfma_f32_16x16x32_bf16 v[80:83], a[52:55], a[36:39], v[80:83]
    buffer_load_dwordx4 a[184:187], v4, s[40:43], s86 offen sc1
L_pg3:
    s_cbranch_execz L_ret
    v_max_f32 v132, 0, v132
    v_max_f32 v133, 0, v133
    v_max_f32 v134, 0, v134
    v_max_f32 v135, 0, v135
    v_mul_f32 v228, v228, v132
    v_mfma_f32_16x16x32_bf16 v[80:83], a[48:51], a[32:35], v[80:83]
    v_mul_f32 v229, v229, v133
    v_mul_f32 v230, v230, v134
    v_mul_f32 v231, v231, v135
    v_cvt_pk_bf16_f32 v132, v228, v229
    ds_read_b64_tr_b16 a[70:71], v60 offset:9216
    v_mfma_f32_16x16x32_bf16 v[76:79], a[48:51], a[24:27], v[76:79]
    v_cvt_pk_bf16_f32 v133, v230, v231
    s_waitcnt lgkmcnt(4)
    v_fmac_f32 v156, v48, v35
    v_fmac_f32 v157, v49, v35
    v_fmac_f32 v158, v50, v35
    v_mfma_f32_16x16x32_bf16 v[76:79], a[52:55], a[28:31], v[76:79]
    v_fmac_f32 v159, v51, v35
    v_fmac_f32 v252, v20, v35
    v_fmac_f32 v253, v21, v35
    v_fmac_f32 v254, v22, v35
    ds_read_b64_tr_b16 a[72:73], v61 offset:0
    v_mfma_f32_16x16x32_bf16 v[100:103], a[60:63], a[28:31], v[100:103]
    v_fmac_f32 v255, v23, v35
    v_max_f32 v156, 0, v156
    v_max_f32 v157, 0, v157
    v_max_f32 v158, 0, v158
    v_max_f32 v159, 0, v159
    v_mfma_f32_16x16x32_bf16 v[100:103], a[56:59], a[24:27], v[100:103]
    s_add_u32 s86, s87, 25600
    v_mul_f32 v252, v252, v156
    v_mul_f32 v253, v253, v157
    v_mul_f32 v254, v254, v158
    v_mul_f32_e64 v255, v255, v159
    ds_read_b64_tr_b16 a[74:75], v61 offset:1024
    v_mfma_f32_16x16x32_bf16 v[96:99], a[56:59], a[16:19], v[96:99]
    buffer_load_dwordx4 a[188:191], v3, s[40:43], s86 offen sc1
    v_cvt_pk_bf16_f32 v134, v252, v253
    v_cvt_pk_bf16_f32 v135, v254, v255
    buffer_store_dwordx4 v[132:135], v33, s[36:39], s64 offen sc1
    v_mfma_f32_16x16x32_bf16 v[96:99], a[60:63], a[20:23], v[96:99]
    ds_write_b128 v5, v[84:87] offset:0
    v_fmac_f32 v128, v44, v34
    v_fmac_f32 v129, v45, v34
    v_fmac_f32 v130, v46, v34
    v_fmac_f32 v131, v47, v34
    v_fmac_f32 v224, v16, v34
    v_mfma_f32_16x16x32_bf16 v[72:75], a[52:55], a[20:23], v[72:75]
    v_fmac_f32 v225, v17, v34
    v_fmac_f32 v226, v18, v34
    v_fmac_f32 v227, v19, v34
    v_max_f32 v128, 0, v128
    ds_read_b64_tr_b16 a[76:77], v61 offset:8192
    v_mfma_f32_16x16x32_bf16 v[72:75], a[48:51], a[16:19], v[72:75]
    v_max_f32 v129, 0, v129
    v_max_f32 v130, 0, v130
    v_max_f32 v131, 0, v131
    v_mul_f32 v224, v224, v128
    v_mul_f32 v225, v225, v129
    v_mfma_f32_16x16x32_bf16 v[68:71], a[48:51], a[8:11], v[68:71]
    v_mul_f32 v226, v226, v130
    v_mul_f32 v227, v227, v131
    v_cvt_pk_bf16_f32 v128, v224, v225
    v_cvt_pk_bf16_f32 v129, v226, v227
    ds_read_b64_tr_b16 a[78:79], v61 offset:9216
    v_mfma_f32_16x16x32_bf16 v[68:71], a[52:55], a[12:15], v[68:71]
    ds_write_b128 v5, v[108:111] offset:64
    v_fmac_f32 v152, v48, v34
    v_fmac_f32 v153, v49, v34
    v_fmac_f32 v154, v50, v34
    v_fmac_f32 v155, v51, v34
    v_mfma_f32_16x16x32_bf16 v[92:95], a[60:63], a[12:15], v[92:95]
    buffer_load_dwordx4 a[192:195], v3, s[40:43], s86 offen offset:1024 sc1
    v_fmac_f32 v248, v20, v34
    v_fmac_f32 v249, v21, v34
    v_fmac_f32 v250, v22, v34
    v_fmac_f32 v251, v23, v34
    v_mfma_f32_16x16x32_bf16 v[92:95], a[56:59], a[8:11], v[92:95]
    v_max_f32 v152, 0, v152
    v_max_f32 v153, 0, v153
    v_max_f32 v154, 0, v154
    v_max_f32 v155, 0, v155
    v_mfma_f32_16x16x32_bf16 v[88:91], a[56:59], a[0:3], v[88:91]
    v_mul_f32 v248, v248, v152
    v_mul_f32 v249, v249, v153
    v_mul_f32 v250, v250, v154
    v_mul_f32 v251, v251, v155
    v_cvt_pk_bf16_f32 v130, v248, v249
    v_mfma_f32_16x16x32_bf16 v[88:91], a[60:63], a[4:7], v[88:91]
    v_cvt_pk_bf16_f32 v131, v250, v251
    buffer_store_dwordx4 v[128:131], v32, s[36:39], s64 offen sc1
    v_fmac_f32 v124, v44, v27
    v_mfma_f32_16x16x32_bf16 v[64:67], a[52:55], a[4:7], v[64:67]
    v_fmac_f32 v125, v45, v27
    v_fmac_f32 v126, v46, v27
    v_fmac_f32 v127, v47, v27
    v_fmac_f32 v220, v16, v27
    v_fmac_f32 v221, v17, v27
    v_mfma_f32_16x16x32_bf16 v[64:67], a[48:51], a[0:3], v[64:67]
    v_fmac_f32 v222, v18, v27
    v_fmac_f32 v223, v19, v27
    v_max_f32 v124, 0, v124
    v_max_f32 v125, 0, v125
    s_waitcnt lgkmcnt(1)
    v_mfma_f32_16x16x32_bf16 v[180:183], a[64:67], a[40:43], v[180:183]
    buffer_load_dwordx4 a[196:199], v3, s[40:43], s86 offen offset:2048 sc1
    v_max_f32 v126, 0, v126
    v_max_f32 v127, 0, v127
    v_mul_f32 v220, v220, v124
    v_mul_f32 v221, v221, v125
    v_mul_f32 v222, v222, v126
    v_mfma_f32_16x16x32_bf16 v[180:183], a[68:71], a[44:47], v[180:183]
    v_mul_f32 v223, v223, v127
    v_cvt_pk_bf16_f32 v124, v220, v221
    v_cvt_pk_bf16_f32 v125, v222, v223
    v_mfma_f32_16x16x32_bf16 v[204:207], a[76:79], a[44:47], v[204:207]
    v_fmac_f32 v148, v48, v27
    v_fmac_f32 v149, v49, v27
    v_fmac_f32 v150, v50, v27
    v_fmac_f32 v151, v51, v27
    v_mfma_f32_16x16x32_bf16 v[204:207], a[72:75], a[40:43], v[204:207]
    v_fmac_f32 v244, v20, v27
    v_fmac_f32 v245, v21, v27
    v_fmac_f32 v246, v22, v27
    v_fmac_f32 v247, v23, v27
    v_max_f32 v148, 0, v148
    v_mfma_f32_16x16x32_bf16 v[200:203], a[72:75], a[32:35], v[200:203]
    v_max_f32 v149, 0, v149
    v_max_f32 v150, 0, v150
    v_max_f32 v151, 0, v151
    v_mul_f32 v244, v244, v148
    v_mfma_f32_16x16x32_bf16 v[200:203], a[76:79], a[36:39], v[200:203]
    v_mul_f32 v245, v245, v149
    v_mul_f32 v246, v246, v150
    v_mul_f32 v247, v247, v151
    v_cvt_pk_bf16_f32 v126, v244, v245
    v_cvt_pk_bf16_f32 v127, v246, v247
    v_mfma_f32_16x16x32_bf16 v[176:179], a[68:71], a[36:39], v[176:179]
    buffer_load_dwordx4 a[200:203], v3, s[40:43], s86 offen offset:3072 sc1
    buffer_store_dwordx4 v[124:127], v31, s[36:39], s64 offen sc1
    v_fmac_f32 v120, v44, v26
    v_fmac_f32 v121, v45, v26
    v_mfma_f32_16x16x32_bf16 v[176:179], a[64:67], a[32:35], v[176:179]
    v_fmac_f32 v122, v46, v26
    v_fmac_f32 v123, v47, v26
    v_fmac_f32 v216, v16, v26
    v_fmac_f32 v217, v17, v26
    v_fmac_f32 v218, v18, v26
    v_mfma_f32_16x16x32_bf16 v[172:175], a[64:67], a[24:27], v[172:175]
    v_fmac_f32 v219, v19, v26
    v_max_f32 v120, 0, v120
    v_max_f32 v121, 0, v121
    v_max_f32 v122, 0, v122
    v_mfma_f32_16x16x32_bf16 v[172:175], a[68:71], a[28:31], v[172:175]
    v_max_f32 v123, 0, v123
    v_mul_f32 v216, v216, v120
    v_mul_f32 v217, v217, v121
    v_mul_f32 v218, v218, v122
    v_mfma_f32_16x16x32_bf16 v[196:199], a[76:79], a[28:31], v[196:199]
    ds_write_b128 v5, v[180:183] offset:256
    v_mul_f32 v219, v219, v123
    v_cvt_pk_bf16_f32 v120, v216, v217
    v_cvt_pk_bf16_f32 v121, v218, v219
    v_fmac_f32 v144, v48, v26
    v_mfma_f32_16x16x32_bf16 v[196:199], a[72:75], a[24:27], v[196:199]
    v_fmac_f32 v145, v49, v26
    v_fmac_f32 v146, v50, v26
    v_fmac_f32 v147, v51, v26
    v_fmac_f32 v240, v20, v26
    v_mfma_f32_16x16x32_bf16 v[192:195], a[72:75], a[16:19], v[192:195]
    buffer_load_dwordx4 a[204:207], v4, s[40:43], s86 offen sc1
    v_fmac_f32 v241, v21, v26
    v_fmac_f32 v242, v22, v26
    v_fmac_f32 v243, v23, v26
    v_max_f32 v144, 0, v144
    v_max_f32 v145, 0, v145
    v_mfma_f32_16x16x32_bf16 v[192:195], a[76:79], a[20:23], v[192:195]
    ds_write_b128 v5, v[204:207] offset:320
    v_max_f32 v146, 0, v146
    v_max_f32 v147, 0, v147
    v_mul_f32 v240, v240, v144
    v_mul_f32 v241, v241, v145
    v_mfma_f32_16x16x32_bf16 v[168:171], a[68:71], a[20:23], v[168:171]
    v_mul_f32 v242, v242, v146
    v_mul_f32 v243, v243, v147
    v_cvt_pk_bf16_f32 v122, v240, v241
    v_cvt_pk_bf16_f32 v123, v242, v243
    buffer_store_dwordx4 v[120:123], v30, s[36:39], s64 offen sc1
    v_mfma_f32_16x16x32_bf16 v[168:171], a[64:67], a[16:19], v[168:171]
    v_fmac_f32 v116, v44, v25
    v_fmac_f32 v117, v45, v25
    v_fmac_f32 v118, v46, v25
    v_mfma_f32_16x16x32_bf16 v[164:167], a[64:67], a[8:11], v[164:167]
    v_fmac_f32 v119, v47, v25
    v_fmac_f32 v212, v16, v25
    v_fmac_f32 v213, v17, v25
    v_fmac_f32 v214, v18, v25
    v_mfma_f32_16x16x32_bf16 v[164:167], a[68:71], a[12:15], v[164:167]
    s_add_u32 s86, s87, 30720
    v_fmac_f32 v215, v19, v25
    v_max_f32 v116, 0, v116
    v_max_f32 v117, 0, v117
    v_max_f32 v118, 0, v118
    v_max_f32 v119, 0, v119
    v_mfma_f32_16x16x32_bf16 v[188:191], a[76:79], a[12:15], v[188:191]
    buffer_load_dwordx4 a[208:211], v3, s[40:43], s86 offen sc1
    v_mul_f32 v212, v212, v116
    v_mul_f32 v213, v213, v117
    v_mul_f32 v214, v214, v118
    v_mul_f32 v215, v215, v119
    v_mfma_f32_16x16x32_bf16 v[188:191], a[72:75], a[8:11], v[188:191]
    v_cvt_pk_bf16_f32 v116, v212, v213
    v_cvt_pk_bf16_f32 v117, v214, v215
    v_fmac_f32 v140, v48, v25
    v_fmac_f32 v141, v49, v25
    v_mfma_f32_16x16x32_bf16 v[184:187], a[72:75], a[0:3], v[184:187]
    v_fmac_f32 v142, v50, v25
    v_fmac_f32 v143, v51, v25
    v_fmac_f32 v236, v20, v25
    v_fmac_f32 v237, v21, v25
    s_waitcnt lgkmcnt(0)
    s_barrier
    v_mfma_f32_16x16x32_bf16 v[184:187], a[76:79], a[4:7], v[184:187]
    ds_read_b128 v[36:39], v6 offset:0
    ds_read_b128 v[8:11], v6 offset:256
    v_fmac_f32 v238, v22, v25
    v_fmac_f32 v239, v23, v25
    v_max_f32 v140, 0, v140
    v_max_f32 v141, 0, v141
    v_max_f32 v142, 0, v142
    v_mfma_f32_16x16x32_bf16 v[160:163], a[68:71], a[4:7], v[160:163]
    ds_read_b128 v[40:43], v6 offset:64
    ds_read_b128 v[12:15], v6 offset:320
    v_max_f32 v143, 0, v143
    v_mul_f32 v236, v236, v140
    v_mul_f32 v237, v237, v141
    v_mul_f32 v238, v238, v142
    v_mfma_f32_16x16x32_bf16 v[160:163], a[64:67], a[0:3], v[160:163]
    v_mul_f32 v239, v239, v143
    v_cvt_pk_bf16_f32 v118, v236, v237
    v_cvt_pk_bf16_f32 v119, v238, v239
    buffer_store_dwordx4 v[116:119], v29, s[36:39], s64 offen sc1
    v_pk_fma_f32 v[112:113], v[44:45], v[24:25], v[112:113] op_sel:[0,0,0] op_sel_hi:[1,0,1]
    v_pk_fma_f32 v[114:115], v[46:47], v[24:25], v[114:115] op_sel:[0,0,0] op_sel_hi:[1,0,1]
    v_pk_fma_f32 v[208:209], v[16:17], v[24:25], v[208:209] op_sel:[0,0,0] op_sel_hi:[1,0,1]
    v_pk_fma_f32 v[210:211], v[18:19], v[24:25], v[210:211] op_sel:[0,0,0] op_sel_hi:[1,0,1]
    v_max_f32 v112, 0, v112
    v_max_f32 v113, 0, v113
    v_max_f32 v114, 0, v114
    v_max_f32_e64 v115, 0, v115
    v_pk_mul_f32 v[208:209], v[208:209], v[112:113]
    v_pk_mul_f32 v[210:211], v[210:211], v[114:115]
    v_cvt_pk_bf16_f32 v112, v208, v209
    v_cvt_pk_bf16_f32 v113, v210, v211
    v_pk_fma_f32 v[136:137], v[48:49], v[24:25], v[136:137] op_sel:[0,0,0] op_sel_hi:[1,0,1]
    v_pk_fma_f32 v[138:139], v[50:51], v[24:25], v[138:139] op_sel:[0,0,0] op_sel_hi:[1,0,1]
    v_pk_fma_f32 v[232:233], v[20:21], v[24:25], v[232:233] op_sel:[0,0,0] op_sel_hi:[1,0,1]
    v_pk_fma_f32 v[234:235], v[22:23], v[24:25], v[234:235] op_sel:[0,0,0] op_sel_hi:[1,0,1]
    v_max_f32 v136, 0, v136
    v_max_f32 v137, 0, v137
    v_max_f32 v138, 0, v138
    v_max_f32 v139, 0, v139
    v_pk_mul_f32 v[232:233], v[232:233], v[136:137]
    v_pk_mul_f32 v[234:235], v[234:235], v[138:139]
    v_cvt_pk_bf16_f32 v114, v232, v233
    v_cvt_pk_bf16_f32 v115, v234, v235
    buffer_store_dwordx4 v[112:115], v28, s[36:39], s64 offen sc1
    s_waitcnt lgkmcnt(2)
    v_pk_fma_f32 v[84:85], v[36:37], v[34:35], v[84:85] op_sel:[0,1,0] op_sel_hi:[1,1,1]
    v_pk_fma_f32 v[86:87], v[38:39], v[34:35], v[86:87] op_sel:[0,1,0] op_sel_hi:[1,1,1]
    v_pk_fma_f32 v[180:181], v[8:9], v[34:35], v[180:181] op_sel:[0,1,0] op_sel_hi:[1,1,1]
    v_pk_fma_f32 v[182:183], v[10:11], v[34:35], v[182:183] op_sel:[0,1,0] op_sel_hi:[1,1,1]
    v_max_f32 v84, 0, v84
    v_max_f32 v85, 0, v85
    v_max_f32 v86, 0, v86
    v_max_f32 v87, 0, v87
    v_pk_mul_f32 v[180:181], v[180:181], v[84:85]
    v_pk_mul_f32 v[182:183], v[182:183], v[86:87]
    v_cvt_pk_bf16_f32 v84, v180, v181
    v_cvt_pk_bf16_f32 v85, v182, v183
    s_waitcnt lgkmcnt(0)
    v_pk_fma_f32 v[108:109], v[40:41], v[34:35], v[108:109] op_sel:[0,1,0] op_sel_hi:[1,1,1]
    v_pk_fma_f32 v[110:111], v[42:43], v[34:35], v[110:111] op_sel:[0,1,0] op_sel_hi:[1,1,1]
    v_pk_fma_f32 v[204:205], v[12:13], v[34:35], v[204:205] op_sel:[0,1,0] op_sel_hi:[1,1,1]
    v_pk_fma_f32 v[206:207], v[14:15], v[34:35], v[206:207] op_sel:[0,1,0] op_sel_hi:[1,1,1]
    v_max_f32 v108, 0, v108
    v_max_f32 v109, 0, v109
    v_max_f32 v110, 0, v110
    v_max_f32 v111, 0, v111
    v_pk_mul_f32 v[204:205], v[204:205], v[108:109]
    v_pk_mul_f32 v[206:207], v[206:207], v[110:111]
    v_cvt_pk_bf16_f32 v86, v204, v205
    v_cvt_pk_bf16_f32 v87, v206, v207
    buffer_store_dwordx4 v[84:87], v33, s[36:39], s63 offen sc1
    v_pk_fma_f32 v[80:81], v[36:37], v[34:35], v[80:81] op_sel:[0,0,0] op_sel_hi:[1,0,1]
    v_pk_fma_f32 v[82:83], v[38:39], v[34:35], v[82:83] op_sel:[0,0,0] op_sel_hi:[1,0,1]
    v_pk_fma_f32 v[176:177], v[8:9], v[34:35], v[176:177] op_sel:[0,0,0] op_sel_hi:[1,0,1]
    v_pk_fma_f32 v[178:179], v[10:11], v[34:35], v[178:179] op_sel:[0,0,0] op_sel_hi:[1,0,1]
    v_max_f32 v80, 0, v80
    v_max_f32 v81, 0, v81
    v_max_f32 v82, 0, v82
    v_max_f32 v83, 0, v83
    v_pk_mul_f32 v[176:177], v[176:177], v[80:81]
    v_pk_mul_f32 v[178:179], v[178:179], v[82:83]
    v_cvt_pk_bf16_f32 v80, v176, v177
    v_cvt_pk_bf16_f32 v81, v178, v179
    v_pk_fma_f32 v[104:105], v[40:41], v[34:35], v[104:105] op_sel:[0,0,0] op_sel_hi:[1,0,1]
    v_pk_fma_f32 v[106:107], v[42:43], v[34:35], v[106:107] op_sel:[0,0,0] op_sel_hi:[1,0,1]
    v_pk_fma_f32 v[200:201], v[12:13], v[34:35], v[200:201] op_sel:[0,0,0] op_sel_hi:[1,0,1]
    v_pk_fma_f32 v[202:203], v[14:15], v[34:35], v[202:203] op_sel:[0,0,0] op_sel_hi:[1,0,1]
    v_max_f32 v104, 0, v104
    v_max_f32 v105, 0, v105
    v_max_f32 v106, 0, v106
    v_max_f32 v107, 0, v107
    v_pk_mul_f32 v[200:201], v[200:201], v[104:105]
    v_pk_mul_f32 v[202:203], v[202:203], v[106:107]
    v_cvt_pk_bf16_f32 v82, v200, v201
    v_cvt_pk_bf16_f32 v83, v202, v203
    buffer_store_dwordx4 v[80:83], v32, s[36:39], s63 offen sc1
    v_pk_fma_f32 v[76:77], v[36:37], v[26:27], v[76:77] op_sel:[0,1,0] op_sel_hi:[1,1,1]
    v_pk_fma_f32 v[78:79], v[38:39], v[26:27], v[78:79] op_sel:[0,1,0] op_sel_hi:[1,1,1]
    v_pk_fma_f32 v[172:173], v[8:9], v[26:27], v[172:173] op_sel:[0,1,0] op_sel_hi:[1,1,1]
    v_pk_fma_f32 v[174:175], v[10:11], v[26:27], v[174:175] op_sel:[0,1,0] op_sel_hi:[1,1,1]
    v_max_f32 v76, 0, v76
    v_max_f32 v77, 0, v77
    v_max_f32 v78, 0, v78
    v_max_f32 v79, 0, v79
    v_pk_mul_f32 v[172:173], v[172:173], v[76:77]
    v_pk_mul_f32 v[174:175], v[174:175], v[78:79]
    v_cvt_pk_bf16_f32 v76, v172, v173
    v_cvt_pk_bf16_f32 v77, v174, v175
    v_pk_fma_f32 v[100:101], v[40:41], v[26:27], v[100:101] op_sel:[0,1,0] op_sel_hi:[1,1,1]
    v_pk_fma_f32 v[102:103], v[42:43], v[26:27], v[102:103] op_sel:[0,1,0] op_sel_hi:[1,1,1]
    v_pk_fma_f32 v[196:197], v[12:13], v[26:27], v[196:197] op_sel:[0,1,0] op_sel_hi:[1,1,1]
    v_pk_fma_f32 v[198:199], v[14:15], v[26:27], v[198:199] op_sel:[0,1,0] op_sel_hi:[1,1,1]
    v_max_f32 v100, 0, v100
    v_max_f32 v101, 0, v101
    v_max_f32 v102, 0, v102
    v_max_f32 v103, 0, v103
    v_pk_mul_f32 v[196:197], v[196:197], v[100:101]
    v_pk_mul_f32 v[198:199], v[198:199], v[102:103]
    v_cvt_pk_bf16_f32 v78, v196, v197
    v_cvt_pk_bf16_f32 v79, v198, v199
    buffer_store_dwordx4 v[76:79], v31, s[36:39], s63 offen sc1
    v_pk_fma_f32 v[72:73], v[36:37], v[26:27], v[72:73] op_sel:[0,0,0] op_sel_hi:[1,0,1]
    v_pk_fma_f32 v[74:75], v[38:39], v[26:27], v[74:75] op_sel:[0,0,0] op_sel_hi:[1,0,1]
    v_pk_fma_f32 v[168:169], v[8:9], v[26:27], v[168:169] op_sel:[0,0,0] op_sel_hi:[1,0,1]
    v_pk_fma_f32 v[170:171], v[10:11], v[26:27], v[170:171] op_sel:[0,0,0] op_sel_hi:[1,0,1]
    v_max_f32 v72, 0, v72
    v_max_f32 v73, 0, v73
    v_max_f32 v74, 0, v74
    v_max_f32 v75, 0, v75
    v_pk_mul_f32 v[168:169], v[168:169], v[72:73]
    v_pk_mul_f32 v[170:171], v[170:171], v[74:75]
    v_cvt_pk_bf16_f32 v72, v168, v169
    v_cvt_pk_bf16_f32 v73, v170, v171
    v_pk_fma_f32 v[96:97], v[40:41], v[26:27], v[96:97] op_sel:[0,0,0] op_sel_hi:[1,0,1]
    v_pk_fma_f32 v[98:99], v[42:43], v[26:27], v[98:99] op_sel:[0,0,0] op_sel_hi:[1,0,1]
    v_pk_fma_f32 v[192:193], v[12:13], v[26:27], v[192:193] op_sel:[0,0,0] op_sel_hi:[1,0,1]
    v_pk_fma_f32 v[194:195], v[14:15], v[26:27], v[194:195] op_sel:[0,0,0] op_sel_hi:[1,0,1]
    v_max_f32 v96, 0, v96
    v_max_f32 v97, 0, v97
    v_max_f32 v98, 0, v98
    v_max_f32 v99, 0, v99
    v_pk_mul_f32 v[192:193], v[192:193], v[96:97]
    v_pk_mul_f32 v[194:195], v[194:195], v[98:99]
    v_cvt_pk_bf16_f32 v74, v192, v193
    v_cvt_pk_bf16_f32 v75, v194, v195
    buffer_store_dwordx4 v[72:75], v30, s[36:39], s63 offen sc1
    v_pk_fma_f32 v[68:69], v[36:37], v[24:25], v[68:69] op_sel:[0,1,0] op_sel_hi:[1,1,1]
    v_pk_fma_f32 v[70:71], v[38:39], v[24:25], v[70:71] op_sel:[0,1,0] op_sel_hi:[1,1,1]
    v_pk_fma_f32 v[164:165], v[8:9], v[24:25], v[164:165] op_sel:[0,1,0] op_sel_hi:[1,1,1]
    v_pk_fma_f32 v[166:167], v[10:11], v[24:25], v[166:167] op_sel:[0,1,0] op_sel_hi:[1,1,1]
    v_max_f32 v68, 0, v68
    v_max_f32 v69, 0, v69
    v_max_f32 v70, 0, v70
    v_max_f32 v71, 0, v71
    v_pk_mul_f32 v[164:165], v[164:165], v[68:69]
    v_pk_mul_f32 v[166:167], v[166:167], v[70:71]
    v_cvt_pk_bf16_f32 v68, v164, v165
    v_cvt_pk_bf16_f32 v69, v166, v167
    v_pk_fma_f32 v[92:93], v[40:41], v[24:25], v[92:93] op_sel:[0,1,0] op_sel_hi:[1,1,1]
    v_pk_fma_f32 v[94:95], v[42:43], v[24:25], v[94:95] op_sel:[0,1,0] op_sel_hi:[1,1,1]
    v_pk_fma_f32 v[188:189], v[12:13], v[24:25], v[188:189] op_sel:[0,1,0] op_sel_hi:[1,1,1]
    v_pk_fma_f32 v[190:191], v[14:15], v[24:25], v[190:191] op_sel:[0,1,0] op_sel_hi:[1,1,1]
    v_max_f32 v92, 0, v92
    v_max_f32 v93, 0, v93
    v_max_f32 v94, 0, v94
    v_max_f32 v95, 0, v95
    v_pk_mul_f32 v[188:189], v[188:189], v[92:93]
    v_pk_mul_f32 v[190:191], v[190:191], v[94:95]
    v_cvt_pk_bf16_f32 v70, v188, v189
    v_cvt_pk_bf16_f32 v71, v190, v191
    buffer_store_dwordx4 v[68:71], v29, s[36:39], s63 offen sc1
    v_pk_fma_f32 v[64:65], v[36:37], v[24:25], v[64:65] op_sel:[0,0,0] op_sel_hi:[1,0,1]
    v_pk_fma_f32 v[66:67], v[38:39], v[24:25], v[66:67] op_sel:[0,0,0] op_sel_hi:[1,0,1]
    v_pk_fma_f32 v[160:161], v[8:9], v[24:25], v[160:161] op_sel:[0,0,0] op_sel_hi:[1,0,1]
    v_pk_fma_f32 v[162:163], v[10:11], v[24:25], v[162:163] op_sel:[0,0,0] op_sel_hi:[1,0,1]
    v_max_f32 v64, 0, v64
    v_max_f32 v65, 0, v65
    v_max_f32 v66, 0, v66
    v_max_f32 v67, 0, v67
    v_pk_mul_f32 v[160:161], v[160:161], v[64:65]
    v_pk_mul_f32 v[162:163], v[162:163], v[66:67]
    v_cvt_pk_bf16_f32 v64, v160, v161
    v_cvt_pk_bf16_f32 v65, v162, v163
    v_pk_fma_f32 v[88:89], v[40:41], v[24:25], v[88:89] op_sel:[0,0,0] op_sel_hi:[1,0,1]
    v_pk_fma_f32 v[90:91], v[42:43], v[24:25], v[90:91] op_sel:[0,0,0] op_sel_hi:[1,0,1]
    v_pk_fma_f32 v[184:185], v[12:13], v[24:25], v[184:185] op_sel:[0,0,0] op_sel_hi:[1,0,1]
    v_pk_fma_f32 v[186:187], v[14:15], v[24:25], v[186:187] op_sel:[0,0,0] op_sel_hi:[1,0,1]
    v_max_f32 v88, 0, v88
    v_max_f32 v89, 0, v89
    v_max_f32 v90, 0, v90
    v_max_f32 v91, 0, v91
    v_pk_mul_f32 v[184:185], v[184:185], v[88:89]
    v_pk_mul_f32 v[186:187], v[186:187], v[90:91]
    v_cvt_pk_bf16_f32 v66, v184, v185
    v_cvt_pk_bf16_f32 v67, v186, v187
    buffer_store_dwordx4 v[64:67], v28, s[36:39], s63 offen sc1
    s_nop 1
    buffer_load_dwordx4 a[212:215], v3, s[40:43], s86 offen offset:1024 sc1
    buffer_load_dwordx4 a[216:219], v3, s[40:43], s86 offen offset:2048 sc1
    buffer_load_dwordx4 a[220:223], v3, s[40:43], s86 offen offset:3072 sc1
    s_add_u32 s12, s89, 0
    s_sub_u32 s13, s89, 0
    v_lshlrev_b32 v5, 4, v0
    v_add_u32 v6, 1024, v5
    v_and_b32 v6, 4095, v6
    v_add_u32 v7, 2048, v5
    v_and_b32 v7, 4095, v7
    v_add_u32 v8, 3072, v5
    v_and_b32 v8, 4095, v8
    s_mul_i32 s70, s84, 178496
    v_bfe_u32 v14, v0, 3, 1
    v_mul_u32_u24 v14, 175707, v14
    v_add_u32 v14, s70, v14
    v_lshrrev_b32 v12, 19, v14
    v_and_b32 v14, 7, v0
    v_cmp_gt_u32 vcc, 4, v14
    s_mul_i32 s70, s60, 3
    v_add_u32 v14, s70, v14
    v_cndmask_b32 v14, 13, v14, vcc
    v_mad_u32_u24 v12, v12, 14, v14
    v_lshlrev_b32 v12, 7, v12
    v_add_u32 v12, 32768, v12
    s_mov_b32 s56, s18
    s_mov_b32 s57, s19
    s_mov_b32 s58, 2621440
    s_mov_b32 s59, 0x20000
    s_and_b32 s70, s60, 1
    s_add_u32 s70, s70, 72
    s_mul_i32 s28, s70, 5120
    s_add_u32 s28, s28, s88
    s_sub_u32 s28, s28, s67
    s_lshl_b32 s29, s70, 12
    s_add_u32 s29, s29, s3
    s_add_u32 s70, s60, 0
    s_and_b32 s70, s70, 3
    s_mul_i32 s71, s70, 15360
    v_add_u32 v27, s71, v3
    s_add_u32 s70, s60, 1
    s_and_b32 s70, s70, 3
    s_mul_i32 s71, s70, 15360
    v_add_u32 v24, s71, v3
    s_add_u32 s70, s60, 2
    s_and_b32 s70, s70, 3
    s_mul_i32 s71, s70, 15360
    s_add_u32 s71, s71, 5120
    v_add_u32 v25, s71, v3
    s_add_u32 s70, s60, 3
    s_and_b32 s70, s70, 3
    s_mul_i32 s71, s70, 15360
    s_add_u32 s71, s71, 10240
    v_add_u32 v26, s71, v3
    s_lshl_b32 s70, s84, 6
    s_lshl4_add_u32 s71, s60, s70
    s_lshl_b32 s80, s84, 6
    s_lshl4_add_u32 s80, s60, s80
    s_lshl3_add_u32 s80, s80, s85
    s_mul_i32 s80, s80, 160
    v_cmp_gt_u32 vcc, 32, v1
    v_mul_u32_u24 v22, 6554, v1
    v_lshrrev_b32 v22, 16, v22
    v_mul_u32_u24 v22, 1120, v22
    v_add3_u32 v136, v22, v3, s80
    v_add_u32 v22, 64, v1
    v_mul_u32_u24 v22, 6554, v22
    v_lshrrev_b32 v22, 16, v22
    v_mul_u32_u24 v22, 1120, v22
    v_add3_u32 v137, v22, v3, s80
    v_add_u32 v22, 128, v1
    v_mul_u32_u24 v22, 6554, v22
    v_lshrrev_b32 v22, 16, v22
    v_mul_u32_u24 v22, 1120, v22
    v_add3_u32 v138, v22, v3, s80
    v_mov_b32 v22, 2147418112
    v_cndmask_b32 v138, v22, v138, vcc
    s_mul_i32 s101, s60, 3072
    s_add_u32 s101, s101, 61440
    s_mul_i32 s69, s60, 15360
    v_and_b32 v22, 15, v0
    v_mul_u32_u24 v10, 160, v22
    v_lshrrev_b32 v23, 4, v1
    v_lshlrev_b32 v23, 3, v23
    v_add3_u32 v11, v10, v23, s69
    v_add_u32 v10, v11, v23
    s_mul_i32 s80, s60, 12288
    s_sub_u32 s80, 61440, s80
    s_add_u32 s69, s69, s80
    v_add_u32 v28, s80, v10
    v_add_u32 v29, s80, v11
    s_lshl2_add_u32 s80, s71, 8192
    v_lshl_add_u32 v22, v22, 2, s80
    s_mul_i32 s70, s71, 2979
    s_lshr_b32 s70, s70, 19
    s_lshl_b32 s70, s70, 10
    s_add_u32 s70, s70, 53248
    v_and_b32 v23, 7, v0
    v_lshl_add_u32 v13, v23, 7, s70
    v_lshrrev_b32 v9, 5, v1
    v_mul_u32_u24 v9, 1536, v9
    s_lshl_b32 s70, s60, 9
    v_add3_u32 v9, v9, v3, s70
    v_mov_b32 v142, s100
    v_mov_b32 v143, 2147418112
    v_cmp_eq_u32 vcc, 0, v0
    s_nop 1
    v_cndmask_b32 v142, v143, v142, vcc
    v_mov_b32_e64 v143, 1
    s_waitcnt vmcnt(3)
    s_barrier
    buffer_store_dword v143, v142, s[44:47], 0 offen sc1
    buffer_load_dwordx4 a[224:227], v4, s[40:43], s86 offen sc1
    s_add_u32 s86, s87, 35840
    buffer_load_dwordx4 a[228:231], v3, s[40:43], s86 offen sc1
    buffer_load_dwordx4 a[232:235], v3, s[40:43], s86 offen offset:1024 sc1
    buffer_load_dwordx4 a[236:239], v3, s[40:43], s86 offen offset:2048 sc1
    buffer_load_dwordx4 a[240:243], v3, s[40:43], s86 offen offset:3072 sc1
    buffer_load_dwordx4 a[244:247], v4, s[40:43], s86 offen sc1
    s_add_u32 s86, s87, 51200
    buffer_load_dwordx4 a[40:43], v3, s[40:43], s86 offen sc1
    buffer_load_dwordx4 a[44:47], v3, s[40:43], s86 offen offset:1024 sc1
    buffer_load_dwordx4 a[48:51], v3, s[40:43], s86 offen offset:2048 sc1
    buffer_load_dwordx4 a[52:55], v3, s[40:43], s86 offen offset:3072 sc1
    buffer_load_dwordx4 a[56:59], v4, s[40:43], s86 offen sc1
    s_add_u32 s86, s87, 40960
    buffer_load_dwordx4 a[0:3], v3, s[40:43], s86 offen sc1
    buffer_load_dwordx4 a[4:7], v3, s[40:43], s86 offen offset:1024 sc1
    buffer_load_dwordx4 a[8:11], v3, s[40:43], s86 offen offset:2048 sc1
    buffer_load_dwordx4 a[12:15], v3, s[40:43], s86 offen offset:3072 sc1
    buffer_load_dwordx4 a[16:19], v4, s[40:43], s86 offen sc1
    s_add_u32 s86, s87, 46080
    buffer_load_dwordx4 a[20:23], v3, s[40:43], s86 offen sc1
    buffer_load_dwordx4 a[24:27], v3, s[40:43], s86 offen offset:1024 sc1
    buffer_load_dwordx4 a[28:31], v3, s[40:43], s86 offen offset:2048 sc1
    buffer_load_dwordx4 a[32:35], v3, s[40:43], s86 offen offset:3072 sc1
    buffer_load_dwordx4 a[36:39], v4, s[40:43], s86 offen sc1
    s_add_u32 s86, s87, 56320
    buffer_load_dwordx4 a[60:63], v3, s[40:43], s86 offen sc1
    buffer_load_dwordx4 a[64:67], v3, s[40:43], s86 offen offset:1024 sc1
    buffer_load_dwordx4 a[68:71], v3, s[40:43], s86 offen offset:2048 sc1
    buffer_load_dwordx4 a[72:75], v3, s[40:43], s86 offen offset:3072 sc1
    buffer_load_dwordx4 a[76:79], v4, s[40:43], s86 offen sc1
    buffer_load_dword v22, v22, s[44:47], 0 offen sc1
    s_mov_b32 m0, s69
    s_nop 0
    buffer_load_dwordx4 v136, s[24:27], 0 offen offset:0 lds
    buffer_load_dwordx4 v137, s[24:27], 0 offen offset:1024 lds
    buffer_load_dwordx4 v138, s[24:27], 0 offen offset:2048 lds
    buffer_load_dword v14, v12, s[44:47], 0 offen sc1
    s_add_u32 s86, s87, 61440
    buffer_load_dwordx4 v[96:99], v3, s[40:43], s86 offen sc1
    buffer_load_dwordx4 v[100:103], v3, s[40:43], s86 offen offset:1024 sc1
    buffer_load_dwordx4 v[104:107], v3, s[40:43], s86 offen offset:2048 sc1
    buffer_load_dwordx4 v[108:111], v3, s[40:43], s86 offen offset:3072 sc1
    buffer_load_dwordx4 v[112:115], v4, s[40:43], s86 offen sc1
    s_mov_b32 s86, s28
    buffer_load_dwordx4 v[116:119], v3, s[40:43], s86 offen sc1
    buffer_load_dwordx4 v[120:123], v3, s[40:43], s86 offen offset:1024 sc1
    buffer_load_dwordx4 v[124:127], v3, s[40:43], s86 offen offset:2048 sc1
    buffer_load_dwordx4 v[128:131], v3, s[40:43], s86 offen offset:3072 sc1
    buffer_load_dwordx4 v[132:135], v4, s[40:43], s86 offen sc1
    s_waitcnt vmcnt(10)
    v_cmp_ne_u32 vcc, 1, v14
    s_nop 0
    s_cbranch_vccnz L_fspin_glu
L_fback_glu:
L_p2:
    s_cbranch_execz L_ret
    s_add_u32 s14, s12, 0
    s_nop 0
    buffer_load_dwordx4 v[72:75], v6, s[36:39], s14 offen sc1
    s_add_u32 s15, s12, 4096
    buffer_load_dwordx4 v[76:79], v6, s[36:39], s15 offen sc1
    buffer_load_dwordx4 v[80:83], v7, s[36:39], s14 offen sc1
    buffer_load_dwordx4 v[84:87], v7, s[36:39], s15 offen sc1
    buffer_load_dwordx4 v[88:91], v8, s[36:39], s14 offen sc1
    buffer_load_dwordx4 v[92:95], v8, s[36:39], s15 offen sc1
    buffer_load_dwordx4 v[64:67], v5, s[36:39], s14 offen sc1
    buffer_load_dwordx4 v[68:71], v5, s[36:39], s15 offen sc1
    v_add_u32 v140, 61440, v3
    v_add_u32 v141, 112640, v3
    s_add_u32 s16, s12, 8192
    buffer_load_dwordx4 v[40:43], v6, s[36:39], s16 offen sc1
    s_add_u32 s17, s12, 12288
    buffer_load_dwordx4 v[44:47], v6, s[36:39], s17 offen sc1
    buffer_load_dwordx4 v[48:51], v7, s[36:39], s16 offen sc1
    buffer_load_dwordx4 v[52:55], v7, s[36:39], s17 offen sc1
    s_waitcnt vmcnt(10)
    v_mfma_f32_16x16x32_bf16 v[196:199], a[88:91], v[72:75], 0
    v_mfma_f32_16x16x32_bf16 v[196:199], a[108:111], v[76:79], v[196:199]
    v_mfma_f32_16x16x32_bf16 v[200:203], a[112:115], v[76:79], 0
    buffer_load_dwordx4 v[56:59], v8, s[36:39], s16 offen sc1
    v_mfma_f32_16x16x32_bf16 v[200:203], a[92:95], v[72:75], v[200:203]
    v_mfma_f32_16x16x32_bf16 v[204:207], a[96:99], v[72:75], 0
    v_mfma_f32_16x16x32_bf16 v[204:207], a[116:119], v[76:79], v[204:207]
    v_mfma_f32_16x16x32_bf16 v[208:211], a[120:123], v[76:79], 0
    buffer_load_dwordx4 v[60:63], v8, s[36:39], s17 offen sc1
    v_mfma_f32_16x16x32_bf16 v[208:211], a[100:103], v[72:75], v[208:211]
    v_mfma_f32_16x16x32_bf16 v[212:215], a[104:107], v[72:75], 0
    v_mfma_f32_16x16x32_bf16 v[212:215], a[124:127], v[76:79], v[212:215]
    s_waitcnt vmcnt(10)
    v_mfma_f32_16x16x32_bf16 v[232:235], a[124:127], v[84:87], 0
    buffer_load_dwordx4 v[32:35], v5, s[36:39], s16 offen sc1
    v_mfma_f32_16x16x32_bf16 v[232:235], a[104:107], v[80:83], v[232:235]
    v_mfma_f32_16x16x32_bf16 v[228:231], a[100:103], v[80:83], 0
    v_mfma_f32_16x16x32_bf16 v[228:231], a[120:123], v[84:87], v[228:231]
    v_mfma_f32_16x16x32_bf16 v[224:227], a[116:119], v[84:87], 0
    buffer_load_dwordx4 v[36:39], v5, s[36:39], s17 offen sc1
    v_mfma_f32_16x16x32_bf16 v[224:227], a[96:99], v[80:83], v[224:227]
    v_mfma_f32_16x16x32_bf16 v[220:223], a[92:95], v[80:83], 0
    v_mfma_f32_16x16x32_bf16 v[220:223], a[112:115], v[84:87], v[220:223]
    s_add_u32 s14, s13, 16384
    v_mfma_f32_16x16x32_bf16 v[216:219], a[108:111], v[84:87], 0
    buffer_load_dwordx4 v[72:75], v6, s[36:39], s14 offen sc1
    v_mfma_f32_16x16x32_bf16 v[216:219], a[88:91], v[80:83], v[216:219]
    s_waitcnt vmcnt(11)
    v_mfma_f32_16x16x32_bf16 v[236:239], a[88:91], v[88:91], 0
    v_mfma_f32_16x16x32_bf16 v[236:239], a[108:111], v[92:95], v[236:239]
    s_add_u32 s15, s13, 20480
    v_mfma_f32_16x16x32_bf16 v[240:243], a[112:115], v[92:95], 0
    buffer_load_dwordx4 v[76:79], v6, s[36:39], s15 offen sc1
    v_mfma_f32_16x16x32_bf16 v[240:243], a[92:95], v[88:91], v[240:243]
    v_mfma_f32_16x16x32_bf16 v[244:247], a[96:99], v[88:91], 0
    v_mfma_f32_16x16x32_bf16 v[244:247], a[116:119], v[92:95], v[244:247]
    v_mfma_f32_16x16x32_bf16 v[248:251], a[120:123], v[92:95], 0
    buffer_load_dwordx4 v[80:83], v7, s[36:39], s14 offen sc1
    v_mfma_f32_16x16x32_bf16 v[248:251], a[100:103], v[88:91], v[248:251]
    v_mfma_f32_16x16x32_bf16 v[252:255], a[104:107], v[88:91], 0
    v_mfma_f32_16x16x32_bf16 v[252:255], a[124:127], v[92:95], v[252:255]
    s_waitcnt vmcnt(11)
    v_mfma_f32_16x16x32_bf16 v[192:195], a[124:127], v[68:71], 0
    buffer_load_dwordx4 v[84:87], v7, s[36:39], s15 offen sc1
    v_mfma_f32_16x16x32_bf16 v[192:195], a[104:107], v[64:67], v[192:195]
    v_mfma_f32_16x16x32_bf16 v[188:191], a[100:103], v[64:67], 0
L_pg4:
    s_cbranch_execz L_ret
    v_mfma_f32_16x16x32_bf16 v[188:191], a[120:123], v[68:71], v[188:191]
    v_mfma_f32_16x16x32_bf16 v[184:187], a[116:119], v[68:71], 0
    buffer_load_dwordx4 v[88:91], v8, s[36:39], s14 offen sc1
    v_mfma_f32_16x16x32_bf16 v[184:187], a[96:99], v[64:67], v[184:187]
    v_mfma_f32_16x16x32_bf16 v[180:183], a[92:95], v[64:67], 0
    v_mfma_f32_16x16x32_bf16 v[180:183], a[112:115], v[68:71], v[180:183]
    v_mfma_f32_16x16x32_bf16 v[176:179], a[108:111], v[68:71], 0
    buffer_load_dwordx4 v[92:95], v8, s[36:39], s15 offen sc1
    v_mfma_f32_16x16x32_bf16 v[176:179], a[88:91], v[64:67], v[176:179]
    s_waitcnt vmcnt(12)
    v_mfma_f32_16x16x32_bf16 v[196:199], a[128:131], v[40:43], v[196:199]
    v_mfma_f32_16x16x32_bf16 v[196:199], a[148:151], v[44:47], v[196:199]
    v_mfma_f32_16x16x32_bf16 v[200:203], a[152:155], v[44:47], v[200:203]
    buffer_load_dwordx4 v[64:67], v5, s[36:39], s14 offen sc1
    v_mfma_f32_16x16x32_bf16 v[200:203], a[132:135], v[40:43], v[200:203]
    v_mfma_f32_16x16x32_bf16 v[204:207], a[136:139], v[40:43], v[204:207]
    v_mfma_f32_16x16x32_bf16 v[204:207], a[156:159], v[44:47], v[204:207]
    v_mfma_f32_16x16x32_bf16 v[208:211], a[160:163], v[44:47], v[208:211]
    buffer_load_dwordx4 v[68:71], v5, s[36:39], s15 offen sc1
    v_mfma_f32_16x16x32_bf16 v[208:211], a[140:143], v[40:43], v[208:211]
    v_mfma_f32_16x16x32_bf16 v[212:215], a[144:147], v[40:43], v[212:215]
    v_mfma_f32_16x16x32_bf16 v[212:215], a[164:167], v[44:47], v[212:215]
    s_waitcnt vmcnt(12)
    v_mfma_f32_16x16x32_bf16 v[232:235], a[164:167], v[52:55], v[232:235]
    v_mfma_f32_16x16x32_bf16 v[232:235], a[144:147], v[48:51], v[232:235]
    s_add_u32 s16, s13, 24576
    v_mfma_f32_16x16x32_bf16 v[228:231], a[140:143], v[48:51], v[228:231]
    buffer_load_dwordx4 v[40:43], v6, s[36:39], s16 offen sc1
    v_mfma_f32_16x16x32_bf16 v[228:231], a[160:163], v[52:55], v[228:231]
    v_mfma_f32_16x16x32_bf16 v[224:227], a[156:159], v[52:55], v[224:227]
    v_mfma_f32_16x16x32_bf16 v[224:227], a[136:139], v[48:51], v[224:227]
    s_add_u32 s17, s13, 28672
    v_mfma_f32_16x16x32_bf16 v[220:223], a[132:135], v[48:51], v[220:223]
    buffer_load_dwordx4 v[44:47], v6, s[36:39], s17 offen sc1
    v_mfma_f32_16x16x32_bf16 v[220:223], a[152:155], v[52:55], v[220:223]
    v_mfma_f32_16x16x32_bf16 v[216:219], a[148:151], v[52:55], v[216:219]
    v_mfma_f32_16x16x32_bf16 v[216:219], a[128:131], v[48:51], v[216:219]
    s_waitcnt vmcnt(12)
    v_mfma_f32_16x16x32_bf16 v[236:239], a[128:131], v[56:59], v[236:239]
    v_mfma_f32_16x16x32_bf16 v[236:239], a[148:151], v[60:63], v[236:239]
    v_mfma_f32_16x16x32_bf16 v[240:243], a[152:155], v[60:63], v[240:243]
    buffer_load_dwordx4 v[48:51], v7, s[36:39], s16 offen sc1
    v_mfma_f32_16x16x32_bf16 v[240:243], a[132:135], v[56:59], v[240:243]
    v_mfma_f32_16x16x32_bf16 v[244:247], a[136:139], v[56:59], v[244:247]
    v_mfma_f32_16x16x32_bf16 v[244:247], a[156:159], v[60:63], v[244:247]
    v_mfma_f32_16x16x32_bf16 v[248:251], a[160:163], v[60:63], v[248:251]
    buffer_load_dwordx4 v[52:55], v7, s[36:39], s17 offen sc1
    v_mfma_f32_16x16x32_bf16 v[248:251], a[140:143], v[56:59], v[248:251]
    v_mfma_f32_16x16x32_bf16 v[252:255], a[144:147], v[56:59], v[252:255]
    v_mfma_f32_16x16x32_bf16 v[252:255], a[164:167], v[60:63], v[252:255]
    s_waitcnt vmcnt(12)
    v_mfma_f32_16x16x32_bf16 v[192:195], a[164:167], v[36:39], v[192:195]
    v_mfma_f32_16x16x32_bf16 v[192:195], a[144:147], v[32:35], v[192:195]
    v_mfma_f32_16x16x32_bf16 v[188:191], a[140:143], v[32:35], v[188:191]
    buffer_load_dwordx4 v[56:59], v8, s[36:39], s16 offen sc1
    v_mfma_f32_16x16x32_bf16 v[188:191], a[160:163], v[36:39], v[188:191]
    v_mfma_f32_16x16x32_bf16 v[184:187], a[156:159], v[36:39], v[184:187]
    v_mfma_f32_16x16x32_bf16 v[184:187], a[136:139], v[32:35], v[184:187]
    v_mfma_f32_16x16x32_bf16 v[180:183], a[132:135], v[32:35], v[180:183]
    buffer_load_dwordx4 v[60:63], v8, s[36:39], s17 offen sc1
    v_mfma_f32_16x16x32_bf16 v[180:183], a[152:155], v[36:39], v[180:183]
    v_mfma_f32_16x16x32_bf16 v[176:179], a[148:151], v[36:39], v[176:179]
    v_mfma_f32_16x16x32_bf16 v[176:179], a[128:131], v[32:35], v[176:179]
    s_waitcnt vmcnt(12)
    v_mfma_f32_16x16x32_bf16 v[196:199], a[168:171], v[72:75], v[196:199]
    v_mfma_f32_16x16x32_bf16 v[196:199], a[188:191], v[76:79], v[196:199]
    v_mfma_f32_16x16x32_bf16 v[200:203], a[192:195], v[76:79], v[200:203]
    buffer_load_dwordx4 v[32:35], v5, s[36:39], s16 offen sc1
    v_mfma_f32_16x16x32_bf16 v[200:203], a[172:175], v[72:75], v[200:203]
    v_mfma_f32_16x16x32_bf16 v[204:207], a[176:179], v[72:75], v[204:207]
    v_mfma_f32_16x16x32_bf16 v[204:207], a[196:199], v[76:79], v[204:207]
    v_mfma_f32_16x16x32_bf16 v[208:211], a[200:203], v[76:79], v[208:211]
    buffer_load_dwordx4 v[36:39], v5, s[36:39], s17 offen sc1
    v_mfma_f32_16x16x32_bf16 v[208:211], a[180:183], v[72:75], v[208:211]
    v_mfma_f32_16x16x32_bf16 v[212:215], a[184:187], v[72:75], v[212:215]
    v_mfma_f32_16x16x32_bf16 v[212:215], a[204:207], v[76:79], v[212:215]
    s_waitcnt vmcnt(12)
    v_mfma_f32_16x16x32_bf16 v[232:235], a[204:207], v[84:87], v[232:235]
    v_mfma_f32_16x16x32_bf16 v[232:235], a[184:187], v[80:83], v[232:235]
    s_add_u32 s14, s13, 32768
    v_mfma_f32_16x16x32_bf16 v[228:231], a[180:183], v[80:83], v[228:231]
    buffer_load_dwordx4 v[72:75], v6, s[36:39], s14 offen sc1
    v_mfma_f32_16x16x32_bf16 v[228:231], a[200:203], v[84:87], v[228:231]
    v_mfma_f32_16x16x32_bf16 v[224:227], a[196:199], v[84:87], v[224:227]
    v_mfma_f32_16x16x32_bf16 v[224:227], a[176:179], v[80:83], v[224:227]
    s_add_u32 s15, s13, 36864
    v_mfma_f32_16x16x32_bf16 v[220:223], a[172:175], v[80:83], v[220:223]
    buffer_load_dwordx4 v[76:79], v6, s[36:39], s15 offen sc1
    v_mfma_f32_16x16x32_bf16 v[220:223], a[192:195], v[84:87], v[220:223]
    v_mfma_f32_16x16x32_bf16 v[216:219], a[188:191], v[84:87], v[216:219]
    v_mfma_f32_16x16x32_bf16 v[216:219], a[168:171], v[80:83], v[216:219]
    s_waitcnt vmcnt(12)
    v_mfma_f32_16x16x32_bf16 v[236:239], a[168:171], v[88:91], v[236:239]
    v_mfma_f32_16x16x32_bf16 v[236:239], a[188:191], v[92:95], v[236:239]
    v_mfma_f32_16x16x32_bf16 v[240:243], a[192:195], v[92:95], v[240:243]
    buffer_load_dwordx4 v[80:83], v7, s[36:39], s14 offen sc1
    v_mfma_f32_16x16x32_bf16 v[240:243], a[172:175], v[88:91], v[240:243]
    v_mfma_f32_16x16x32_bf16 v[244:247], a[176:179], v[88:91], v[244:247]
    v_mfma_f32_16x16x32_bf16 v[244:247], a[196:199], v[92:95], v[244:247]
    v_mfma_f32_16x16x32_bf16 v[248:251], a[200:203], v[92:95], v[248:251]
    buffer_load_dwordx4 v[84:87], v7, s[36:39], s15 offen sc1
    v_mfma_f32_16x16x32_bf16 v[248:251], a[180:183], v[88:91], v[248:251]
    v_mfma_f32_16x16x32_bf16 v[252:255], a[184:187], v[88:91], v[252:255]
    v_mfma_f32_16x16x32_bf16 v[252:255], a[204:207], v[92:95], v[252:255]
    s_waitcnt vmcnt(12)
    v_mfma_f32_16x16x32_bf16 v[192:195], a[204:207], v[68:71], v[192:195]
    v_mfma_f32_16x16x32_bf16 v[192:195], a[184:187], v[64:67], v[192:195]
    v_mfma_f32_16x16x32_bf16 v[188:191], a[180:183], v[64:67], v[188:191]
    buffer_load_dwordx4 v[88:91], v8, s[36:39], s14 offen sc1
    v_mfma_f32_16x16x32_bf16 v[188:191], a[200:203], v[68:71], v[188:191]
    v_mfma_f32_16x16x32_bf16 v[184:187], a[196:199], v[68:71], v[184:187]
    v_mfma_f32_16x16x32_bf16 v[184:187], a[176:179], v[64:67], v[184:187]
    v_mfma_f32_16x16x32_bf16 v[180:183], a[172:175], v[64:67], v[180:183]
    buffer_load_dwordx4 v[92:95], v8, s[36:39], s15 offen sc1
    v_mfma_f32_16x16x32_bf16 v[180:183], a[192:195], v[68:71], v[180:183]
    v_mfma_f32_16x16x32_bf16 v[176:179], a[188:191], v[68:71], v[176:179]
    v_mfma_f32_16x16x32_bf16 v[176:179], a[168:171], v[64:67], v[176:179]
    s_waitcnt vmcnt(12)
    v_mfma_f32_16x16x32_bf16 v[196:199], a[208:211], v[40:43], v[196:199]
    v_mfma_f32_16x16x32_bf16 v[196:199], a[228:231], v[44:47], v[196:199]
    v_mfma_f32_16x16x32_bf16 v[200:203], a[232:235], v[44:47], v[200:203]
    buffer_load_dwordx4 v[64:67], v5, s[36:39], s14 offen sc1
    v_mfma_f32_16x16x32_bf16 v[200:203], a[212:215], v[40:43], v[200:203]
    v_mfma_f32_16x16x32_bf16 v[204:207], a[216:219], v[40:43], v[204:207]
    v_mfma_f32_16x16x32_bf16 v[204:207], a[236:239], v[44:47], v[204:207]
    v_mfma_f32_16x16x32_bf16 v[208:211], a[240:243], v[44:47], v[208:211]
    buffer_load_dwordx4 v[68:71], v5, s[36:39], s15 offen sc1
    v_mfma_f32_16x16x32_bf16 v[208:211], a[220:223], v[40:43], v[208:211]
    v_mfma_f32_16x16x32_bf16 v[212:215], a[224:227], v[40:43], v[212:215]
    v_mfma_f32_16x16x32_bf16 v[212:215], a[244:247], v[44:47], v[212:215]
    s_waitcnt vmcnt(12)
    v_mfma_f32_16x16x32_bf16 v[232:235], a[244:247], v[52:55], v[232:235]
    v_mfma_f32_16x16x32_bf16 v[232:235], a[224:227], v[48:51], v[232:235]
    s_add_u32 s16, s13, 40960
    v_mfma_f32_16x16x32_bf16 v[228:231], a[220:223], v[48:51], v[228:231]
    buffer_load_dwordx4 v[40:43], v6, s[36:39], s16 offen sc1
    v_mfma_f32_16x16x32_bf16 v[228:231], a[240:243], v[52:55], v[228:231]
    v_mfma_f32_16x16x32_bf16 v[224:227], a[236:239], v[52:55], v[224:227]
    v_mfma_f32_16x16x32_bf16 v[224:227], a[216:219], v[48:51], v[224:227]
    s_add_u32 s17, s13, 45056
    v_mfma_f32_16x16x32_bf16 v[220:223], a[212:215], v[48:51], v[220:223]
    buffer_load_dwordx4 v[44:47], v6, s[36:39], s17 offen sc1
    v_mfma_f32_16x16x32_bf16 v[220:223], a[232:235], v[52:55], v[220:223]
    v_mfma_f32_16x16x32_bf16 v[216:219], a[228:231], v[52:55], v[216:219]
    v_mfma_f32_16x16x32_bf16 v[216:219], a[208:211], v[48:51], v[216:219]
    s_waitcnt vmcnt(12)
    v_mfma_f32_16x16x32_bf16 v[236:239], a[208:211], v[56:59], v[236:239]
    ds_read_b128 v[142:145], v28
    ds_read_b128 v[146:149], v28 offset:64
    v_mfma_f32_16x16x32_bf16 v[236:239], a[228:231], v[60:63], v[236:239]
    ds_read_b64 v[150:151], v29 offset:128
    v_mul_f32 v22, v22, v22
    v_mfma_f32_16x16x32_bf16 v[240:243], a[232:235], v[60:63], v[240:243]
    buffer_load_dword v14, v13, s[44:47], 0 offen sc1
    v_mfma_f32_16x16x32_bf16 v[240:243], a[212:215], v[56:59], v[240:243]
    v_mul_f32 v23, 0xbfb8aa3b, v22
    v_mfma_f32_16x16x32_bf16 v[244:247], a[216:219], v[56:59], v[244:247]
    v_rcp_f32 v22, v22
    v_mfma_f32_16x16x32_bf16 v[244:247], a[236:239], v[60:63], v[244:247]
    v_mfma_f32_16x16x32_bf16 v[248:251], a[240:243], v[60:63], v[248:251]
    buffer_load_dwordx4 v[48:51], v7, s[36:39], s16 offen sc1
    v_mfma_f32_16x16x32_bf16 v[248:251], a[220:223], v[56:59], v[248:251]
    v_mfma_f32_16x16x32_bf16 v[252:255], a[224:227], v[56:59], v[252:255]
    v_mfma_f32_16x16x32_bf16 v[252:255], a[244:247], v[60:63], v[252:255]
    s_waitcnt vmcnt(12)
    v_mfma_f32_16x16x32_bf16 v[192:195], a[244:247], v[36:39], v[192:195]
    buffer_load_dwordx4 v[52:55], v7, s[36:39], s17 offen sc1
    v_mfma_f32_16x16x32_bf16 v[192:195], a[224:227], v[32:35], v[192:195]
    s_waitcnt lgkmcnt(0)
    v_lshlrev_b32 v156, 16, v142
    v_mfma_f32_16x16x32_bf16 v[188:191], a[220:223], v[32:35], v[188:191]
    v_and_b32 v157, 0xffff0000, v142
    v_lshlrev_b32 v158, 16, v143
    v_mfma_f32_16x16x32_bf16 v[188:191], a[240:243], v[36:39], v[188:191]
    s_add_u32 s14, s89, 49152
    v_and_b32 v159, 0xffff0000, v143
    v_lshlrev_b32 v160, 16, v144
    v_mfma_f32_16x16x32_bf16 v[184:187], a[236:239], v[36:39], v[184:187]
    buffer_load_dwordx4 a[96:99], v7, s[36:39], s14 offen sc1
    v_mfma_f32_16x16x32_bf16 v[184:187], a[216:219], v[32:35], v[184:187]
    v_and_b32 v161, 0xffff0000, v144
    v_lshlrev_b32 v162, 16, v145
    v_mfma_f32_16x16x32_bf16 v[180:183], a[212:215], v[32:35], v[180:183]
    v_and_b32 v163, 0xffff0000, v145
    v_lshlrev_b32 v164, 16, v146
    v_mfma_f32_16x16x32_bf16 v[180:183], a[232:235], v[36:39], v[180:183]
    v_and_b32 v165, 0xffff0000, v146
    v_lshlrev_b32 v166, 16, v147
    v_mfma_f32_16x16x32_bf16 v[176:179], a[228:231], v[36:39], v[176:179]
    buffer_load_dwordx4 v[56:59], v8, s[36:39], s16 offen sc1
    v_mfma_f32_16x16x32_bf16 v[176:179], a[208:211], v[32:35], v[176:179]
    s_waitcnt vmcnt(13)
    v_and_b32 v167, 0xffff0000, v147
    v_lshlrev_b32 v168, 16, v148
    v_mfma_f32_16x16x32_bf16 v[196:199], a[0:3], v[72:75], v[196:199]
    v_and_b32 v169, 0xffff0000, v148
    v_lshlrev_b32 v170, 16, v149
    v_mfma_f32_16x16x32_bf16 v[196:199], a[20:23], v[76:79], v[196:199]
    ds_read_b128 a[168:171], v140 offset:24576
    v_and_b32 v171, 0xffff0000, v149
    v_mfma_f32_16x16x32_bf16 v[200:203], a[24:27], v[76:79], v[200:203]
    buffer_load_dwordx4 v[60:63], v8, s[36:39], s17 offen sc1
    v_mfma_f32_16x16x32_bf16 v[200:203], a[4:7], v[72:75], v[200:203]
    ds_read_b128 a[172:175], v140 offset:29696
    v_lshlrev_b32 v172, 16, v150
    v_mfma_f32_16x16x32_bf16 v[204:207], a[8:11], v[72:75], v[204:207]
    ds_read_b128 a[176:179], v140 offset:34816
    v_and_b32 v173, 0xffff0000, v150
    v_mfma_f32_16x16x32_bf16 v[204:207], a[28:31], v[76:79], v[204:207]
    ds_read_b128 a[180:183], v140 offset:39936
    v_lshlrev_b32 v174, 16, v151
    v_mfma_f32_16x16x32_bf16 v[208:211], a[32:35], v[76:79], v[208:211]
    buffer_load_dwordx4 a[100:103], v8, s[36:39], s14 offen sc1
    v_mfma_f32_16x16x32_bf16 v[208:211], a[12:15], v[72:75], v[208:211]
    ds_read_b128 a[184:187], v140 offset:38912
    v_and_b32 v175, 0xffff0000, v151
    v_mfma_f32_16x16x32_bf16 v[212:215], a[16:19], v[72:75], v[212:215]
    ds_read_b128 a[188:191], v140 offset:33792
    v_mfma_f32_16x16x32_bf16 v[212:215], a[36:39], v[76:79], v[212:215]
    s_waitcnt vmcnt(13)
    ds_read_b128 a[192:195], v140 offset:28672
    v_mfma_f32_16x16x32_bf16 v[232:235], a[36:39], v[84:87], v[232:235]
    buffer_load_dwordx4 a[92:95], v6, s[36:39], s14 offen sc1
    v_mfma_f32_16x16x32_bf16 v[232:235], a[16:19], v[80:83], v[232:235]
    ds_read_b128 a[196:199], v140 offset:23552
    v_mfma_f32_16x16x32_bf16 v[228:231], a[12:15], v[80:83], v[228:231]
    ds_read_b128 a[200:203], v140 offset:22528
    v_mfma_f32_16x16x32_bf16 v[228:231], a[32:35], v[84:87], v[228:231]
    ds_read_b128 a[204:207], v140 offset:27648
    v_mfma_f32_16x16x32_bf16 v[224:227], a[28:31], v[84:87], v[224:227]
    buffer_load_dwordx4 v[152:155], v6, s[36:39], s29 offen sc1
    v_mfma_f32_16x16x32_bf16 v[224:227], a[8:11], v[80:83], v[224:227]
    ds_read_b128 a[208:211], v140 offset:32768
    v_mfma_f32_16x16x32_bf16 v[220:223], a[4:7], v[80:83], v[220:223]
    ds_read_b128 a[212:215], v140 offset:37888
    v_mfma_f32_16x16x32_bf16 v[220:223], a[24:27], v[84:87], v[220:223]
    ds_read_b128 a[216:219], v140 offset:36864
    v_mfma_f32_16x16x32_bf16 v[216:219], a[20:23], v[84:87], v[216:219]
    buffer_load_dwordx4 v[32:35], v5, s[36:39], s16 offen sc1
    v_mfma_f32_16x16x32_bf16 v[216:219], a[0:3], v[80:83], v[216:219]
    s_waitcnt vmcnt(14)
    ds_read_b128 a[220:223], v140 offset:31744
    v_mfma_f32_16x16x32_bf16 v[236:239], a[0:3], v[88:91], v[236:239]
    ds_read_b128 a[224:227], v140 offset:26624
    v_mfma_f32_16x16x32_bf16 v[236:239], a[20:23], v[92:95], v[236:239]
    ds_read_b128 a[228:231], v140 offset:21504
    v_mfma_f32_16x16x32_bf16 v[240:243], a[24:27], v[92:95], v[240:243]
    buffer_load_dwordx4 v[36:39], v5, s[36:39], s17 offen sc1
    v_mfma_f32_16x16x32_bf16 v[240:243], a[4:7], v[88:91], v[240:243]
    ds_read_b128 a[232:235], v140 offset:20480
    v_mfma_f32_16x16x32_bf16 v[244:247], a[8:11], v[88:91], v[244:247]
    ds_read_b128 a[236:239], v140 offset:25600
    v_mfma_f32_16x16x32_bf16 v[244:247], a[28:31], v[92:95], v[244:247]
    ds_read_b128 a[240:243], v140 offset:30720
    v_mfma_f32_16x16x32_bf16 v[248:251], a[32:35], v[92:95], v[248:251]
    buffer_load_dwordx4 a[88:91], v5, s[36:39], s14 offen sc1
    v_mfma_f32_16x16x32_bf16 v[248:251], a[12:15], v[88:91], v[248:251]
    ds_read_b128 a[244:247], v140 offset:35840
    v_mfma_f32_16x16x32_bf16 v[252:255], a[16:19], v[88:91], v[252:255]
    v_mfma_f32_16x16x32_bf16 v[252:255], a[36:39], v[92:95], v[252:255]
    s_waitcnt vmcnt(14)
    v_mfma_f32_16x16x32_bf16 v[192:195], a[36:39], v[68:71], v[192:195]
    buffer_load_dwordx4 a[248:251], v5, s[36:39], s29 offen sc1
    v_mfma_f32_16x16x32_bf16 v[192:195], a[16:19], v[64:67], v[192:195]
    v_mfma_f32_16x16x32_bf16 v[188:191], a[12:15], v[64:67], v[188:191]
    v_mfma_f32_16x16x32_bf16 v[188:191], a[32:35], v[68:71], v[188:191]
    v_mfma_f32_16x16x32_bf16 v[184:187], a[28:31], v[68:71], v[184:187]
    v_mfma_f32_16x16x32_bf16 v[184:187], a[8:11], v[64:67], v[184:187]
    v_mfma_f32_16x16x32_bf16 v[180:183], a[4:7], v[64:67], v[180:183]
    v_mfma_f32_16x16x32_bf16 v[180:183], a[24:27], v[68:71], v[180:183]
    v_mfma_f32_16x16x32_bf16 v[176:179], a[20:23], v[68:71], v[176:179]
    v_mfma_f32_16x16x32_bf16 v[176:179], a[0:3], v[64:67], v[176:179]
    s_waitcnt vmcnt(12)
    v_cmp_ne_u32 vcc, 1, v14
    s_nop 0
    s_cbranch_vccnz L_fspin_sglu
L_fback_sglu:
    s_waitcnt vmcnt(10)
    v_mfma_f32_16x16x32_bf16 v[216:219], a[40:43], v[48:51], v[216:219]
    v_mfma_f32_16x16x32_bf16 v[216:219], a[60:63], v[52:55], v[216:219]
    s_add_u32 s70, s3, 16384
    ds_read_b128 a[0:3], v140 offset:40960
    s_waitcnt vmcnt(9)
    v_mfma_f32_16x16x32_bf16 v[216:219], v[96:99], a[96:99], v[216:219]
    buffer_load_dwordx4 a[104:107], v5, s[36:39], s70 offen sc1
    v_mfma_f32_16x16x32_bf16 v[220:223], v[100:103], a[96:99], v[220:223]
    ds_read_b128 a[4:7], v140 offset:46080
    v_mfma_f32_16x16x32_bf16 v[220:223], a[64:67], v[52:55], v[220:223]
    ds_read_b128 a[8:11], v141 offset:0
    v_mfma_f32_16x16x32_bf16 v[220:223], a[44:47], v[48:51], v[220:223]
    s_add_u32 s70, s3, 20480
    ds_read_b128 a[12:15], v141 offset:5120
    v_mfma_f32_16x16x32_bf16 v[224:227], a[48:51], v[48:51], v[224:227]
    buffer_load_dwordx4 a[108:111], v5, s[36:39], s70 offen sc1
    v_mfma_f32_16x16x32_bf16 v[224:227], a[68:71], v[52:55], v[224:227]
    ds_read_b128 a[16:19], v141 offset:6144
    v_mfma_f32_16x16x32_bf16 v[224:227], v[104:107], a[96:99], v[224:227]
    ds_read_b128 a[20:23], v141 offset:1024
    v_mfma_f32_16x16x32_bf16 v[228:231], v[108:111], a[96:99], v[228:231]
    ds_read_b128 a[24:27], v140 offset:47104
    v_mfma_f32_16x16x32_bf16 v[228:231], a[72:75], v[52:55], v[228:231]
    s_add_u32 s70, s3, 24576
    ds_write_b128 v25, v[216:219] offset:0
    v_mfma_f32_16x16x32_bf16 v[228:231], a[52:55], v[48:51], v[228:231]
    buffer_load_dwordx4 a[112:115], v5, s[36:39], s70 offen sc1
    v_mfma_f32_16x16x32_bf16 v[232:235], a[56:59], v[48:51], v[232:235]
    ds_read_b128 a[28:31], v140 offset:41984
    v_mfma_f32_16x16x32_bf16 v[232:235], a[76:79], v[52:55], v[232:235]
    ds_read_b128 a[32:35], v140 offset:43008
    v_mfma_f32_16x16x32_bf16 v[232:235], v[112:115], a[96:99], v[232:235]
    s_add_u32 s70, s3, 28672
    ds_write_b128 v25, v[220:223] offset:1024
    s_waitcnt vmcnt(10)
    v_mfma_f32_16x16x32_bf16 v[236:239], a[40:43], v[56:59], v[236:239]
    buffer_load_dwordx4 a[116:119], v5, s[36:39], s70 offen sc1
    v_mfma_f32_16x16x32_bf16 v[236:239], a[60:63], v[60:63], v[236:239]
    s_waitcnt vmcnt(10)
    ds_read_b128 a[36:39], v140 offset:48128
    v_mfma_f32_16x16x32_bf16 v[236:239], v[96:99], a[100:103], v[236:239]
    v_mfma_f32_16x16x32_bf16 v[240:243], v[100:103], a[100:103], v[240:243]
    s_add_u32 s70, s3, 32768
    ds_write_b128 v25, v[224:227] offset:2048
    v_mfma_f32_16x16x32_bf16 v[240:243], a[64:67], v[60:63], v[240:243]
    buffer_load_dwordx4 a[120:123], v5, s[36:39], s70 offen sc1
    v_mfma_f32_16x16x32_bf16 v[240:243], a[44:47], v[56:59], v[240:243]
    v_mfma_f32_16x16x32_bf16 v[244:247], a[48:51], v[56:59], v[244:247]
    v_mfma_f32_16x16x32_bf16 v[244:247], a[68:71], v[60:63], v[244:247]
    s_add_u32 s70, s3, 36864
    ds_write_b128 v25, v[228:231] offset:3072
    v_mfma_f32_16x16x32_bf16 v[244:247], v[104:107], a[100:103], v[244:247]
    buffer_load_dwordx4 a[124:127], v5, s[36:39], s70 offen sc1
    v_mfma_f32_16x16x32_bf16 v[248:251], v[108:111], a[100:103], v[248:251]
    v_mfma_f32_16x16x32_bf16 v[248:251], a[72:75], v[60:63], v[248:251]
    v_mfma_f32_16x16x32_bf16 v[248:251], a[52:55], v[56:59], v[248:251]
    s_add_u32 s70, s3, 40960
    ds_write_b128 v25, v[232:235] offset:4096
    v_mfma_f32_16x16x32_bf16 v[252:255], a[56:59], v[56:59], v[252:255]
    buffer_load_dwordx4 a[128:131], v5, s[36:39], s70 offen sc1
    v_mfma_f32_16x16x32_bf16 v[252:255], a[76:79], v[60:63], v[252:255]
    v_mfma_f32_16x16x32_bf16 v[252:255], v[112:115], a[100:103], v[252:255]
    v_mfma_f32_16x16x32_bf16 v[196:199], a[40:43], v[40:43], v[196:199]
    s_add_u32 s70, s3, 45056
    ds_write_b128 v26, v[236:239] offset:0
    v_mfma_f32_16x16x32_bf16 v[196:199], a[60:63], v[44:47], v[196:199]
    s_waitcnt vmcnt(11)
    buffer_load_dwordx4 a[132:135], v5, s[36:39], s70 offen sc1
    v_mfma_f32_16x16x32_bf16 v[196:199], v[96:99], a[92:95], v[196:199]
    v_mfma_f32_16x16x32_bf16 v[196:199], v[116:119], v[152:155], v[196:199]
    v_mfma_f32_16x16x32_bf16 v[200:203], v[120:123], v[152:155], v[200:203]
    s_add_u32 s70, s3, 49152
    ds_write_b128 v26, v[240:243] offset:1024
    v_mfma_f32_16x16x32_bf16 v[200:203], v[100:103], a[92:95], v[200:203]
    buffer_load_dwordx4 a[136:139], v5, s[36:39], s70 offen sc1
    v_mfma_f32_16x16x32_bf16 v[200:203], a[64:67], v[44:47], v[200:203]
    v_mfma_f32_16x16x32_bf16 v[200:203], a[44:47], v[40:43], v[200:203]
    v_mfma_f32_16x16x32_bf16 v[204:207], a[48:51], v[40:43], v[204:207]
    s_add_u32 s70, s3, 53248
    ds_write_b128 v26, v[244:247] offset:2048
    v_mfma_f32_16x16x32_bf16 v[204:207], a[68:71], v[44:47], v[204:207]
    buffer_load_dwordx4 a[140:143], v5, s[36:39], s70 offen sc1
    v_mfma_f32_16x16x32_bf16 v[204:207], v[104:107], a[92:95], v[204:207]
    v_mfma_f32_16x16x32_bf16 v[204:207], v[124:127], v[152:155], v[204:207]
    v_mfma_f32_16x16x32_bf16 v[208:211], v[128:131], v[152:155], v[208:211]
    s_add_u32 s70, s3, 57344
    ds_write_b128 v26, v[248:251] offset:3072
    v_mfma_f32_16x16x32_bf16 v[208:211], v[108:111], a[92:95], v[208:211]
    buffer_load_dwordx4 a[144:147], v5, s[36:39], s70 offen sc1
    v_mfma_f32_16x16x32_bf16 v[208:211], a[72:75], v[44:47], v[208:211]
    v_mfma_f32_16x16x32_bf16 v[208:211], a[52:55], v[40:43], v[208:211]
    v_mfma_f32_16x16x32_bf16 v[212:215], a[56:59], v[40:43], v[212:215]
    s_add_u32 s70, s3, 61440
    ds_write_b128 v26, v[252:255] offset:4096
    v_mfma_f32_16x16x32_bf16 v[212:215], a[76:79], v[44:47], v[212:215]
    buffer_load_dwordx4 a[148:151], v5, s[36:39], s70 offen sc1
    v_mfma_f32_16x16x32_bf16 v[212:215], v[112:115], a[92:95], v[212:215]
    v_mfma_f32_16x16x32_bf16 v[212:215], v[132:135], v[152:155], v[212:215]
    s_waitcnt vmcnt(14)
    v_mfma_f32_16x16x32_bf16 v[176:179], a[40:43], v[32:35], v[176:179]
    ds_write_b128 v24, v[196:199] offset:0
    v_mfma_f32_16x16x32_bf16 v[176:179], a[60:63], v[36:39], v[176:179]
    s_waitcnt vmcnt(12)
    v_mfma_f32_16x16x32_bf16 v[176:179], v[96:99], a[88:91], v[176:179]
    v_mfma_f32_16x16x32_bf16 v[176:179], v[116:119], a[248:251], v[176:179]
    v_mfma_f32_16x16x32_bf16 v[180:183], v[120:123], a[248:251], v[180:183]
    ds_write_b128 v24, v[200:203] offset:1024
    v_mfma_f32_16x16x32_bf16 v[180:183], v[100:103], a[88:91], v[180:183]
    v_mfma_f32_16x16x32_bf16 v[180:183], a[64:67], v[36:39], v[180:183]
    v_mfma_f32_16x16x32_bf16 v[180:183], a[44:47], v[32:35], v[180:183]
    v_mfma_f32_16x16x32_bf16 v[184:187], a[48:51], v[32:35], v[184:187]
    ds_write_b128 v24, v[204:207] offset:2048
    v_mfma_f32_16x16x32_bf16 v[184:187], a[68:71], v[36:39], v[184:187]
    v_mfma_f32_16x16x32_bf16 v[184:187], v[104:107], a[88:91], v[184:187]
    v_mfma_f32_16x16x32_bf16 v[184:187], v[124:127], a[248:251], v[184:187]
    v_mfma_f32_16x16x32_bf16 v[188:191], v[128:131], a[248:251], v[188:191]
    ds_write_b128 v24, v[208:211] offset:3072
    v_mfma_f32_16x16x32_bf16 v[188:191], v[108:111], a[88:91], v[188:191]
    v_mfma_f32_16x16x32_bf16 v[188:191], a[72:75], v[36:39], v[188:191]
    v_mfma_f32_16x16x32_bf16 v[188:191], a[52:55], v[32:35], v[188:191]
    v_mfma_f32_16x16x32_bf16 v[192:195], a[56:59], v[32:35], v[192:195]
    ds_write_b128 v24, v[212:215] offset:4096
    v_mfma_f32_16x16x32_bf16 v[192:195], a[76:79], v[36:39], v[192:195]
    v_mfma_f32_16x16x32_bf16 v[192:195], v[112:115], a[88:91], v[192:195]
    v_mfma_f32_16x16x32_bf16 v[192:195], v[132:135], a[248:251], v[192:195]
    s_waitcnt vmcnt(11) lgkmcnt(15)
    v_mfma_f32_16x16x32_bf16 v[80:83], a[168:171], a[104:107], 0
    s_waitcnt lgkmcnt(0)
    s_barrier
    s_waitcnt vmcnt(10)
    v_mfma_f32_16x16x32_bf16 v[80:83], a[172:175], a[108:111], v[80:83]
    s_add_u32 s70, s3, 65536
    ds_read_b128 v[196:199], v27 offset:0
    ds_read_b128 v[216:219], v27 offset:5120
    s_waitcnt vmcnt(9)
    v_mfma_f32_16x16x32_bf16 v[80:83], a[176:179], a[112:115], v[80:83]
    s_waitcnt vmcnt(8)
    buffer_load_dwordx4 v[96:99], v9, s[36:39], s70 offen sc1
    v_mfma_f32_16x16x32_bf16 v[80:83], a[180:183], a[116:119], v[80:83]
    ds_read_b128 v[236:239], v27 offset:10240
    ds_read_b128 v[200:203], v27 offset:1024
    v_mfma_f32_16x16x32_bf16 v[76:79], a[184:187], a[116:119], 0
    s_add_u32 m0, s67, 61440
    ds_read_b128 v[220:223], v27 offset:6144
    ds_read_b128 v[240:243], v27 offset:11264
    v_mfma_f32_16x16x32_bf16 v[76:79], a[188:191], a[112:115], v[76:79]
    s_add_u32 s86, s88, 0
    ds_read_b128 v[204:207], v27 offset:2048
    ds_read_b128 v[224:227], v27 offset:7168
    v_mfma_f32_16x16x32_bf16 v[76:79], a[192:195], a[108:111], v[76:79]
    buffer_load_dwordx4 v3, s[40:43], s86 offen sc1 lds
    v_mfma_f32_16x16x32_bf16 v[76:79], a[196:199], a[104:107], v[76:79]
    ds_read_b128 v[244:247], v27 offset:12288
    ds_read_b128 v[208:211], v27 offset:3072
    v_mfma_f32_16x16x32_bf16 v[72:75], a[200:203], a[104:107], 0
    s_add_u32 m0, s67, 65536
    ds_read_b128 v[228:231], v27 offset:8192
    ds_read_b128 v[248:251], v27 offset:13312
    v_mfma_f32_16x16x32_bf16 v[72:75], a[204:207], a[108:111], v[72:75]
    s_add_u32 s86, s88, 4096
    ds_read_b128 v[212:215], v27 offset:4096
    ds_read_b128 v[232:235], v27 offset:9216
    v_mfma_f32_16x16x32_bf16 v[72:75], a[208:211], a[112:115], v[72:75]
    buffer_load_dwordx4 v3, s[40:43], s86 offen sc1 lds
    v_mfma_f32_16x16x32_bf16 v[72:75], a[212:215], a[116:119], v[72:75]
    ds_read_b128 v[252:255], v27 offset:14336
    v_mfma_f32_16x16x32_bf16 v[68:71], a[216:219], a[116:119], 0
    s_add_u32 m0, s67, 69632
    v_mfma_f32_16x16x32_bf16 v[68:71], a[220:223], a[112:115], v[68:71]
    s_add_u32 s86, s88, 8192
    v_mfma_f32_16x16x32_bf16 v[68:71], a[224:227], a[108:111], v[68:71]
    buffer_load_dwordx4 v3, s[40:43], s86 offen sc1 lds
    s_waitcnt lgkmcnt(12)
    v_pk_add_f32 v[176:177], v[176:177], v[196:197]
    v_pk_add_f32 v[178:179], v[178:179], v[198:199]
    v_pk_add_f32 v[176:177], v[176:177], v[216:217]
    v_pk_add_f32 v[178:179], v[178:179], v[218:219]
    v_pk_add_f32 v[176:177], v[176:177], v[236:237]
    v_pk_add_f32 v[178:179], v[178:179], v[238:239]
    v_pk_mul_f32 v[32:33], v[176:177], v[22:23] op_sel:[0,1] op_sel_hi:[1,1]
    v_pk_mul_f32 v[34:35], v[178:179], v[22:23] op_sel:[0,1] op_sel_hi:[1,1]
    s_waitcnt lgkmcnt(9)
    v_pk_add_f32 v[180:181], v[180:181], v[200:201]
    v_pk_add_f32 v[182:183], v[182:183], v[202:203]
    v_pk_add_f32 v[180:181], v[180:181], v[220:221]
    v_pk_add_f32 v[182:183], v[182:183], v[222:223]
    v_pk_add_f32 v[180:181], v[180:181], v[240:241]
    v_pk_add_f32 v[182:183], v[182:183], v[242:243]
    v_pk_mul_f32 v[36:37], v[180:181], v[22:23] op_sel:[0,1] op_sel_hi:[1,1]
    v_pk_mul_f32 v[38:39], v[182:183], v[22:23] op_sel:[0,1] op_sel_hi:[1,1]
    s_waitcnt lgkmcnt(6)
    v_pk_add_f32 v[184:185], v[184:185], v[204:205]
    v_pk_add_f32 v[186:187], v[186:187], v[206:207]
    v_pk_add_f32 v[184:185], v[184:185], v[224:225]
    v_pk_add_f32 v[186:187], v[186:187], v[226:227]
    v_pk_add_f32 v[184:185], v[184:185], v[244:245]
    v_pk_add_f32 v[186:187], v[186:187], v[246:247]
    v_pk_mul_f32 v[40:41], v[184:185], v[22:23] op_sel:[0,1] op_sel_hi:[1,1]
    v_pk_mul_f32 v[42:43], v[186:187], v[22:23] op_sel:[0,1] op_sel_hi:[1,1]
    s_waitcnt lgkmcnt(3)
    v_pk_add_f32 v[188:189], v[188:189], v[208:209]
    v_pk_add_f32 v[190:191], v[190:191], v[210:211]
    v_pk_add_f32 v[188:189], v[188:189], v[228:229]
    v_pk_add_f32 v[190:191], v[190:191], v[230:231]
    v_pk_add_f32 v[188:189], v[188:189], v[248:249]
    v_pk_add_f32 v[190:191], v[190:191], v[250:251]
    v_pk_mul_f32 v[44:45], v[188:189], v[22:23] op_sel:[0,1] op_sel_hi:[1,1]
    v_pk_mul_f32 v[46:47], v[190:191], v[22:23] op_sel:[0,1] op_sel_hi:[1,1]
    s_waitcnt lgkmcnt(0)
    v_pk_add_f32 v[192:193], v[192:193], v[212:213]
    v_pk_add_f32 v[194:195], v[194:195], v[214:215]
    v_pk_add_f32 v[192:193], v[192:193], v[232:233]
    v_pk_add_f32 v[194:195], v[194:195], v[234:235]
    v_pk_add_f32 v[192:193], v[192:193], v[252:253]
    v_pk_add_f32 v[194:195], v[194:195], v[254:255]
    v_pk_mul_f32 v[48:49], v[192:193], v[22:23] op_sel:[0,1] op_sel_hi:[1,1]
    v_pk_mul_f32 v[50:51], v[194:195], v[22:23] op_sel:[0,1] op_sel_hi:[1,1]
    v_mfma_f32_16x16x32_bf16 v[68:71], a[228:231], a[104:107], v[68:71]
    v_exp_f32 v51, v51
    v_mfma_f32_16x16x32_bf16 v[64:67], a[232:235], a[104:107], 0
    v_exp_f32 v50, v50
    v_mfma_f32_16x16x32_bf16 v[64:67], a[236:239], a[108:111], v[64:67]
    s_add_u32 s70, s3, 69632
    v_exp_f32 v49, v49
    v_mfma_f32_16x16x32_bf16 v[64:67], a[240:243], a[112:115], v[64:67]
    buffer_load_dwordx4 v[100:103], v9, s[36:39], s70 offen sc1
    v_mfma_f32_16x16x32_bf16 v[64:67], a[244:247], a[116:119], v[64:67]
    s_waitcnt vmcnt(12)
    v_exp_f32 v48, v48
    v_mfma_f32_16x16x32_bf16 v[64:67], a[0:3], a[120:123], v[64:67]
    s_waitcnt vmcnt(11)
    v_exp_f32 v47, v47
    v_mfma_f32_16x16x32_bf16 v[64:67], a[4:7], a[124:127], v[64:67]
    s_add_u32 s70, s3, 73728
    v_exp_f32 v46, v46
    s_waitcnt vmcnt(10)
    v_mfma_f32_16x16x32_bf16 v[64:67], a[8:11], a[128:131], v[64:67]
    s_waitcnt vmcnt(9)
    buffer_load_dwordx4 v[104:107], v9, s[36:39], s70 offen sc1
    v_mfma_f32_16x16x32_bf16 v[64:67], a[12:15], a[132:135], v[64:67]
    ds_read_b128 a[40:43], v141 offset:2048
    ds_read_b128 a[44:47], v141 offset:7168
    v_mfma_f32_16x16x32_bf16 v[68:71], a[16:19], a[132:135], v[68:71]
    ds_read_b128 a[48:51], v141 offset:8192
    ds_read_b128 a[52:55], v141 offset:3072
    v_mfma_f32_16x16x32_bf16 v[68:71], a[20:23], a[128:131], v[68:71]
    s_add_u32 s70, s3, 77824
    v_exp_f32 v45, v45
    v_mfma_f32_16x16x32_bf16 v[68:71], a[24:27], a[124:127], v[68:71]
    buffer_load_dwordx4 v[108:111], v9, s[36:39], s70 offen sc1
    v_mfma_f32_16x16x32_bf16 v[68:71], a[28:31], a[120:123], v[68:71]
    ds_read_b128 a[56:59], v140 offset:49152
    ds_read_b128 a[60:63], v140 offset:44032
    v_mfma_f32_16x16x32_bf16 v[72:75], a[32:35], a[120:123], v[72:75]
    ds_read_b128 a[64:67], v140 offset:45056
    ds_read_b128 a[68:71], v140 offset:50176
    v_mfma_f32_16x16x32_bf16 v[72:75], a[36:39], a[124:127], v[72:75]
    s_add_u32 s70, s3, 0
    v_exp_f32 v44, v44
    s_waitcnt lgkmcnt(6)
    v_mfma_f32_16x16x32_bf16 v[72:75], a[40:43], a[128:131], v[72:75]
    buffer_load_dwordx4 a[88:91], v5, s[36:39], s70 offen sc1
    v_mfma_f32_16x16x32_bf16 v[72:75], a[44:47], a[132:135], v[72:75]
    s_waitcnt lgkmcnt(4)
    ds_read_b128 a[72:75], v141 offset:4096
    ds_read_b128 a[76:79], v141 offset:9216
    v_mfma_f32_16x16x32_bf16 v[76:79], a[48:51], a[132:135], v[76:79]
    ds_read_b128 a[168:171], v141 offset:14336
L_pg5:
    s_cbranch_execz L_ret
    ds_read_b128 a[172:175], v141 offset:19456
    v_mfma_f32_16x16x32_bf16 v[76:79], a[52:55], a[128:131], v[76:79]
    s_add_u32 s70, s3, 4096
    v_exp_f32 v43, v43
    s_waitcnt lgkmcnt(6)
    v_mfma_f32_16x16x32_bf16 v[76:79], a[56:59], a[124:127], v[76:79]
    buffer_load_dwordx4 a[92:95], v5, s[36:39], s70 offen sc1
    v_mfma_f32_16x16x32_bf16 v[76:79], a[60:63], a[120:123], v[76:79]
    s_waitcnt lgkmcnt(4)
    ds_read_b128 a[176:179], v141 offset:24576
    ds_read_b128 a[180:183], v141 offset:29696
    v_mfma_f32_16x16x32_bf16 v[80:83], a[64:67], a[120:123], v[80:83]
    ds_read_b128 a[184:187], v141 offset:28672
    ds_read_b128 a[188:191], v141 offset:23552
    v_mfma_f32_16x16x32_bf16 v[80:83], a[68:71], a[124:127], v[80:83]
    s_add_u32 s70, s3, 8192
    v_exp_f32 v42, v42
    s_waitcnt lgkmcnt(6)
    v_mfma_f32_16x16x32_bf16 v[80:83], a[72:75], a[128:131], v[80:83]
    buffer_load_dwordx4 a[96:99], v5, s[36:39], s70 offen sc1
    v_mfma_f32_16x16x32_bf16 v[80:83], a[76:79], a[132:135], v[80:83]
    s_waitcnt vmcnt(13) lgkmcnt(4)
    ds_read_b128 a[192:195], v141 offset:18432
    ds_read_b128 a[196:199], v141 offset:13312
    v_mfma_f32_16x16x32_bf16 v[80:83], a[168:171], a[136:139], v[80:83]
    s_waitcnt vmcnt(12)
    ds_read_b128 a[200:203], v141 offset:12288
    ds_read_b128 a[204:207], v141 offset:17408
    v_mfma_f32_16x16x32_bf16 v[80:83], a[172:175], a[140:143], v[80:83]
    s_add_u32 s70, s3, 12288
    s_waitcnt vmcnt(9)
    v_permlane32_swap_b32 v96, v98
    s_waitcnt lgkmcnt(6)
    v_mfma_f32_16x16x32_bf16 v[80:83], a[176:179], a[144:147], v[80:83]
    buffer_load_dwordx4 a[100:103], v5, s[36:39], s70 offen sc1
    v_mfma_f32_16x16x32_bf16 v[80:83], a[180:183], a[148:151], v[80:83]
    s_waitcnt lgkmcnt(4)
    ds_read_b128 a[208:211], v141 offset:22528
    ds_read_b128 a[212:215], v141 offset:27648
    v_mfma_f32_16x16x32_bf16 v[76:79], a[184:187], a[148:151], v[76:79]
    ds_read_b128 a[216:219], v141 offset:26624
    ds_read_b128 a[220:223], v141 offset:21504
    v_mfma_f32_16x16x32_bf16 v[76:79], a[188:191], a[144:147], v[76:79]
    s_waitcnt lgkmcnt(6)
    v_permlane32_swap_b32 v97, v99
    v_mfma_f32_16x16x32_bf16 v[76:79], a[192:195], a[140:143], v[76:79]
    ds_read_b128 a[224:227], v141 offset:16384
    ds_read_b128 a[228:231], v141 offset:11264
    v_mfma_f32_16x16x32_bf16 v[76:79], a[196:199], a[136:139], v[76:79]
    s_waitcnt lgkmcnt(6)
    s_waitcnt vmcnt(6)
    v_permlane32_swap_b32 v100, v102
    v_mfma_f32_16x16x32_bf16 v[72:75], a[200:203], a[136:139], v[72:75]
    ds_read_b128 a[232:235], v141 offset:10240
    ds_read_b128 a[236:239], v141 offset:15360
    v_mfma_f32_16x16x32_bf16 v[72:75], a[204:207], a[140:143], v[72:75]
    s_waitcnt lgkmcnt(6)
    v_permlane32_swap_b32 v101, v103
    v_mfma_f32_16x16x32_bf16 v[72:75], a[208:211], a[144:147], v[72:75]
    ds_read_b128 a[240:243], v141 offset:20480
    ds_read_b128 a[244:247], v141 offset:25600
    v_mfma_f32_16x16x32_bf16 v[72:75], a[212:215], a[148:151], v[72:75]
    s_waitcnt lgkmcnt(6)
    s_waitcnt vmcnt(5)
    v_permlane32_swap_b32 v104, v106
    v_mfma_f32_16x16x32_bf16 v[68:71], a[216:219], a[148:151], v[68:71]
    ds_read_b128 a[0:3], v141 offset:30720
    ds_read_b128 a[4:7], v141 offset:35840
    v_mfma_f32_16x16x32_bf16 v[68:71], a[220:223], a[144:147], v[68:71]
    s_waitcnt lgkmcnt(6)
    v_permlane32_swap_b32 v105, v107
    v_mfma_f32_16x16x32_bf16 v[68:71], a[224:227], a[140:143], v[68:71]
    ds_read_b128 a[8:11], v141 offset:40960
    ds_read_b128 a[12:15], v141 offset:46080
    v_mfma_f32_16x16x32_bf16 v[68:71], a[228:231], a[136:139], v[68:71]
    s_waitcnt lgkmcnt(6)
    s_waitcnt vmcnt(4)
    v_permlane32_swap_b32 v108, v110
    v_mfma_f32_16x16x32_bf16 v[64:67], a[232:235], a[136:139], v[64:67]
    ds_read_b128 a[16:19], v141 offset:47104
    ds_read_b128 a[20:23], v141 offset:41984
    v_mfma_f32_16x16x32_bf16 v[64:67], a[236:239], a[140:143], v[64:67]
    s_waitcnt lgkmcnt(6)
    v_permlane32_swap_b32 v109, v111
    v_mfma_f32_16x16x32_bf16 v[64:67], a[240:243], a[144:147], v[64:67]
    ds_read_b128 a[24:27], v141 offset:36864
    ds_read_b128 a[28:31], v141 offset:31744
    v_mfma_f32_16x16x32_bf16 v[64:67], a[244:247], a[148:151], v[64:67]
    s_waitcnt lgkmcnt(6)
    v_exp_f32 v41, v41
    v_mfma_f32_16x16x32_bf16 v[64:67], a[0:3], v[96:99], v[64:67]
    ds_read_b128 a[32:35], v141 offset:32768
    ds_read_b128 a[36:39], v141 offset:37888
    v_mfma_f32_16x16x32_bf16 v[64:67], a[4:7], v[100:103], v[64:67]
    s_waitcnt lgkmcnt(6)
    v_exp_f32 v40, v40
    v_mfma_f32_16x16x32_bf16 v[64:67], a[8:11], v[104:107], v[64:67]
    ds_read_b128 a[40:43], v141 offset:43008
    ds_read_b128 a[44:47], v141 offset:48128
    v_mfma_f32_16x16x32_bf16 v[64:67], a[12:15], v[108:111], v[64:67]
    s_waitcnt lgkmcnt(6)
    v_exp_f32 v39, v39
    v_mfma_f32_16x16x32_bf16 v[68:71], a[16:19], v[108:111], v[68:71]
    ds_read_b128 a[48:51], v141 offset:49152
    ds_read_b128 a[52:55], v141 offset:44032
    v_mfma_f32_16x16x32_bf16 v[68:71], a[20:23], v[104:107], v[68:71]
    s_waitcnt lgkmcnt(6)
    v_exp_f32 v38, v38
    v_mfma_f32_16x16x32_bf16 v[68:71], a[24:27], v[100:103], v[68:71]
    ds_read_b128 a[56:59], v141 offset:38912
    ds_read_b128 a[60:63], v141 offset:33792
    v_mfma_f32_16x16x32_bf16 v[68:71], a[28:31], v[96:99], v[68:71]
    s_waitcnt lgkmcnt(6)
    v_exp_f32 v37, v37
    v_mfma_f32_16x16x32_bf16 v[72:75], a[32:35], v[96:99], v[72:75]
    ds_read_b128 a[64:67], v141 offset:34816
    ds_read_b128 a[68:71], v141 offset:39936
    v_mfma_f32_16x16x32_bf16 v[72:75], a[36:39], v[100:103], v[72:75]
    s_waitcnt lgkmcnt(6)
    v_exp_f32 v36, v36
    v_mfma_f32_16x16x32_bf16 v[72:75], a[40:43], v[104:107], v[72:75]
    ds_read_b128 a[72:75], v141 offset:45056
    ds_read_b128 a[76:79], v141 offset:50176
    v_mfma_f32_16x16x32_bf16 v[72:75], a[44:47], v[108:111], v[72:75]
    v_exp_f32 v35, v35
    s_barrier
    s_waitcnt lgkmcnt(6)
    v_mfma_f32_16x16x32_bf16 v[76:79], a[48:51], v[108:111], v[76:79]
    ds_read_b128 a[168:171], v140 offset:4096
    ds_read_b128 a[172:175], v140 offset:9216
    v_mfma_f32_16x16x32_bf16 v[76:79], a[52:55], v[104:107], v[76:79]
    s_waitcnt lgkmcnt(6)
    v_exp_f32 v34, v34
    v_mfma_f32_16x16x32_bf16 v[76:79], a[56:59], v[100:103], v[76:79]
    ds_read_b128 a[176:179], v140 offset:14336
    ds_read_b128 a[180:183], v140 offset:19456
    v_mfma_f32_16x16x32_bf16 v[76:79], a[60:63], v[96:99], v[76:79]
    s_waitcnt lgkmcnt(6)
    v_exp_f32 v33, v33
    v_mfma_f32_16x16x32_bf16 v[80:83], a[64:67], v[96:99], v[80:83]
    ds_read_b128 a[184:187], v140 offset:18432
    ds_read_b128 a[188:191], v140 offset:13312
    v_mfma_f32_16x16x32_bf16 v[80:83], a[68:71], v[100:103], v[80:83]
    s_waitcnt lgkmcnt(6)
    v_exp_f32 v32, v32
    v_fma_f32 v51, v51, v22, v22
    v_mfma_f32_16x16x32_bf16 v[80:83], a[72:75], v[104:107], v[80:83]
    ds_read_b128 a[192:195], v140 offset:8192
    ds_read_b128 a[196:199], v140 offset:3072
    v_mfma_f32_16x16x32_bf16 v[80:83], a[76:79], v[108:111], v[80:83]
    s_waitcnt vmcnt(3) lgkmcnt(6)
    v_fma_f32 v50, v50, v22, v22
    v_rcp_f32 v51, v51
    v_mfma_f32_16x16x32_bf16 v[80:83], a[168:171], a[88:91], v[80:83]
    s_waitcnt vmcnt(2)
    ds_read_b128 a[200:203], v140 offset:2048
    ds_read_b128 a[204:207], v140 offset:7168
    v_mfma_f32_16x16x32_bf16 v[80:83], a[172:175], a[92:95], v[80:83]
    s_waitcnt vmcnt(1) lgkmcnt(6)
    v_rcp_f32 v50, v50
    v_fma_f32 v49, v49, v22, v22
    v_mfma_f32_16x16x32_bf16 v[80:83], a[176:179], a[96:99], v[80:83]
    s_waitcnt vmcnt(0)
    ds_read_b128 a[208:211], v140 offset:12288
    ds_read_b128 a[212:215], v140 offset:17408
    v_mfma_f32_16x16x32_bf16 v[80:83], a[180:183], a[100:103], v[80:83]
    s_waitcnt lgkmcnt(6)
    v_fma_f32 v48, v48, v22, v22
    v_rcp_f32 v49, v49
    v_mfma_f32_16x16x32_bf16 v[76:79], a[184:187], a[100:103], v[76:79]
    ds_read_b128 a[216:219], v140 offset:16384
    ds_read_b128 a[220:223], v140 offset:11264
    v_mfma_f32_16x16x32_bf16 v[76:79], a[188:191], a[96:99], v[76:79]
    s_waitcnt lgkmcnt(6)
    v_rcp_f32 v48, v48
    v_fma_f32 v47, v47, v22, v22
    v_mfma_f32_16x16x32_bf16 v[76:79], a[192:195], a[92:95], v[76:79]
    ds_read_b128 a[224:227], v140 offset:6144
    ds_read_b128 a[228:231], v140 offset:1024
    v_mfma_f32_16x16x32_bf16 v[76:79], a[196:199], a[88:91], v[76:79]
    s_waitcnt lgkmcnt(6)
    v_fma_f32 v46, v46, v22, v22
    v_rcp_f32 v47, v47
    v_mfma_f32_16x16x32_bf16 v[72:75], a[200:203], a[88:91], v[72:75]
    ds_read_b128 a[232:235], v140 offset:0
    ds_read_b128 a[236:239], v140 offset:5120
    v_mfma_f32_16x16x32_bf16 v[72:75], a[204:207], a[92:95], v[72:75]
    s_waitcnt lgkmcnt(6)
    v_rcp_f32 v46, v46
    v_fma_f32 v45, v45, v22, v22
    v_mfma_f32_16x16x32_bf16 v[72:75], a[208:211], a[96:99], v[72:75]
    ds_read_b128 a[240:243], v140 offset:10240
    ds_read_b128 a[244:247], v140 offset:15360
    v_mfma_f32_16x16x32_bf16 v[72:75], a[212:215], a[100:103], v[72:75]
    s_waitcnt lgkmcnt(6)
    v_fma_f32 v44, v44, v22, v22
    v_rcp_f32 v45, v45
    v_mfma_f32_16x16x32_bf16 v[68:71], a[216:219], a[100:103], v[68:71]
    v_rcp_f32 v44, v44
    v_fma_f32 v43, v43, v22, v22
    v_mfma_f32_16x16x32_bf16 v[68:71], a[220:223], a[96:99], v[68:71]
    s_waitcnt lgkmcnt(4)
    v_fma_f32 v42, v42, v22, v22
    v_rcp_f32 v43, v43
    v_mfma_f32_16x16x32_bf16 v[68:71], a[224:227], a[92:95], v[68:71]
    v_rcp_f32 v42, v42
    v_fma_f32 v41, v41, v22, v22
    v_mfma_f32_16x16x32_bf16 v[68:71], a[228:231], a[88:91], v[68:71]
    s_waitcnt lgkmcnt(2)
    v_fma_f32 v40, v40, v22, v22
    v_rcp_f32 v41, v41
    v_mfma_f32_16x16x32_bf16 v[64:67], a[232:235], a[88:91], v[64:67]
    v_rcp_f32 v40, v40
    v_fma_f32 v39, v39, v22, v22
    v_mfma_f32_16x16x32_bf16 v[64:67], a[236:239], a[92:95], v[64:67]
    s_waitcnt lgkmcnt(0)
    v_fma_f32 v38, v38, v22, v22
    v_rcp_f32 v39, v39
    v_mfma_f32_16x16x32_bf16 v[64:67], a[240:243], a[96:99], v[64:67]
    v_rcp_f32 v38, v38
    v_fma_f32 v37, v37, v22, v22
    v_mfma_f32_16x16x32_bf16 v[64:67], a[244:247], a[100:103], v[64:67]
    v_fma_f32 v36, v36, v22, v22
    v_rcp_f32 v37, v37
    v_rcp_f32 v36, v36
    v_fma_f32 v35, v35, v22, v22
    v_fma_f32 v34, v34, v22, v22
    v_rcp_f32 v35, v35
    v_rcp_f32 v34, v34
    v_fma_f32 v33, v33, v22, v22
    v_fma_f32 v32, v32, v22, v22
    v_rcp_f32 v33, v33
    v_rcp_f32 v32, v32
    v_pk_mul_f32 v[194:195], v[194:195], v[50:51]
    v_pk_mul_f32 v[192:193], v[192:193], v[48:49]
    v_pk_mul_f32 v[190:191], v[190:191], v[46:47]
    v_pk_mul_f32 v[188:189], v[188:189], v[44:45]
    v_pk_mul_f32 v[186:187], v[186:187], v[42:43]
    v_pk_mul_f32 v[184:185], v[184:185], v[40:41]
    v_pk_mul_f32 v[182:183], v[182:183], v[38:39]
    v_pk_mul_f32 v[180:181], v[180:181], v[36:37]
    v_pk_mul_f32 v[178:179], v[178:179], v[34:35]
    v_pk_mul_f32 v[176:177], v[176:177], v[32:33]
    v_pk_fma_f32 v[80:81], v[80:81], v[192:193], v[172:173]
    v_pk_fma_f32 v[82:83], v[82:83], v[194:195], v[174:175]
    v_cvt_pk_bf16_f32 v150, v80, v81
    v_cvt_pk_bf16_f32 v151, v82, v83
    ds_write_b64 v11, v[150:151] offset:128
    v_pk_fma_f32 v[76:77], v[76:77], v[188:189], v[168:169]
    v_pk_fma_f32 v[78:79], v[78:79], v[190:191], v[170:171]
    v_cvt_pk_bf16_f32 v148, v76, v77
    v_cvt_pk_bf16_f32 v149, v78, v79
    v_pk_fma_f32 v[72:73], v[72:73], v[184:185], v[164:165]
    v_pk_fma_f32 v[74:75], v[74:75], v[186:187], v[166:167]
    v_cvt_pk_bf16_f32 v146, v72, v73
    v_cvt_pk_bf16_f32 v147, v74, v75
    ds_write_b128 v10, v[146:149] offset:64
    v_pk_fma_f32 v[68:69], v[68:69], v[180:181], v[160:161]
    v_pk_fma_f32 v[70:71], v[70:71], v[182:183], v[162:163]
    v_cvt_pk_bf16_f32 v144, v68, v69
    v_cvt_pk_bf16_f32 v145, v70, v71
    v_pk_fma_f32 v[64:65], v[64:65], v[176:177], v[156:157]
    v_pk_fma_f32 v[66:67], v[66:67], v[178:179], v[158:159]
    v_cvt_pk_bf16_f32 v142, v64, v65
    v_cvt_pk_bf16_f32 v143, v66, v67
    ds_write_b128 v10, v[142:145]
    ds_read_b128 v[32:35], v27 offset:0
    ds_read_b128 v[36:39], v27 offset:1024
    ds_read_b128 v[40:43], v27 offset:2048
    s_waitcnt lgkmcnt(2)
    buffer_store_dwordx4 v[32:35], v136, s[56:59], 0 offen offset:0
    s_waitcnt lgkmcnt(1)
    buffer_store_dwordx4 v[36:39], v137, s[56:59], 0 offen offset:1024
    s_waitcnt lgkmcnt(0)
    buffer_store_dwordx4 v[40:43], v138, s[56:59], 0 offen offset:2048
    s_endpgm
L_fspin_glu:
    s_mov_b32 s81, 0
L_fspin2_glu:
    buffer_load_dword v14, v12, s[44:47], 0 offen sc1
    s_add_u32 s81, s81, 1
    s_waitcnt vmcnt(0)
    v_cmp_ne_u32 vcc, 1, v14
    s_cmp_lt_u32 s81, 0x40000
    s_nop 0
    s_cbranch_vccz L_fback_glu
    s_sleep 2
    s_cbranch_scc1 L_fspin2_glu
    s_branch L_fback_glu
L_fspin_sglu:
    s_mov_b32 s81, 0
L_fspin2_sglu:
    buffer_load_dword v14, v13, s[44:47], 0 offen sc1
    s_add_u32 s81, s81, 1
    s_waitcnt vmcnt(0)
    v_cmp_ne_u32 vcc, 1, v14
    s_cmp_lt_u32 s81, 0x40000
    s_nop 0
    s_cbranch_vccz L_fback_sglu
    s_sleep 2
    s_cbranch_scc1 L_fspin2_sglu
    s_branch L_fback_sglu
L_spin_glue:
    s_mov_b32 s81, 0
L_spin2_glue:
    s_sleep 8
    buffer_load_dwordx4 v[24:27], v48, s[44:47], 0 offen sc1
    s_add_u32 s81, s81, 1
    s_waitcnt vmcnt(0)
    v_and_b32 v24, v24, v25
    v_and_b32 v26, v26, v27
    v_and_b32 v24, v24, v26
    v_cmp_ne_u32 vcc, s83, v24
    s_cmp_lt_u32 s81, 0x40000
    s_nop 1
    s_cbranch_vccz L_back_glue
    s_cbranch_scc1 L_spin2_glue
    s_branch L_back_glue
L_spin_glur:
    s_mov_b32 s81, 0
L_spin2_glur:
    s_sleep 8
    buffer_load_dword v53, off, s[52:55], 0 sc1
    s_add_u32 s81, s81, 1
    s_waitcnt vmcnt(0)
    v_cmp_ne_u32 vcc, 1, v53
    s_cmp_lt_u32 s81, 0x40000
    s_nop 1
    s_cbranch_vccz L_back_glur
    s_cbranch_scc1 L_spin2_glur
    s_branch L_back_glur
.p2align 12
L_qkv2:
    s_waitcnt vmcnt(9) lgkmcnt(0)
    s_barrier
    ds_read_b64_tr_b16 a[48:49], v15 offset:0
    ds_read_b64_tr_b16 a[50:51], v15 offset:640
    ds_read_b64_tr_b16 a[52:53], v15 offset:5632
    ds_read_b64_tr_b16 a[54:55], v15 offset:6272
    ds_read_b128 a[0:3], v11 offset:0
    ds_read_b128 a[4:7], v12 offset:0
    ds_read_b128 a[8:11], v11 offset:2048
    ds_read_b128 a[12:15], v12 offset:2048
    ds_read_b128 a[16:19], v11 offset:4096
    ds_read_b128 a[20:23], v12 offset:4096
    ds_read_b64_tr_b16 a[56:57], v15 offset:40
    ds_read_b64_tr_b16 a[58:59], v15 offset:680
    ds_read_b64_tr_b16 a[60:61], v15 offset:5672
    ds_read_b64_tr_b16 a[62:63], v15 offset:6312
    s_waitcnt lgkmcnt(8)
    v_mfma_f32_16x16x32_bf16 v[196:199], a[0:3], a[48:51], 0
    s_add_u32 m0, s67, 24576
    s_mov_b32 s70, 128
    ds_read_b64_tr_b16 a[64:65], v15 offset:80
    ds_read_b64_tr_b16 a[80:81], v16 offset:0
    v_mfma_f32_16x16x32_bf16 v[196:199], a[4:7], a[52:55], v[196:199]
    s_mov_b64 exec, s[72:73]
    buffer_load_dwordx4 v5, s[24:27], s70 offen lds
    s_mov_b64 exec, -1
    s_waitcnt lgkmcnt(8)
    v_mfma_f32_16x16x32_bf16 v[200:203], a[12:15], a[52:55], 0
    ds_read_b64_tr_b16 a[66:67], v15 offset:720
    ds_read_b64_tr_b16 a[72:73], v15 offset:120
    ds_read_b64_tr_b16 a[82:83], v16 offset:640
    v_mfma_f32_16x16x32_bf16 v[200:203], a[8:11], a[48:51], v[200:203]
    ds_read_b64_tr_b16 a[68:69], v15 offset:5712
    ds_read_b64_tr_b16 a[84:85], v16 offset:5632
    s_waitcnt lgkmcnt(11)
    v_mfma_f32_16x16x32_bf16 v[204:207], a[16:19], a[48:51], 0
    s_add_u32 m0, s67, 28672
    ds_read_b64_tr_b16 a[70:71], v15 offset:6352
    ds_read_b64_tr_b16 a[74:75], v15 offset:760
    ds_read_b64_tr_b16 a[86:87], v16 offset:6272
    v_mfma_f32_16x16x32_bf16 v[204:207], a[20:23], a[52:55], v[204:207]
    buffer_load_dwordx4 v6, s[24:27], s70 offen lds
    s_waitcnt lgkmcnt(10)
    v_mfma_f32_16x16x32_bf16 v[216:219], a[20:23], a[60:63], 0
    ds_read_b64_tr_b16 a[76:77], v15 offset:5752
    ds_read_b64_tr_b16 a[78:79], v15 offset:6392
    s_add_u32 s44, s22, 14680064
    s_addc_u32 s45, s23, 0
    v_mfma_f32_16x16x32_bf16 v[216:219], a[16:19], a[56:59], v[216:219]
    s_mov_b32 s46, 65536
    s_mov_b32 s47, 0x20000
    s_mov_b32 s52, s20
    s_mov_b32 s53, s21
    v_mfma_f32_16x16x32_bf16 v[212:215], a[8:11], a[56:59], 0
    s_add_u32 m0, s67, 32768
    s_mov_b32 s54, 256
    s_mov_b32 s55, 0x20000
    s_mov_b32 s36, s22
    v_mfma_f32_16x16x32_bf16 v[212:215], a[12:15], a[60:63], v[212:215]
    buffer_load_dwordx4 v7, s[24:27], s70 offen lds
    s_mov_b32 s37, s23
    v_mfma_f32_16x16x32_bf16 v[208:211], a[4:7], a[60:63], 0
    s_mov_b32 s38, 9699328
    s_mov_b32 s39, 0x20000
    s_add_u32 s40, s22, 10485760
    s_addc_u32 s41, s23, 0
    v_mfma_f32_16x16x32_bf16 v[208:211], a[0:3], a[56:59], v[208:211]
    s_waitcnt vmcnt(9) lgkmcnt(0)
    s_barrier
    v_mfma_f32_16x16x32_bf16 v[220:223], a[0:3], a[64:67], 0
    ds_read_b64_tr_b16 a[48:49], v15 offset:12288
    s_mov_b32 s42, 3031040
    s_mov_b32 s43, 0x20000
    v_mfma_f32_16x16x32_bf16 v[220:223], a[4:7], a[68:71], v[220:223]
    s_add_u32 m0, s67, 36864
    ds_read_b64_tr_b16 a[50:51], v15 offset:12928
    s_lshl3_add_u32 s100, s61, s62
    s_lshl_b32 s100, s100, 7
    v_mfma_f32_16x16x32_bf16 v[224:227], a[12:15], a[68:71], 0
    buffer_load_dwordx4 v8, s[24:27], s70 offen lds
    s_add_u32 s100, s100, 53248
    v_mfma_f32_16x16x32_bf16 v[224:227], a[8:11], a[64:67], v[224:227]
    ds_read_b64_tr_b16 a[52:53], v15 offset:17920
    v_mfma_f32_16x16x32_bf16 v[228:231], a[16:19], a[64:67], 0
    ds_read_b64_tr_b16 a[54:55], v15 offset:18560
    v_mfma_f32_16x16x32_bf16 v[228:231], a[20:23], a[68:71], v[228:231]
    s_add_u32 m0, s67, 40960
    ds_read_b64_tr_b16 a[56:57], v15 offset:12328
    v_mfma_f32_16x16x32_bf16 v[240:243], a[20:23], a[76:79], 0
    buffer_load_dwordx4 v9, s[24:27], s70 offen lds
    v_mfma_f32_16x16x32_bf16 v[240:243], a[16:19], a[72:75], v[240:243]
    ds_read_b64_tr_b16 a[58:59], v15 offset:12968
    v_mfma_f32_16x16x32_bf16 v[236:239], a[8:11], a[72:75], 0
    ds_read_b64_tr_b16 a[60:61], v15 offset:17960
    v_mfma_f32_16x16x32_bf16 v[236:239], a[12:15], a[76:79], v[236:239]
    ds_read_b64_tr_b16 a[62:63], v15 offset:18600
    v_mfma_f32_16x16x32_bf16 v[232:235], a[4:7], a[76:79], 0
    s_add_u32 m0, s67, 45056
    ds_read_b64_tr_b16 a[64:65], v15 offset:12368
    v_mfma_f32_16x16x32_bf16 v[232:235], a[0:3], a[72:75], v[232:235]
    buffer_load_dwordx4 v10, s[24:27], s70 offen lds
    v_mfma_f32_16x16x32_bf16 v[244:247], a[0:3], a[80:83], 0
    ds_read_b64_tr_b16 a[66:67], v15 offset:13008
    v_mfma_f32_16x16x32_bf16 v[244:247], a[4:7], a[84:87], v[244:247]
    s_add_u32 m0, s68, 86016
    ds_read_b64_tr_b16 a[68:69], v15 offset:18000
    v_mfma_f32_16x16x32_bf16 v[248:251], a[12:15], a[84:87], 0
    s_mov_b32 s71, 248320
    ds_read_b64_tr_b16 a[70:71], v15 offset:18640
    v_mfma_f32_16x16x32_bf16 v[248:251], a[8:11], a[80:83], v[248:251]
    buffer_load_dwordx4 v70, s[28:31], s71 offen lds
    v_mfma_f32_16x16x32_bf16 v[252:255], a[16:19], a[80:83], 0
    ds_read_b64_tr_b16 a[72:73], v15 offset:12408
    v_mfma_f32_16x16x32_bf16 v[252:255], a[20:23], a[84:87], v[252:255]
    ds_read_b64_tr_b16 a[74:75], v15 offset:13048
    s_waitcnt lgkmcnt(10)
    v_mfma_f32_16x16x32_bf16 v[144:147], a[52:55], a[20:23], 0
    ds_read_b64_tr_b16 a[76:77], v15 offset:18040
    v_mfma_f32_16x16x32_bf16 v[144:147], a[48:51], a[16:19], v[144:147]
    buffer_load_dwordx4 v71, s[28:31], s71 offen offset:1024 lds
    v_mfma_f32_16x16x32_bf16 v[140:143], a[48:51], a[8:11], 0
    ds_read_b64_tr_b16 a[78:79], v15 offset:18680
    v_mfma_f32_16x16x32_bf16 v[140:143], a[52:55], a[12:15], v[140:143]
    ds_read_b64_tr_b16 a[80:81], v16 offset:12288
    v_mfma_f32_16x16x32_bf16 v[136:139], a[52:55], a[4:7], 0
    ds_read_b64_tr_b16 a[82:83], v16 offset:12928
    v_mfma_f32_16x16x32_bf16 v[136:139], a[48:51], a[0:3], v[136:139]
    ds_read_b64_tr_b16 a[84:85], v16 offset:17920
    ds_read_b64_tr_b16 a[86:87], v16 offset:18560
    s_waitcnt lgkmcnt(12)
    v_mfma_f32_16x16x32_bf16 v[148:151], a[56:59], a[0:3], 0
    buffer_load_dwordx4 v72, s[28:31], s71 offen offset:2048 lds
    v_mfma_f32_16x16x32_bf16 v[148:151], a[60:63], a[4:7], v[148:151]
    s_add_u32 m0, s68, 98304
    v_mfma_f32_16x16x32_bf16 v[152:155], a[60:63], a[12:15], 0
    s_mov_b32 s71, 247040
    v_mfma_f32_16x16x32_bf16 v[152:155], a[56:59], a[8:11], v[152:155]
    buffer_load_dwordx4 v70, s[28:31], s71 offen lds
    v_mfma_f32_16x16x32_bf16 v[156:159], a[56:59], a[16:19], 0
    v_mfma_f32_16x16x32_bf16 v[156:159], a[60:63], a[20:23], v[156:159]
    s_waitcnt vmcnt(13) lgkmcnt(0)
    s_barrier
    v_mfma_f32_16x16x32_bf16 v[168:171], a[68:71], a[20:23], 0
    ds_read_b64_tr_b16 a[48:49], v15 offset:24576
    v_mfma_f32_16x16x32_bf16 v[168:171], a[64:67], a[16:19], v[168:171]
    ds_read_b64_tr_b16 a[50:51], v15 offset:25216
    v_mfma_f32_16x16x32_bf16 v[164:167], a[64:67], a[8:11], 0
    ds_read_b64_tr_b16 a[52:53], v15 offset:30208
    v_mfma_f32_16x16x32_bf16 v[164:167], a[68:71], a[12:15], v[164:167]
    ds_read_b64_tr_b16 a[54:55], v15 offset:30848
    v_mfma_f32_16x16x32_bf16 v[160:163], a[68:71], a[4:7], 0
    buffer_load_dwordx4 v71, s[28:31], s71 offen offset:1024 lds
    v_mfma_f32_16x16x32_bf16 v[160:163], a[64:67], a[0:3], v[160:163]
    ds_read_b64_tr_b16 a[56:57], v15 offset:24616
    v_mfma_f32_16x16x32_bf16 v[172:175], a[72:75], a[0:3], 0
    ds_read_b64_tr_b16 a[58:59], v15 offset:25256
    v_mfma_f32_16x16x32_bf16 v[172:175], a[76:79], a[4:7], v[172:175]
    ds_read_b64_tr_b16 a[60:61], v15 offset:30248
    v_mfma_f32_16x16x32_bf16 v[176:179], a[76:79], a[12:15], 0
    buffer_load_dwordx4 v72, s[28:31], s71 offen offset:2048 lds
    v_mfma_f32_16x16x32_bf16 v[176:179], a[72:75], a[8:11], v[176:179]
    ds_read_b64_tr_b16 a[62:63], v15 offset:30888
    v_mfma_f32_16x16x32_bf16 v[180:183], a[72:75], a[16:19], 0
    s_add_u32 m0, s68, 110592
    ds_read_b64_tr_b16 a[64:65], v15 offset:24656
    v_mfma_f32_16x16x32_bf16 v[180:183], a[76:79], a[20:23], v[180:183]
    s_mov_b32 s71, 245760
    ds_read_b64_tr_b16 a[66:67], v15 offset:25296
    v_mfma_f32_16x16x32_bf16 v[192:195], a[84:87], a[20:23], 0
    buffer_load_dwordx4 v70, s[28:31], s71 offen lds
    v_mfma_f32_16x16x32_bf16 v[192:195], a[80:83], a[16:19], v[192:195]
    ds_read_b64_tr_b16 a[68:69], v15 offset:30288
    v_mfma_f32_16x16x32_bf16 v[188:191], a[80:83], a[8:11], 0
    ds_read_b64_tr_b16 a[70:71], v15 offset:30928
    v_mfma_f32_16x16x32_bf16 v[188:191], a[84:87], a[12:15], v[188:191]
    ds_read_b64_tr_b16 a[72:73], v15 offset:24696
    v_mfma_f32_16x16x32_bf16 v[184:187], a[84:87], a[4:7], 0
    ds_read_b64_tr_b16 a[74:75], v15 offset:25336
    v_mfma_f32_16x16x32_bf16 v[184:187], a[80:83], a[0:3], v[184:187]
    buffer_load_dwordx4 v71, s[28:31], s71 offen offset:1024 lds
    s_waitcnt lgkmcnt(10)
    v_mfma_f32_16x16x32_bf16 v[76:79], a[48:51], a[0:3], 0
    ds_read_b64_tr_b16 a[76:77], v15 offset:30328
    v_mfma_f32_16x16x32_bf16 v[76:79], a[52:55], a[4:7], v[76:79]
    ds_read_b64_tr_b16 a[78:79], v15 offset:30968
    v_mfma_f32_16x16x32_bf16 v[80:83], a[52:55], a[12:15], 0
    buffer_load_dword v22, v43, s[24:27], 0 offen offset:0
    ds_read_b64_tr_b16 a[80:81], v16 offset:24576
    v_mfma_f32_16x16x32_bf16 v[80:83], a[48:51], a[8:11], v[80:83]
    buffer_load_dwordx4 v72, s[28:31], s71 offen offset:2048 lds
    buffer_load_dword v23, v43, s[24:27], 0 offen offset:128
    v_mfma_f32_16x16x32_bf16 v[84:87], a[48:51], a[16:19], 0
    ds_read_b64_tr_b16 a[82:83], v16 offset:25216
    ds_read_b64_tr_b16 a[84:85], v16 offset:30208
    v_mfma_f32_16x16x32_bf16 v[84:87], a[52:55], a[20:23], v[84:87]
    buffer_load_dword v26, v43, s[24:27], 0 offen offset:512
    s_waitcnt lgkmcnt(11)
    v_mfma_f32_16x16x32_bf16 v[96:99], a[60:63], a[20:23], 0
    s_add_u32 m0, s67, 0
    ds_read_b64_tr_b16 a[86:87], v16 offset:30848
    v_mfma_f32_16x16x32_bf16 v[96:99], a[56:59], a[16:19], v[96:99]
    s_mov_b32 s70, 256
    buffer_load_dword v27, v43, s[24:27], 0 offen offset:640
    v_mfma_f32_16x16x32_bf16 v[92:95], a[56:59], a[8:11], 0
    s_mov_b64 exec, s[72:73]
    buffer_load_dwordx4 v5, s[24:27], s70 offen lds
    s_mov_b64 exec, -1
    v_mfma_f32_16x16x32_bf16 v[92:95], a[60:63], a[12:15], v[92:95]
    buffer_load_dword v28, v43, s[24:27], 0 offen offset:768
    v_mfma_f32_16x16x32_bf16 v[88:91], a[60:63], a[4:7], 0
    v_mfma_f32_16x16x32_bf16 v[88:91], a[56:59], a[0:3], v[88:91]
    s_add_u32 m0, s67, 4096
    s_waitcnt vmcnt(12) lgkmcnt(0)
    s_barrier
    v_mfma_f32_16x16x32_bf16 v[100:103], a[64:67], a[0:3], 0
    buffer_load_dwordx4 v6, s[24:27], s70 offen lds
    buffer_load_dword v29, v43, s[24:27], 0 offen offset:896
    v_mfma_f32_16x16x32_bf16 v[100:103], a[68:71], a[4:7], v[100:103]
    ds_read_b64_tr_b16 a[48:49], v15 offset:36864
    v_mfma_f32_16x16x32_bf16 v[104:107], a[68:71], a[12:15], 0
    buffer_load_dword v30, v43, s[24:27], 0 offen offset:1024
    ds_read_b64_tr_b16 a[50:51], v15 offset:37504
    v_mfma_f32_16x16x32_bf16 v[104:107], a[64:67], a[8:11], v[104:107]
    s_add_u32 m0, s67, 8192
    ds_read_b64_tr_b16 a[52:53], v15 offset:42496
    v_mfma_f32_16x16x32_bf16 v[108:111], a[64:67], a[16:19], 0
    buffer_load_dwordx4 v7, s[24:27], s70 offen lds
    buffer_load_dword v31, v43, s[24:27], 0 offen offset:1152
    v_mfma_f32_16x16x32_bf16 v[108:111], a[68:71], a[20:23], v[108:111]
    ds_read_b64_tr_b16 a[54:55], v15 offset:43136
    v_mfma_f32_16x16x32_bf16 v[120:123], a[76:79], a[20:23], 0
    ds_read_b128 a[40:43], v11 offset:28672
    v_mfma_f32_16x16x32_bf16 v[120:123], a[72:75], a[16:19], v[120:123]
    ds_read_b128 a[44:47], v12 offset:28672
    v_mfma_f32_16x16x32_bf16 v[116:119], a[72:75], a[8:11], 0
    s_add_u32 m0, s67, 12288
    ds_read_b128 a[32:35], v11 offset:26624
    v_mfma_f32_16x16x32_bf16 v[116:119], a[76:79], a[12:15], v[116:119]
    buffer_load_dwordx4 v8, s[24:27], s70 offen lds
    v_mfma_f32_16x16x32_bf16 v[112:115], a[76:79], a[4:7], 0
    ds_read_b128 a[36:39], v12 offset:26624
    v_mfma_f32_16x16x32_bf16 v[112:115], a[72:75], a[0:3], v[112:115]
    ds_read_b128 a[24:27], v11 offset:24576
    v_mfma_f32_16x16x32_bf16 v[124:127], a[80:83], a[0:3], 0
    s_add_u32 m0, s67, 16384
    ds_read_b128 a[28:31], v12 offset:24576
    ds_read_b64_tr_b16 a[72:73], v15 offset:36984
    v_mfma_f32_16x16x32_bf16 v[124:127], a[84:87], a[4:7], v[124:127]
    buffer_load_dwordx4 v9, s[24:27], s70 offen lds
    v_mfma_f32_16x16x32_bf16 v[128:131], a[84:87], a[12:15], 0
    ds_read_b64_tr_b16 a[56:57], v15 offset:36904
    ds_read_b64_tr_b16 a[74:75], v15 offset:37624
    v_mfma_f32_16x16x32_bf16 v[128:131], a[80:83], a[8:11], v[128:131]
    ds_read_b64_tr_b16 a[58:59], v15 offset:37544
    ds_read_b64_tr_b16 a[76:77], v15 offset:42616
    v_mfma_f32_16x16x32_bf16 v[132:135], a[80:83], a[16:19], 0
    ds_read_b64_tr_b16 a[60:61], v15 offset:42536
    v_mfma_f32_16x16x32_bf16 v[132:135], a[84:87], a[20:23], v[132:135]
    ds_read_b64_tr_b16 a[62:63], v15 offset:43176
    s_waitcnt lgkmcnt(11)
    v_mfma_f32_16x16x32_bf16 v[204:207], a[44:47], a[52:55], v[204:207]
    s_add_u32 m0, s67, 20480
    ds_read_b64_tr_b16 a[64:65], v15 offset:36944
    ds_read_b64_tr_b16 a[80:81], v16 offset:36864
    v_mfma_f32_16x16x32_bf16 v[204:207], a[40:43], a[48:51], v[204:207]
    buffer_load_dwordx4 v10, s[24:27], s70 offen lds
    s_waitcnt lgkmcnt(11)
    v_mfma_f32_16x16x32_bf16 v[200:203], a[32:35], a[48:51], v[200:203]
    ds_read_b64_tr_b16 a[66:67], v15 offset:37584
    ds_read_b64_tr_b16 a[82:83], v16 offset:37504
    v_mfma_f32_16x16x32_bf16 v[200:203], a[36:39], a[52:55], v[200:203]
    s_add_u32 m0, s68, 122880
    ds_read_b64_tr_b16 a[68:69], v15 offset:42576
    s_waitcnt lgkmcnt(12)
    v_mfma_f32_16x16x32_bf16 v[196:199], a[28:31], a[52:55], v[196:199]
    s_mov_b32 s71, 494080
    ds_read_b64_tr_b16 a[70:71], v15 offset:43216
    ds_read_b64_tr_b16 a[84:85], v16 offset:42496
    v_mfma_f32_16x16x32_bf16 v[196:199], a[24:27], a[48:51], v[196:199]
    buffer_load_dwordx4 v70, s[28:31], s71 offen lds
    s_waitcnt lgkmcnt(7)
    v_mfma_f32_16x16x32_bf16 v[208:211], a[24:27], a[56:59], v[208:211]
    ds_read_b64_tr_b16 a[78:79], v15 offset:43256
    ds_read_b64_tr_b16 a[86:87], v16 offset:43136
    v_mfma_f32_16x16x32_bf16 v[208:211], a[28:31], a[60:63], v[208:211]
    v_mfma_f32_16x16x32_bf16 v[212:215], a[36:39], a[60:63], v[212:215]
    v_mfma_f32_16x16x32_bf16 v[212:215], a[32:35], a[56:59], v[212:215]
    buffer_load_dwordx4 v71, s[28:31], s71 offen offset:1024 lds
    v_mfma_f32_16x16x32_bf16 v[216:219], a[40:43], a[56:59], v[216:219]
    v_mfma_f32_16x16x32_bf16 v[216:219], a[44:47], a[60:63], v[216:219]
    s_waitcnt vmcnt(19) lgkmcnt(0)
    s_barrier
    v_mfma_f32_16x16x32_bf16 v[228:231], a[44:47], a[68:71], v[228:231]
    ds_read_b64_tr_b16 a[48:49], v15 offset:49152
    v_mfma_f32_16x16x32_bf16 v[228:231], a[40:43], a[64:67], v[228:231]
    ds_read_b64_tr_b16 a[50:51], v15 offset:49792
    v_mfma_f32_16x16x32_bf16 v[224:227], a[32:35], a[64:67], v[224:227]
    buffer_load_dwordx4 v72, s[28:31], s71 offen offset:2048 lds
    v_mfma_f32_16x16x32_bf16 v[224:227], a[36:39], a[68:71], v[224:227]
    ds_read_b64_tr_b16 a[52:53], v15 offset:54784
    v_mfma_f32_16x16x32_bf16 v[220:223], a[28:31], a[68:71], v[220:223]
    s_add_u32 m0, s68, 135168
    ds_read_b64_tr_b16 a[54:55], v15 offset:55424
    v_mfma_f32_16x16x32_bf16 v[220:223], a[24:27], a[64:67], v[220:223]
    s_mov_b32 s71, 492800
    ds_read_b64_tr_b16 a[56:57], v15 offset:49192
    v_mfma_f32_16x16x32_bf16 v[232:235], a[24:27], a[72:75], v[232:235]
    buffer_load_dwordx4 v70, s[28:31], s71 offen lds
    v_mfma_f32_16x16x32_bf16 v[232:235], a[28:31], a[76:79], v[232:235]
    ds_read_b64_tr_b16 a[58:59], v15 offset:49832
    v_mfma_f32_16x16x32_bf16 v[236:239], a[36:39], a[76:79], v[236:239]
    ds_read_b64_tr_b16 a[60:61], v15 offset:54824
    v_mfma_f32_16x16x32_bf16 v[236:239], a[32:35], a[72:75], v[236:239]
    ds_read_b64_tr_b16 a[62:63], v15 offset:55464
    v_mfma_f32_16x16x32_bf16 v[240:243], a[40:43], a[72:75], v[240:243]
    ds_read_b64_tr_b16 a[64:65], v15 offset:49232
    v_mfma_f32_16x16x32_bf16 v[240:243], a[44:47], a[76:79], v[240:243]
    buffer_load_dwordx4 v71, s[28:31], s71 offen offset:1024 lds
    v_mfma_f32_16x16x32_bf16 v[252:255], a[44:47], a[84:87], v[252:255]
    ds_read_b64_tr_b16 a[66:67], v15 offset:49872
    v_mfma_f32_16x16x32_bf16 v[252:255], a[40:43], a[80:83], v[252:255]
    ds_read_b64_tr_b16 a[68:69], v15 offset:54864
    v_mfma_f32_16x16x32_bf16 v[248:251], a[32:35], a[80:83], v[248:251]
    ds_read_b64_tr_b16 a[70:71], v15 offset:55504
    v_mfma_f32_16x16x32_bf16 v[248:251], a[36:39], a[84:87], v[248:251]
    buffer_load_dwordx4 v72, s[28:31], s71 offen offset:2048 lds
    v_mfma_f32_16x16x32_bf16 v[244:247], a[28:31], a[84:87], v[244:247]
    ds_read_b64_tr_b16 a[72:73], v15 offset:49272
    v_mfma_f32_16x16x32_bf16 v[244:247], a[24:27], a[80:83], v[244:247]
    s_add_u32 m0, s68, 147456
    ds_read_b64_tr_b16 a[74:75], v15 offset:49912
    s_waitcnt lgkmcnt(10)
    v_mfma_f32_16x16x32_bf16 v[136:139], a[48:51], a[24:27], v[136:139]
    s_mov_b32 s71, 491520
    ds_read_b64_tr_b16 a[76:77], v15 offset:54904
    v_mfma_f32_16x16x32_bf16 v[136:139], a[52:55], a[28:31], v[136:139]
    buffer_load_dwordx4 v70, s[28:31], s71 offen lds
    v_mfma_f32_16x16x32_bf16 v[140:143], a[52:55], a[36:39], v[140:143]
    ds_read_b64_tr_b16 a[78:79], v15 offset:55544
    v_mfma_f32_16x16x32_bf16 v[140:143], a[48:51], a[32:35], v[140:143]
    ds_read_b64_tr_b16 a[80:81], v16 offset:49152
    v_mfma_f32_16x16x32_bf16 v[144:147], a[48:51], a[40:43], v[144:147]
    ds_read_b64_tr_b16 a[82:83], v16 offset:49792
    v_mfma_f32_16x16x32_bf16 v[144:147], a[52:55], a[44:47], v[144:147]
    ds_read_b64_tr_b16 a[84:85], v16 offset:54784
    ds_read_b64_tr_b16 a[86:87], v16 offset:55424
    s_waitcnt lgkmcnt(12)
    v_mfma_f32_16x16x32_bf16 v[156:159], a[60:63], a[44:47], v[156:159]
    buffer_load_dwordx4 v71, s[28:31], s71 offen offset:1024 lds
    v_mfma_f32_16x16x32_bf16 v[156:159], a[56:59], a[40:43], v[156:159]
    v_mfma_f32_16x16x32_bf16 v[152:155], a[56:59], a[32:35], v[152:155]
    v_mfma_f32_16x16x32_bf16 v[152:155], a[60:63], a[36:39], v[152:155]
    buffer_load_dwordx4 v72, s[28:31], s71 offen offset:2048 lds
    v_mfma_f32_16x16x32_bf16 v[148:151], a[60:63], a[28:31], v[148:151]
    v_mfma_f32_16x16x32_bf16 v[148:151], a[56:59], a[24:27], v[148:151]
    s_waitcnt vmcnt(22) lgkmcnt(0)
    s_barrier
    v_mfma_f32_16x16x32_bf16 v[160:163], a[64:67], a[24:27], v[160:163]
    ds_read_b64_tr_b16 a[48:49], v13 offset:0
    v_mfma_f32_16x16x32_bf16 v[160:163], a[68:71], a[28:31], v[160:163]
    ds_read_b64_tr_b16 a[50:51], v13 offset:640
    v_mfma_f32_16x16x32_bf16 v[164:167], a[68:71], a[36:39], v[164:167]
    s_add_u32 m0, s67, 24576
    ds_read_b64_tr_b16 a[52:53], v13 offset:5632
    v_mfma_f32_16x16x32_bf16 v[164:167], a[64:67], a[32:35], v[164:167]
    s_mov_b32 s70, 384
    ds_read_b64_tr_b16 a[54:55], v13 offset:6272
    s_waitcnt vmcnt(12)
    v_lshlrev_b32 v32, 16, v22
    v_mfma_f32_16x16x32_bf16 v[168:171], a[64:67], a[40:43], v[168:171]
    s_mov_b64 exec, s[72:73]
    buffer_load_dwordx4 v5, s[24:27], s70 offen lds
    s_mov_b64 exec, -1
    v_and_b32 v22, 0xffff0000, v22
    v_mfma_f32_16x16x32_bf16 v[168:171], a[68:71], a[44:47], v[168:171]
    ds_read_b64_tr_b16 a[56:57], v13 offset:40
    v_lshlrev_b32 v33, 16, v23
    v_mfma_f32_16x16x32_bf16 v[180:183], a[76:79], a[44:47], v[180:183]
    ds_read_b64_tr_b16 a[58:59], v13 offset:680
    v_and_b32 v23, 0xffff0000, v23
    v_lshlrev_b32 v34, 16, v24
    v_mfma_f32_16x16x32_bf16 v[180:183], a[72:75], a[40:43], v[180:183]
    s_add_u32 m0, s67, 28672
    ds_read_b64_tr_b16 a[60:61], v13 offset:5672
    v_and_b32 v24, 0xffff0000, v24
    v_lshlrev_b32 v35, 16, v25
    v_mfma_f32_16x16x32_bf16 v[176:179], a[72:75], a[32:35], v[176:179]
    buffer_load_dwordx4 v6, s[24:27], s70 offen lds
    v_and_b32 v25, 0xffff0000, v25
    v_mfma_f32_16x16x32_bf16 v[176:179], a[76:79], a[36:39], v[176:179]
    ds_read_b64_tr_b16 a[62:63], v13 offset:6312
    v_lshlrev_b32 v36, 16, v26
    v_and_b32 v26, 0xffff0000, v26
    v_mfma_f32_16x16x32_bf16 v[172:175], a[76:79], a[28:31], v[172:175]
    ds_read_b64_tr_b16 a[64:65], v13 offset:80
    v_lshlrev_b32 v37, 16, v27
    v_and_b32 v27, 0xffff0000, v27
    v_mfma_f32_16x16x32_bf16 v[172:175], a[72:75], a[24:27], v[172:175]
    ds_read_b64_tr_b16 a[66:67], v13 offset:720
    v_lshlrev_b32 v38, 16, v28
    v_mfma_f32_16x16x32_bf16 v[184:187], a[80:83], a[24:27], v[184:187]
    s_add_u32 m0, s67, 32768
    ds_read_b64_tr_b16 a[68:69], v13 offset:5712
    v_and_b32 v28, 0xffff0000, v28
    v_lshlrev_b32 v39, 16, v29
    v_mfma_f32_16x16x32_bf16 v[184:187], a[84:87], a[28:31], v[184:187]
    buffer_load_dwordx4 v7, s[24:27], s70 offen lds
    v_and_b32 v29, 0xffff0000, v29
    v_mfma_f32_16x16x32_bf16 v[188:191], a[84:87], a[36:39], v[188:191]
    ds_read_b64_tr_b16 a[70:71], v13 offset:6352
    v_lshlrev_b32 v40, 16, v30
    v_and_b32 v30, 0xffff0000, v30
    v_mfma_f32_16x16x32_bf16 v[188:191], a[80:83], a[32:35], v[188:191]
    ds_read_b64_tr_b16 a[72:73], v13 offset:120
    v_lshlrev_b32 v41, 16, v31
    v_and_b32 v31, 0xffff0000, v31
    v_mfma_f32_16x16x32_bf16 v[192:195], a[80:83], a[40:43], v[192:195]
    ds_read_b64_tr_b16 a[74:75], v13 offset:760
    v_add_f32 v43, v22, v23
    v_add_f32 v44, v32, v33
    v_mfma_f32_16x16x32_bf16 v[192:195], a[84:87], a[44:47], v[192:195]
    s_add_u32 m0, s67, 36864
    ds_read_b64_tr_b16 a[76:77], v13 offset:5752
    v_add_f32 v43, v43, v24
    s_waitcnt lgkmcnt(11)
    v_mfma_f32_16x16x32_bf16 v[84:87], a[52:55], a[44:47], v[84:87]
    buffer_load_dwordx4 v8, s[24:27], s70 offen lds
    v_add_f32 v44, v44, v34
    v_mfma_f32_16x16x32_bf16 v[84:87], a[48:51], a[40:43], v[84:87]
    ds_read_b64_tr_b16 a[78:79], v13 offset:6392
    v_add_f32 v43, v43, v25
    v_add_f32 v44, v44, v35
    v_mfma_f32_16x16x32_bf16 v[80:83], a[48:51], a[32:35], v[80:83]
    ds_read_b64_tr_b16 a[80:81], v14 offset:0
    v_add_f32 v43, v43, v26
    v_add_f32 v44, v44, v36
    v_mfma_f32_16x16x32_bf16 v[80:83], a[52:55], a[36:39], v[80:83]
    ds_read_b64_tr_b16 a[82:83], v14 offset:640
    v_add_f32 v43, v43, v27
    v_add_f32 v44, v44, v37
    v_mfma_f32_16x16x32_bf16 v[76:79], a[52:55], a[28:31], v[76:79]
    s_add_u32 m0, s67, 40960
    ds_read_b64_tr_b16 a[84:85], v14 offset:5632
    v_add_f32 v43, v43, v28
    v_add_f32 v44, v44, v38
    v_mfma_f32_16x16x32_bf16 v[76:79], a[48:51], a[24:27], v[76:79]
    buffer_load_dwordx4 v9, s[24:27], s70 offen lds
    s_waitcnt lgkmcnt(11)
    v_mfma_f32_16x16x32_bf16 v[88:91], a[56:59], a[24:27], v[88:91]
    ds_read_b64_tr_b16 a[86:87], v14 offset:6272
    v_add_f32 v43, v43, v29
    v_add_f32 v44, v44, v39
    v_mfma_f32_16x16x32_bf16 v[88:91], a[60:63], a[28:31], v[88:91]
    v_add_f32 v43, v43, v30
    v_add_f32 v44, v44, v40
    v_add_f32 v43, v43, v31
    v_mfma_f32_16x16x32_bf16 v[92:95], a[60:63], a[36:39], v[92:95]
    s_add_u32 m0, s67, 45056
    v_add_f32 v44, v44, v41
    v_add_f32 v43, v43, v44
    s_nop 1
    v_add_f32_dpp v43, v43, v43 row_ror:8 row_mask:0xf bank_mask:0xf
    v_mfma_f32_16x16x32_bf16 v[92:95], a[56:59], a[32:35], v[92:95]
    buffer_load_dwordx4 v10, s[24:27], s70 offen lds
    v_add_f32_dpp v43, v43, v43 row_ror:4 row_mask:0xf bank_mask:0xf
    v_mfma_f32_16x16x32_bf16 v[96:99], a[56:59], a[40:43], v[96:99]
    s_nop 0
    v_add_f32_dpp v43, v43, v43 row_ror:2 row_mask:0xf bank_mask:0xf
    s_nop 1
    v_add_f32_dpp v43, v43, v43 row_ror:1 row_mask:0xf bank_mask:0xf
    v_mfma_f32_16x16x32_bf16 v[96:99], a[60:63], a[44:47], v[96:99]
    s_waitcnt vmcnt(12) lgkmcnt(0)
    s_barrier
    v_mfma_f32_16x16x32_bf16 v[108:111], a[68:71], a[44:47], v[108:111]
    ds_read_b64_tr_b16 a[48:49], v13 offset:12288
    v_mov_b32 v44, v43
    s_nop 1
    v_permlane16_swap_b32 v43, v44
    v_mfma_f32_16x16x32_bf16 v[108:111], a[64:67], a[40:43], v[108:111]
    s_add_u32 m0, s68, 49152
    ds_read_b64_tr_b16 a[50:51], v13 offset:12928
    v_add_f32 v43, v43, v44
    v_mul_f32 v43, 0x3acccccd, v43
    v_mfma_f32_16x16x32_bf16 v[104:107], a[64:67], a[32:35], v[104:107]
    s_mov_b32 s71, 739840
    ds_read_b64_tr_b16 a[52:53], v13 offset:17920
    v_sub_f32 v22, v22, v43
    v_sub_f32 v23, v23, v43
    v_mfma_f32_16x16x32_bf16 v[104:107], a[68:71], a[36:39], v[104:107]
    buffer_load_dwordx4 v70, s[28:31], s71 offen lds
    v_sub_f32 v24, v24, v43
    v_mfma_f32_16x16x32_bf16 v[100:103], a[68:71], a[28:31], v[100:103]
    ds_read_b64_tr_b16 a[54:55], v13 offset:18560
    v_sub_f32 v25, v25, v43
    v_sub_f32 v26, v26, v43
    v_mfma_f32_16x16x32_bf16 v[100:103], a[64:67], a[24:27], v[100:103]
    ds_read_b128 a[0:3], v11 offset:0
    v_sub_f32 v27, v27, v43
    v_mfma_f32_16x16x32_bf16 v[112:115], a[72:75], a[24:27], v[112:115]
    ds_read_b128 a[4:7], v12 offset:0
    v_sub_f32 v28, v28, v43
    v_sub_f32 v29, v29, v43
    v_mfma_f32_16x16x32_bf16 v[112:115], a[76:79], a[28:31], v[112:115]
    ds_read_b128 a[8:11], v11 offset:2048
    v_sub_f32 v30, v30, v43
    v_sub_f32 v31, v31, v43
    v_mfma_f32_16x16x32_bf16 v[116:119], a[76:79], a[36:39], v[116:119]
    buffer_load_dwordx4 v71, s[28:31], s71 offen offset:1024 lds
    v_sub_f32 v32, v32, v43
    v_mfma_f32_16x16x32_bf16 v[116:119], a[72:75], a[32:35], v[116:119]
    ds_read_b128 a[12:15], v12 offset:2048
    v_sub_f32 v33, v33, v43
    v_sub_f32 v34, v34, v43
    v_mfma_f32_16x16x32_bf16 v[120:123], a[72:75], a[40:43], v[120:123]
    ds_read_b128 a[16:19], v11 offset:4096
    v_sub_f32 v35, v35, v43
    v_sub_f32 v36, v36, v43
    v_mfma_f32_16x16x32_bf16 v[120:123], a[76:79], a[44:47], v[120:123]
    ds_read_b128 a[20:23], v12 offset:4096
    v_sub_f32 v37, v37, v43
    v_mfma_f32_16x16x32_bf16 v[132:135], a[84:87], a[44:47], v[132:135]
    ds_read_b64_tr_b16 a[56:57], v13 offset:12328
    ds_read_b64_tr_b16 a[72:73], v13 offset:12408
    v_sub_f32 v38, v38, v43
    v_mfma_f32_16x16x32_bf16 v[132:135], a[80:83], a[40:43], v[132:135]
    buffer_load_dwordx4 v72, s[28:31], s71 offen offset:2048 lds
    v_sub_f32 v39, v39, v43
    v_mfma_f32_16x16x32_bf16 v[128:131], a[80:83], a[32:35], v[128:131]
    ds_read_b64_tr_b16 a[58:59], v13 offset:12968
    v_sub_f32 v40, v40, v43
    v_sub_f32 v41, v41, v43
    v_mfma_f32_16x16x32_bf16 v[128:131], a[84:87], a[36:39], v[128:131]
    ds_read_b64_tr_b16 a[60:61], v13 offset:17960
    v_cvt_pk_bf16_f32 v45, v43, v43
    v_mul_f32 v43, v22, v22
    v_mfma_f32_16x16x32_bf16 v[124:127], a[84:87], a[28:31], v[124:127]
    ds_read_b64_tr_b16 a[62:63], v13 offset:18600
    v_mul_f32 v44, v23, v23
    v_fmac_f32 v43, v24, v24
    v_mfma_f32_16x16x32_bf16 v[124:127], a[80:83], a[24:27], v[124:127]
    s_add_u32 m0, s68, 61440
    ds_read_b64_tr_b16 a[64:65], v13 offset:12368
    v_fmac_f32 v44, v25, v25
    s_waitcnt lgkmcnt(10)
    v_mfma_f32_16x16x32_bf16 v[196:199], a[0:3], a[48:51], v[196:199]
    s_mov_b32 s71, 738560
    ds_read_b64_tr_b16 a[66:67], v13 offset:13008
    ds_read_b64_tr_b16 a[80:81], v14 offset:12288
    v_fmac_f32 v43, v26, v26
    v_mfma_f32_16x16x32_bf16 v[196:199], a[4:7], a[52:55], v[196:199]
    buffer_load_dwordx4 v70, s[28:31], s71 offen lds
    s_waitcnt lgkmcnt(10)
    v_mfma_f32_16x16x32_bf16 v[200:203], a[12:15], a[52:55], v[200:203]
    ds_read_b64_tr_b16 a[68:69], v13 offset:18000
    ds_read_b64_tr_b16 a[82:83], v14 offset:12928
    v_fmac_f32 v44, v27, v27
    v_mfma_f32_16x16x32_bf16 v[200:203], a[8:11], a[48:51], v[200:203]
    ds_read_b64_tr_b16 a[70:71], v13 offset:18640
    v_fmac_f32 v43, v28, v28
    s_waitcnt lgkmcnt(11)
    v_mfma_f32_16x16x32_bf16 v[204:207], a[16:19], a[48:51], v[204:207]
    ds_read_b64_tr_b16 a[74:75], v13 offset:13048
    ds_read_b64_tr_b16 a[84:85], v14 offset:17920
    ds_read_b64_tr_b16 a[86:87], v14 offset:18560
    v_mfma_f32_16x16x32_bf16 v[204:207], a[20:23], a[52:55], v[204:207]
    ds_read_b64_tr_b16 a[76:77], v13 offset:18040
    ds_read_b64_tr_b16 a[78:79], v13 offset:18680
    s_waitcnt lgkmcnt(11)
    v_mfma_f32_16x16x32_bf16 v[216:219], a[20:23], a[60:63], v[216:219]
L_pg6:
    s_cbranch_execz L_pg10
    buffer_load_dwordx4 v71, s[28:31], s71 offen offset:1024 lds
    v_fmac_f32 v44, v29, v29
    v_mfma_f32_16x16x32_bf16 v[216:219], a[16:19], a[56:59], v[216:219]
    v_fmac_f32 v43, v30, v30
    v_fmac_f32 v44, v31, v31
    v_fmac_f32 v43, v32, v32
    v_mfma_f32_16x16x32_bf16 v[212:215], a[8:11], a[56:59], v[212:215]
    v_fmac_f32 v44, v33, v33
    v_fmac_f32 v43, v34, v34
    v_fmac_f32 v44, v35, v35
    v_mfma_f32_16x16x32_bf16 v[212:215], a[12:15], a[60:63], v[212:215]
    v_fmac_f32 v43, v36, v36
    v_fmac_f32 v44, v37, v37
    v_fmac_f32 v43, v38, v38
    v_mfma_f32_16x16x32_bf16 v[208:211], a[4:7], a[60:63], v[208:211]
    v_fmac_f32 v44, v39, v39
    v_fmac_f32 v43, v40, v40
    v_fmac_f32 v44, v41, v41
    v_mfma_f32_16x16x32_bf16 v[208:211], a[0:3], a[56:59], v[208:211]
    s_waitcnt vmcnt(14) lgkmcnt(0)
    s_barrier
    v_mfma_f32_16x16x32_bf16 v[220:223], a[0:3], a[64:67], v[220:223]
    buffer_load_dwordx4 v72, s[28:31], s71 offen offset:2048 lds
    v_lshlrev_b32 v45, 16, v45
    v_mfma_f32_16x16x32_bf16 v[220:223], a[4:7], a[68:71], v[220:223]
    ds_read_b64_tr_b16 a[48:49], v13 offset:24576
    v_add_f32 v43, v43, v44
    s_nop 1
    v_add_f32_dpp v43, v43, v43 row_ror:8 row_mask:0xf bank_mask:0xf
    v_mfma_f32_16x16x32_bf16 v[224:227], a[12:15], a[68:71], v[224:227]
    ds_read_b64_tr_b16 a[50:51], v13 offset:25216
    v_add_f32_dpp v43, v43, v43 row_ror:4 row_mask:0xf bank_mask:0xf
    v_mfma_f32_16x16x32_bf16 v[224:227], a[8:11], a[64:67], v[224:227]
    s_add_u32 m0, s68, 73728
    ds_read_b64_tr_b16 a[52:53], v13 offset:30208
    v_add_f32_dpp v43, v43, v43 row_ror:2 row_mask:0xf bank_mask:0xf
    v_mfma_f32_16x16x32_bf16 v[228:231], a[16:19], a[64:67], v[228:231]
    s_mov_b32 s71, 737280
    ds_read_b64_tr_b16 a[54:55], v13 offset:30848
    v_add_f32_dpp v43, v43, v43 row_ror:1 row_mask:0xf bank_mask:0xf
    v_mfma_f32_16x16x32_bf16 v[228:231], a[20:23], a[68:71], v[228:231]
    buffer_load_dwordx4 v70, s[28:31], s71 offen lds
    v_mfma_f32_16x16x32_bf16 v[240:243], a[20:23], a[76:79], v[240:243]
    ds_read_b64_tr_b16 a[56:57], v13 offset:24616
    v_mov_b32 v44, v43
    s_nop 1
    v_permlane16_swap_b32 v43, v44
    v_mfma_f32_16x16x32_bf16 v[240:243], a[16:19], a[72:75], v[240:243]
    ds_read_b64_tr_b16 a[58:59], v13 offset:25256
    v_add_f32 v43, v43, v44
    v_mul_f32 v43, 0x3acccccd, v43
    v_mfma_f32_16x16x32_bf16 v[236:239], a[8:11], a[72:75], v[236:239]
    ds_read_b64_tr_b16 a[60:61], v13 offset:30248
    v_cvt_pk_bf16_f32 v43, v43, v43
    v_lshlrev_b32 v43, 16, v43
    v_mfma_f32_16x16x32_bf16 v[236:239], a[12:15], a[76:79], v[236:239]
    ds_read_b64_tr_b16 a[62:63], v13 offset:30888
    v_add_f32 v43, 0x3727c5ac, v43
    v_cvt_pk_bf16_f32 v43, v43, v43
    v_mfma_f32_16x16x32_bf16 v[232:235], a[4:7], a[76:79], v[232:235]
    ds_read_b64_tr_b16 a[64:65], v13 offset:24656
    v_lshlrev_b32 v43, 16, v43
    v_sqrt_f32 v43, v43
    v_mfma_f32_16x16x32_bf16 v[232:235], a[0:3], a[72:75], v[232:235]
    buffer_load_dwordx4 v71, s[28:31], s71 offen offset:1024 lds
    v_mfma_f32_16x16x32_bf16 v[244:247], a[0:3], a[80:83], v[244:247]
    ds_read_b64_tr_b16 a[66:67], v13 offset:25296
    v_cvt_pk_bf16_f32 v43, v43, v43
    v_lshlrev_b32 v43, 16, v43
    v_mfma_f32_16x16x32_bf16 v[244:247], a[4:7], a[84:87], v[244:247]
    ds_read_b64_tr_b16 a[68:69], v13 offset:30288
    v_rcp_f32 v43, v43
    v_mfma_f32_16x16x32_bf16 v[248:251], a[12:15], a[84:87], v[248:251]
    ds_read_b64_tr_b16 a[70:71], v13 offset:30928
    v_lshlrev_b32 v42, 2, v42
    v_and_b32 v22, 31, v0
    v_mfma_f32_16x16x32_bf16 v[248:251], a[8:11], a[80:83], v[248:251]
    ds_read_b64_tr_b16 a[72:73], v13 offset:24696
    v_mov_b32 v23, 2147418112
    v_cmp_eq_u32 vcc, 0, v22
    v_mfma_f32_16x16x32_bf16 v[252:255], a[16:19], a[80:83], v[252:255]
    buffer_load_dwordx4 v72, s[28:31], s71 offen offset:2048 lds
    v_lshl_add_u32 v42, v22, 13, v42
    v_mfma_f32_16x16x32_bf16 v[252:255], a[20:23], a[84:87], v[252:255]
    ds_read_b64_tr_b16 a[74:75], v13 offset:25336
    v_cndmask_b32 v43, v43, v45, vcc
    s_waitcnt lgkmcnt(10)
    v_mfma_f32_16x16x32_bf16 v[144:147], a[52:55], a[20:23], v[144:147]
    ds_read_b64_tr_b16 a[76:77], v13 offset:30328
    v_cmp_gt_u32 vcc, 2, v22
    s_nop 0
    v_mfma_f32_16x16x32_bf16 v[144:147], a[48:51], a[16:19], v[144:147]
    ds_read_b64_tr_b16 a[78:79], v13 offset:30968
    v_cndmask_b32 v42, v23, v42, vcc
    buffer_store_dword v43, v42, s[44:47], 0 offen sc1
    v_mfma_f32_16x16x32_bf16 v[140:143], a[48:51], a[8:11], v[140:143]
    s_add_u32 m0, s67, 0
    ds_read_b64_tr_b16 a[80:81], v14 offset:24576
    buffer_load_dword v75, off, s[52:55], 0 sc1
    v_mfma_f32_16x16x32_bf16 v[140:143], a[52:55], a[12:15], v[140:143]
    s_mov_b32 s70, 512
    ds_read_b64_tr_b16 a[82:83], v14 offset:25216
    v_mfma_f32_16x16x32_bf16 v[136:139], a[52:55], a[4:7], v[136:139]
    s_mov_b64 exec, s[72:73]
    buffer_load_dwordx4 v5, s[24:27], s70 offen lds
    s_mov_b64 exec, -1
    v_mfma_f32_16x16x32_bf16 v[136:139], a[48:51], a[0:3], v[136:139]
    ds_read_b64_tr_b16 a[84:85], v14 offset:30208
    s_waitcnt lgkmcnt(11)
    v_mfma_f32_16x16x32_bf16 v[148:151], a[56:59], a[0:3], v[148:151]
    ds_read_b64_tr_b16 a[86:87], v14 offset:30848
    v_mfma_f32_16x16x32_bf16 v[148:151], a[60:63], a[4:7], v[148:151]
    v_mfma_f32_16x16x32_bf16 v[152:155], a[60:63], a[12:15], v[152:155]
    s_add_u32 m0, s67, 4096
    v_mfma_f32_16x16x32_bf16 v[152:155], a[56:59], a[8:11], v[152:155]
    buffer_load_dwordx4 v6, s[24:27], s70 offen lds
    v_mfma_f32_16x16x32_bf16 v[156:159], a[56:59], a[16:19], v[156:159]
    v_mfma_f32_16x16x32_bf16 v[156:159], a[60:63], a[20:23], v[156:159]
    s_waitcnt vmcnt(19) lgkmcnt(0)
    s_barrier
    v_mfma_f32_16x16x32_bf16 v[168:171], a[68:71], a[20:23], v[168:171]
    ds_read_b64_tr_b16 a[48:49], v13 offset:36864
    v_mfma_f32_16x16x32_bf16 v[168:171], a[64:67], a[16:19], v[168:171]
    ds_read_b64_tr_b16 a[50:51], v13 offset:37504
    v_mfma_f32_16x16x32_bf16 v[164:167], a[64:67], a[8:11], v[164:167]
    ds_read_b64_tr_b16 a[52:53], v13 offset:42496
    v_mfma_f32_16x16x32_bf16 v[164:167], a[68:71], a[12:15], v[164:167]
    s_add_u32 m0, s67, 8192
    ds_read_b64_tr_b16 a[54:55], v13 offset:43136
    v_mfma_f32_16x16x32_bf16 v[160:163], a[68:71], a[4:7], v[160:163]
    buffer_load_dwordx4 v7, s[24:27], s70 offen lds
    v_mfma_f32_16x16x32_bf16 v[160:163], a[64:67], a[0:3], v[160:163]
    ds_read_b64_tr_b16 a[56:57], v13 offset:36904
    v_mfma_f32_16x16x32_bf16 v[172:175], a[72:75], a[0:3], v[172:175]
    ds_read_b64_tr_b16 a[58:59], v13 offset:37544
    v_mfma_f32_16x16x32_bf16 v[172:175], a[76:79], a[4:7], v[172:175]
    ds_read_b64_tr_b16 a[60:61], v13 offset:42536
    v_mfma_f32_16x16x32_bf16 v[176:179], a[76:79], a[12:15], v[176:179]
    s_add_u32 m0, s67, 12288
    ds_read_b64_tr_b16 a[62:63], v13 offset:43176
    v_mfma_f32_16x16x32_bf16 v[176:179], a[72:75], a[8:11], v[176:179]
    buffer_load_dwordx4 v8, s[24:27], s70 offen lds
    v_mfma_f32_16x16x32_bf16 v[180:183], a[72:75], a[16:19], v[180:183]
    ds_read_b64_tr_b16 a[64:65], v13 offset:36944
    v_mfma_f32_16x16x32_bf16 v[180:183], a[76:79], a[20:23], v[180:183]
    ds_read_b64_tr_b16 a[66:67], v13 offset:37584
    v_mfma_f32_16x16x32_bf16 v[192:195], a[84:87], a[20:23], v[192:195]
    ds_read_b64_tr_b16 a[68:69], v13 offset:42576
    v_mfma_f32_16x16x32_bf16 v[192:195], a[80:83], a[16:19], v[192:195]
    ds_read_b64_tr_b16 a[70:71], v13 offset:43216
    v_mfma_f32_16x16x32_bf16 v[188:191], a[80:83], a[8:11], v[188:191]
    s_add_u32 m0, s67, 16384
    ds_read_b64_tr_b16 a[72:73], v13 offset:36984
    v_mfma_f32_16x16x32_bf16 v[188:191], a[84:87], a[12:15], v[188:191]
    buffer_load_dwordx4 v9, s[24:27], s70 offen lds
    v_mfma_f32_16x16x32_bf16 v[184:187], a[84:87], a[4:7], v[184:187]
    ds_read_b64_tr_b16 a[74:75], v13 offset:37624
    v_mfma_f32_16x16x32_bf16 v[184:187], a[80:83], a[0:3], v[184:187]
    ds_read_b64_tr_b16 a[76:77], v13 offset:42616
    s_waitcnt lgkmcnt(11)
    v_mfma_f32_16x16x32_bf16 v[76:79], a[48:51], a[0:3], v[76:79]
    ds_read_b64_tr_b16 a[78:79], v13 offset:43256
    v_mfma_f32_16x16x32_bf16 v[76:79], a[52:55], a[4:7], v[76:79]
    s_add_u32 m0, s67, 20480
    ds_read_b64_tr_b16 a[80:81], v14 offset:36864
    v_mfma_f32_16x16x32_bf16 v[80:83], a[52:55], a[12:15], v[80:83]
    buffer_load_dwordx4 v10, s[24:27], s70 offen lds
    v_mfma_f32_16x16x32_bf16 v[80:83], a[48:51], a[8:11], v[80:83]
    ds_read_b64_tr_b16 a[82:83], v14 offset:37504
    v_mfma_f32_16x16x32_bf16 v[84:87], a[48:51], a[16:19], v[84:87]
    ds_read_b64_tr_b16 a[84:85], v14 offset:42496
    v_mfma_f32_16x16x32_bf16 v[84:87], a[52:55], a[20:23], v[84:87]
    ds_read_b64_tr_b16 a[86:87], v14 offset:43136
    s_waitcnt lgkmcnt(12)
    v_mfma_f32_16x16x32_bf16 v[96:99], a[60:63], a[20:23], v[96:99]
    s_add_u32 m0, s68, 86016
    v_mfma_f32_16x16x32_bf16 v[96:99], a[56:59], a[16:19], v[96:99]
    s_mov_b32 s71, 985600
    v_mfma_f32_16x16x32_bf16 v[92:95], a[56:59], a[8:11], v[92:95]
    buffer_load_dwordx4 v70, s[28:31], s71 offen lds
    v_mfma_f32_16x16x32_bf16 v[92:95], a[60:63], a[12:15], v[92:95]
    v_mfma_f32_16x16x32_bf16 v[88:91], a[60:63], a[4:7], v[88:91]
    v_mfma_f32_16x16x32_bf16 v[88:91], a[56:59], a[0:3], v[88:91]
    s_waitcnt vmcnt(15) lgkmcnt(0)
    s_barrier
    v_mfma_f32_16x16x32_bf16 v[100:103], a[64:67], a[0:3], v[100:103]
    ds_read_b64_tr_b16 a[48:49], v15 offset:0
    v_mfma_f32_16x16x32_bf16 v[100:103], a[68:71], a[4:7], v[100:103]
    buffer_load_dwordx4 v71, s[28:31], s71 offen offset:1024 lds
    v_mfma_f32_16x16x32_bf16 v[104:107], a[68:71], a[12:15], v[104:107]
    ds_read_b64_tr_b16 a[50:51], v15 offset:640
    v_mfma_f32_16x16x32_bf16 v[104:107], a[64:67], a[8:11], v[104:107]
    ds_read_b64_tr_b16 a[52:53], v15 offset:5632
    v_mfma_f32_16x16x32_bf16 v[108:111], a[64:67], a[16:19], v[108:111]
    ds_read_b64_tr_b16 a[54:55], v15 offset:6272
    v_mfma_f32_16x16x32_bf16 v[108:111], a[68:71], a[20:23], v[108:111]
    ds_read_b128 a[40:43], v11 offset:28672
    v_mfma_f32_16x16x32_bf16 v[120:123], a[76:79], a[20:23], v[120:123]
    ds_read_b128 a[44:47], v12 offset:28672
    v_mfma_f32_16x16x32_bf16 v[120:123], a[72:75], a[16:19], v[120:123]
    buffer_load_dwordx4 v72, s[28:31], s71 offen offset:2048 lds
    v_mfma_f32_16x16x32_bf16 v[116:119], a[72:75], a[8:11], v[116:119]
    ds_read_b128 a[32:35], v11 offset:26624
    v_mfma_f32_16x16x32_bf16 v[116:119], a[76:79], a[12:15], v[116:119]
    ds_read_b128 a[36:39], v12 offset:26624
    v_mfma_f32_16x16x32_bf16 v[112:115], a[76:79], a[4:7], v[112:115]
    s_add_u32 m0, s68, 98304
    ds_read_b128 a[24:27], v11 offset:24576
    v_mfma_f32_16x16x32_bf16 v[112:115], a[72:75], a[0:3], v[112:115]
    s_mov_b32 s71, 984320
    ds_read_b128 a[28:31], v12 offset:24576
    v_mfma_f32_16x16x32_bf16 v[124:127], a[80:83], a[0:3], v[124:127]
    buffer_load_dwordx4 v70, s[28:31], s71 offen lds
    s_waitcnt vmcnt(10)
    v_mfma_f32_16x16x32_bf16 v[124:127], a[84:87], a[4:7], v[124:127]
    ds_read_b64_tr_b16 a[56:57], v15 offset:40
    ds_read_b64_tr_b16 a[72:73], v15 offset:120
    v_cmp_ne_u32 vcc, 1, v75
    v_mfma_f32_16x16x32_bf16 v[128:131], a[84:87], a[12:15], v[128:131]
    ds_read_b64_tr_b16 a[58:59], v15 offset:680
    s_nop 0
    s_cbranch_vccnz L_spin_qkvr
L_back_qkvr:
    v_mfma_f32_16x16x32_bf16 v[128:131], a[80:83], a[8:11], v[128:131]
    ds_read_b64_tr_b16 a[60:61], v15 offset:5672
    v_mfma_f32_16x16x32_bf16 v[132:135], a[80:83], a[16:19], v[132:135]
    ds_read_b64_tr_b16 a[62:63], v15 offset:6312
    v_mfma_f32_16x16x32_bf16 v[132:135], a[84:87], a[20:23], v[132:135]
    ds_read_b64_tr_b16 a[64:65], v15 offset:80
    s_waitcnt lgkmcnt(10)
    v_mfma_f32_16x16x32_bf16 v[204:207], a[44:47], a[52:55], v[204:207]
    ds_read_b64_tr_b16 a[66:67], v15 offset:720
    ds_read_b64_tr_b16 a[80:81], v16 offset:0
    v_mfma_f32_16x16x32_bf16 v[204:207], a[40:43], a[48:51], v[204:207]
    buffer_load_dwordx4 v71, s[28:31], s71 offen offset:1024 lds
    s_waitcnt lgkmcnt(10)
    v_mfma_f32_16x16x32_bf16 v[200:203], a[32:35], a[48:51], v[200:203]
    ds_read_b64_tr_b16 a[68:69], v15 offset:5712
    ds_read_b64_tr_b16 a[82:83], v16 offset:640
    v_mfma_f32_16x16x32_bf16 v[200:203], a[36:39], a[52:55], v[200:203]
    ds_read_b64_tr_b16 a[70:71], v15 offset:6352
    s_waitcnt lgkmcnt(11)
    v_mfma_f32_16x16x32_bf16 v[196:199], a[28:31], a[52:55], v[196:199]
    ds_read_b64_tr_b16 a[74:75], v15 offset:760
    ds_read_b64_tr_b16 a[84:85], v16 offset:5632
    ds_read_b64_tr_b16 a[86:87], v16 offset:6272
    v_mfma_f32_16x16x32_bf16 v[196:199], a[24:27], a[48:51], v[196:199]
    ds_read_b64_tr_b16 a[76:77], v15 offset:5752
    ds_read_b64_tr_b16 a[78:79], v15 offset:6392
    s_waitcnt lgkmcnt(11)
    v_mfma_f32_16x16x32_bf16 v[208:211], a[24:27], a[56:59], v[208:211]
    buffer_load_dwordx4 v72, s[28:31], s71 offen offset:2048 lds
    v_mfma_f32_16x16x32_bf16 v[208:211], a[28:31], a[60:63], v[208:211]
    v_mfma_f32_16x16x32_bf16 v[212:215], a[36:39], a[60:63], v[212:215]
    v_mfma_f32_16x16x32_bf16 v[212:215], a[32:35], a[56:59], v[212:215]
    v_mfma_f32_16x16x32_bf16 v[216:219], a[40:43], a[56:59], v[216:219]
    s_add_u32 m0, s68, 110592
    v_mfma_f32_16x16x32_bf16 v[216:219], a[44:47], a[60:63], v[216:219]
    s_mov_b32 s71, 983040
    s_waitcnt lgkmcnt(0)
    s_barrier
    v_mfma_f32_16x16x32_bf16 v[228:231], a[44:47], a[68:71], v[228:231]
    buffer_load_dwordx4 v70, s[28:31], s71 offen lds
    v_mfma_f32_16x16x32_bf16 v[228:231], a[40:43], a[64:67], v[228:231]
    ds_read_b64_tr_b16 a[48:49], v15 offset:12288
    s_lshr_b32 s63, s2, 3
    v_mfma_f32_16x16x32_bf16 v[224:227], a[32:35], a[64:67], v[224:227]
    ds_read_b64_tr_b16 a[50:51], v15 offset:12928
    s_lshl_b32 s63, s63, 5
    v_mfma_f32_16x16x32_bf16 v[224:227], a[36:39], a[68:71], v[224:227]
    ds_read_b64_tr_b16 a[52:53], v15 offset:17920
    s_and_b32 s64, s2, 7
    v_mfma_f32_16x16x32_bf16 v[220:223], a[28:31], a[68:71], v[220:223]
    ds_read_b64_tr_b16 a[54:55], v15 offset:18560
    s_add_u32 s63, s63, s64
    v_mfma_f32_16x16x32_bf16 v[220:223], a[24:27], a[64:67], v[220:223]
    buffer_load_dwordx4 v71, s[28:31], s71 offen offset:1024 lds
    v_mfma_f32_16x16x32_bf16 v[232:235], a[24:27], a[72:75], v[232:235]
    ds_read_b64_tr_b16 a[56:57], v15 offset:12328
    s_lshl2_add_u32 s63, s63, 20480
    v_mfma_f32_16x16x32_bf16 v[232:235], a[28:31], a[76:79], v[232:235]
    ds_read_b64_tr_b16 a[58:59], v15 offset:12968
    v_cmp_eq_u32 vcc, 0, v0
    v_mfma_f32_16x16x32_bf16 v[236:239], a[36:39], a[76:79], v[236:239]
    ds_read_b64_tr_b16 a[60:61], v15 offset:17960
    v_mov_b32 v60, s63
    v_mfma_f32_16x16x32_bf16 v[236:239], a[32:35], a[72:75], v[236:239]
    ds_read_b64_tr_b16 a[62:63], v15 offset:18600
    v_mov_b32 v61, 2147418112
    v_mfma_f32_16x16x32_bf16 v[240:243], a[40:43], a[72:75], v[240:243]
    ds_read_b64_tr_b16 a[64:65], v15 offset:12368
    v_cndmask_b32 v60, v61, v60, vcc
    v_mfma_f32_16x16x32_bf16 v[240:243], a[44:47], a[76:79], v[240:243]
    buffer_load_dwordx4 v72, s[28:31], s71 offen offset:2048 lds
    v_mfma_f32_16x16x32_bf16 v[252:255], a[44:47], a[84:87], v[252:255]
    ds_read_b64_tr_b16 a[66:67], v15 offset:13008
    v_mov_b32 v61, 1
    v_mfma_f32_16x16x32_bf16 v[252:255], a[40:43], a[80:83], v[252:255]
    ds_read_b64_tr_b16 a[68:69], v15 offset:18000
    buffer_store_dword v61, v60, s[44:47], 0 offen sc1
    v_mfma_f32_16x16x32_bf16 v[248:251], a[32:35], a[80:83], v[248:251]
    s_add_u32 m0, s67, 24576
    ds_read_b64_tr_b16 a[70:71], v15 offset:18640
    v_and_b32 v60, 15, v0
    v_mfma_f32_16x16x32_bf16 v[248:251], a[36:39], a[84:87], v[248:251]
    s_mov_b32 s70, 640
    ds_read_b64_tr_b16 a[72:73], v15 offset:12408
    v_bfe_u32 v61, v0, 4, 2
    v_mfma_f32_16x16x32_bf16 v[244:247], a[28:31], a[84:87], v[244:247]
    s_mov_b64 exec, s[72:73]
    buffer_load_dwordx4 v5, s[24:27], s70 offen lds
    s_mov_b64 exec, -1
    v_mfma_f32_16x16x32_bf16 v[244:247], a[24:27], a[80:83], v[244:247]
    ds_read_b64_tr_b16 a[74:75], v15 offset:13048
    s_waitcnt lgkmcnt(10)
    v_mfma_f32_16x16x32_bf16 v[136:139], a[48:51], a[24:27], v[136:139]
    ds_read_b64_tr_b16 a[76:77], v15 offset:18040
    s_mul_i32 s63, s61, 176
    v_mfma_f32_16x16x32_bf16 v[136:139], a[52:55], a[28:31], v[136:139]
    ds_read_b64_tr_b16 a[78:79], v15 offset:18680
    s_mul_i32 s64, s60, 48
    v_mfma_f32_16x16x32_bf16 v[140:143], a[52:55], a[36:39], v[140:143]
    ds_read_b64_tr_b16 a[80:81], v16 offset:12288
    s_add_u32 s63, s63, s64
    v_mfma_f32_16x16x32_bf16 v[140:143], a[48:51], a[32:35], v[140:143]
    s_add_u32 m0, s67, 28672
    ds_read_b64_tr_b16 a[82:83], v16 offset:12928
    s_sub_u32 s63, s63, 16
    v_mfma_f32_16x16x32_bf16 v[144:147], a[48:51], a[40:43], v[144:147]
    buffer_load_dwordx4 v6, s[24:27], s70 offen lds
    v_mfma_f32_16x16x32_bf16 v[144:147], a[52:55], a[44:47], v[144:147]
    ds_read_b64_tr_b16 a[84:85], v16 offset:17920
    s_waitcnt lgkmcnt(11)
    v_mfma_f32_16x16x32_bf16 v[156:159], a[60:63], a[44:47], v[156:159]
    ds_read_b64_tr_b16 a[86:87], v16 offset:18560
    v_add_u32 v64, s63, v1
    v_mfma_f32_16x16x32_bf16 v[156:159], a[56:59], a[40:43], v[156:159]
    ds_read_b64_tr_b16 a[48:49], v15 offset:24576
    v_max_i32 v64, 0, v64
    v_mfma_f32_16x16x32_bf16 v[152:155], a[56:59], a[32:35], v[152:155]
    s_add_u32 m0, s67, 32768
    ds_read_b64_tr_b16 a[50:51], v15 offset:25216
    v_min_i32 v64, 2047, v64
    v_mfma_f32_16x16x32_bf16 v[152:155], a[60:63], a[36:39], v[152:155]
    buffer_load_dwordx4 v7, s[24:27], s70 offen lds
    v_mfma_f32_16x16x32_bf16 v[148:151], a[60:63], a[28:31], v[148:151]
    ds_read_b64_tr_b16 a[52:53], v15 offset:30208
    v_lshlrev_b32 v64, 2, v64
    v_mfma_f32_16x16x32_bf16 v[148:151], a[56:59], a[24:27], v[148:151]
    ds_read_b64_tr_b16 a[54:55], v15 offset:30848
    s_waitcnt lgkmcnt(12)
    v_mfma_f32_16x16x32_bf16 v[160:163], a[64:67], a[24:27], v[160:163]
    ds_read_b64_tr_b16 a[56:57], v15 offset:24616
    s_lshl_b32 s69, s60, 9
    v_mfma_f32_16x16x32_bf16 v[160:163], a[68:71], a[28:31], v[160:163]
    ds_read_b64_tr_b16 a[58:59], v15 offset:25256
    s_add_u32 s69, s69, 159744
    v_mfma_f32_16x16x32_bf16 v[164:167], a[68:71], a[36:39], v[164:167]
    ds_read_b64_tr_b16 a[60:61], v15 offset:30248
    v_lshl_add_u32 v65, v60, 2, s69
    v_mfma_f32_16x16x32_bf16 v[164:167], a[64:67], a[32:35], v[164:167]
    s_add_u32 m0, s67, 36864
    ds_read_b64_tr_b16 a[62:63], v15 offset:30888
    v_lshl_add_u32 v66, v61, 4, s69
    v_mfma_f32_16x16x32_bf16 v[168:171], a[64:67], a[40:43], v[168:171]
    buffer_load_dwordx4 v8, s[24:27], s70 offen lds
    v_mfma_f32_16x16x32_bf16 v[168:171], a[68:71], a[44:47], v[168:171]
    s_mov_b32 s74, 0xaaaaaaaa
    s_waitcnt lgkmcnt(12)
    v_mfma_f32_16x16x32_bf16 v[180:183], a[76:79], a[44:47], v[180:183]
    ds_read_b64_tr_b16 a[64:65], v15 offset:24656
    s_mov_b32 s75, 0xaaaaaaaa
    v_mfma_f32_16x16x32_bf16 v[180:183], a[72:75], a[40:43], v[180:183]
    ds_read_b64_tr_b16 a[66:67], v15 offset:25296
    s_mov_b32 s76, 0xfff0ffff
    v_mfma_f32_16x16x32_bf16 v[176:179], a[72:75], a[32:35], v[176:179]
    s_add_u32 m0, s67, 40960
    ds_read_b64_tr_b16 a[68:69], v15 offset:30288
    s_mov_b32 s77, 0xf000ff00
    v_mfma_f32_16x16x32_bf16 v[176:179], a[76:79], a[36:39], v[176:179]
    buffer_load_dwordx4 v9, s[24:27], s70 offen lds
    v_mfma_f32_16x16x32_bf16 v[172:175], a[76:79], a[28:31], v[172:175]
    ds_read_b64_tr_b16 a[70:71], v15 offset:30928
    s_mov_b32 s78, 0xffc0fffc
    v_mfma_f32_16x16x32_bf16 v[172:175], a[72:75], a[24:27], v[172:175]
    s_mov_b32 s79, 0xc000fc00
    s_waitcnt lgkmcnt(12)
    v_mfma_f32_16x16x32_bf16 v[184:187], a[80:83], a[24:27], v[184:187]
    ds_read_b64_tr_b16 a[72:73], v15 offset:24696
    s_mov_b32 s4, 0xffff
    v_mfma_f32_16x16x32_bf16 v[184:187], a[84:87], a[28:31], v[184:187]
    ds_read_b64_tr_b16 a[74:75], v15 offset:25336
    s_mov_b32 s5, 0x0
    v_mfma_f32_16x16x32_bf16 v[188:191], a[84:87], a[36:39], v[188:191]
    s_add_u32 m0, s67, 45056
    ds_read_b64_tr_b16 a[76:77], v15 offset:30328
    s_mov_b32 s6, 0xffff0000
    v_mfma_f32_16x16x32_bf16 v[188:191], a[80:83], a[32:35], v[188:191]
    buffer_load_dwordx4 v10, s[24:27], s70 offen lds
    v_mfma_f32_16x16x32_bf16 v[192:195], a[80:83], a[40:43], v[192:195]
    ds_read_b64_tr_b16 a[78:79], v15 offset:30968
    s_mov_b32 s7, 0x0
    v_mfma_f32_16x16x32_bf16 v[192:195], a[84:87], a[44:47], v[192:195]
    s_mov_b32 s8, 0x0
    s_waitcnt lgkmcnt(12)
    v_mfma_f32_16x16x32_bf16 v[84:87], a[52:55], a[44:47], v[84:87]
    s_add_u32 m0, s68, 122880
    ds_read_b64_tr_b16 a[80:81], v16 offset:24576
    s_mov_b32 s9, 0xffff
    v_mfma_f32_16x16x32_bf16 v[84:87], a[48:51], a[40:43], v[84:87]
    s_mov_b32 s71, 1231360
    ds_read_b64_tr_b16 a[82:83], v16 offset:25216
    s_mov_b32 s10, 0x0
    v_mfma_f32_16x16x32_bf16 v[80:83], a[48:51], a[32:35], v[80:83]
    buffer_load_dwordx4 v70, s[28:31], s71 offen lds
    v_mfma_f32_16x16x32_bf16 v[80:83], a[52:55], a[36:39], v[80:83]
    ds_read_b64_tr_b16 a[84:85], v16 offset:30208
    s_mov_b32 s11, 0xffff0000
    v_mfma_f32_16x16x32_bf16 v[76:79], a[52:55], a[28:31], v[76:79]
    ds_read_b64_tr_b16 a[86:87], v16 offset:30848
    v_mov_b32 v63, 0x0c0c0c0c
    v_mfma_f32_16x16x32_bf16 v[76:79], a[48:51], a[24:27], v[76:79]
    v_mov_b32 v60, 0xc0c0100
    s_waitcnt lgkmcnt(12)
    v_mfma_f32_16x16x32_bf16 v[88:91], a[56:59], a[24:27], v[88:91]
    v_mov_b32 v61, 0x1000c0c
    v_cndmask_b32 v60, v60, v61, s[74:75]
    v_mfma_f32_16x16x32_bf16 v[88:91], a[60:63], a[28:31], v[88:91]
    v_cndmask_b32 v17, v63, v60, s[76:77]
    v_cndmask_b32 v19, v60, v63, s[76:77]
    v_mfma_f32_16x16x32_bf16 v[92:95], a[60:63], a[36:39], v[92:95]
    buffer_load_dwordx4 v71, s[28:31], s71 offen offset:1024 lds
    v_mfma_f32_16x16x32_bf16 v[92:95], a[56:59], a[32:35], v[92:95]
    v_mov_b32 v60, 0xc0c0302
    v_mov_b32 v61, 0x3020c0c
    v_mfma_f32_16x16x32_bf16 v[96:99], a[56:59], a[40:43], v[96:99]
    v_cndmask_b32 v60, v60, v61, s[74:75]
    v_cndmask_b32 v18, v63, v60, s[78:79]
    v_mfma_f32_16x16x32_bf16 v[96:99], a[60:63], a[44:47], v[96:99]
    s_waitcnt vmcnt(9) lgkmcnt(0)
    s_barrier
    v_mfma_f32_16x16x32_bf16 v[108:111], a[68:71], a[44:47], v[108:111]
    ds_read_b64_tr_b16 a[48:49], v15 offset:36864
    v_cndmask_b32 v20, v60, v63, s[78:79]
    v_mfma_f32_16x16x32_bf16 v[108:111], a[64:67], a[40:43], v[108:111]
    buffer_load_dwordx4 v72, s[28:31], s71 offen offset:2048 lds
    v_mfma_f32_16x16x32_bf16 v[104:107], a[64:67], a[32:35], v[104:107]
    ds_read_b64_tr_b16 a[50:51], v15 offset:37504
    s_and_b32 s63, s2, 7
    v_mfma_f32_16x16x32_bf16 v[104:107], a[68:71], a[36:39], v[104:107]
    ds_read_b64_tr_b16 a[52:53], v15 offset:42496
    s_lshr_b32 s64, s2, 3
    v_mfma_f32_16x16x32_bf16 v[100:103], a[68:71], a[28:31], v[100:103]
    ds_read_b64_tr_b16 a[54:55], v15 offset:43136
    s_lshr_b32 s84, s63, 1
    v_mfma_f32_16x16x32_bf16 v[100:103], a[64:67], a[24:27], v[100:103]
    s_add_u32 m0, s68, 135168
    ds_read_b128 a[0:3], v11 offset:0
    v_mfma_f32_16x16x32_bf16 v[112:115], a[72:75], a[24:27], v[112:115]
    s_mov_b32 s71, 1230080
    ds_read_b128 a[4:7], v12 offset:0
    s_lshl_b32 s84, s84, 3
    v_mfma_f32_16x16x32_bf16 v[112:115], a[76:79], a[28:31], v[112:115]
    buffer_load_dwordx4 v70, s[28:31], s71 offen lds
    v_mfma_f32_16x16x32_bf16 v[116:119], a[76:79], a[36:39], v[116:119]
    ds_read_b128 a[8:11], v11 offset:2048
    s_lshr_b32 s65, s64, 2
    v_mfma_f32_16x16x32_bf16 v[116:119], a[72:75], a[32:35], v[116:119]
    ds_read_b128 a[12:15], v12 offset:2048
    s_add_u32 s84, s84, s65
    v_mfma_f32_16x16x32_bf16 v[120:123], a[72:75], a[40:43], v[120:123]
    ds_read_b128 a[16:19], v11 offset:4096
    s_and_b32 s85, s63, 1
    v_mfma_f32_16x16x32_bf16 v[120:123], a[76:79], a[44:47], v[120:123]
    ds_read_b128 a[20:23], v12 offset:4096
    v_mfma_f32_16x16x32_bf16 v[132:135], a[84:87], a[44:47], v[132:135]
    buffer_load_dwordx4 v71, s[28:31], s71 offen offset:1024 lds
    v_mfma_f32_16x16x32_bf16 v[132:135], a[80:83], a[40:43], v[132:135]
    ds_read_b64_tr_b16 a[56:57], v15 offset:36904
    s_lshl_b32 s85, s85, 2
    v_mfma_f32_16x16x32_bf16 v[128:131], a[80:83], a[32:35], v[128:131]
    ds_read_b64_tr_b16 a[58:59], v15 offset:37544
    s_and_b32 s65, s64, 3
    v_mfma_f32_16x16x32_bf16 v[128:131], a[84:87], a[36:39], v[128:131]
    ds_read_b64_tr_b16 a[60:61], v15 offset:42536
    s_add_u32 s85, s85, s65
    v_mfma_f32_16x16x32_bf16 v[124:127], a[84:87], a[28:31], v[124:127]
    ds_read_b64_tr_b16 a[62:63], v15 offset:43176
    s_mul_i32 s63, s60, 13
    v_mfma_f32_16x16x32_bf16 v[124:127], a[80:83], a[24:27], v[124:127]
    ds_read_b64_tr_b16 a[64:65], v15 offset:36944
    s_waitcnt lgkmcnt(9)
    v_mfma_f32_16x16x32_bf16 v[196:199], a[0:3], a[48:51], v[196:199]
    ds_read_b64_tr_b16 a[66:67], v15 offset:37584
    s_add_u32 s63, s63, 20
    v_mfma_f32_16x16x32_bf16 v[196:199], a[4:7], a[52:55], v[196:199]
    buffer_load_dwordx4 v72, s[28:31], s71 offen offset:2048 lds
    s_waitcnt lgkmcnt(8)
    v_mfma_f32_16x16x32_bf16 v[200:203], a[12:15], a[52:55], v[200:203]
    ds_read_b64_tr_b16 a[68:69], v15 offset:42576
    s_mul_i32 s64, s85, 378880
    v_mfma_f32_16x16x32_bf16 v[200:203], a[8:11], a[48:51], v[200:203]
    ds_read_b64_tr_b16 a[70:71], v15 offset:43216
    s_waitcnt lgkmcnt(8)
    v_mfma_f32_16x16x32_bf16 v[204:207], a[16:19], a[48:51], v[204:207]
    s_add_u32 m0, s68, 147456
    ds_read_b64_tr_b16 a[72:73], v15 offset:36984
    s_mul_i32 s65, s63, 5120
    v_mfma_f32_16x16x32_bf16 v[204:207], a[20:23], a[52:55], v[204:207]
    s_mov_b32 s71, 1228800
    ds_read_b64_tr_b16 a[74:75], v15 offset:37624
    s_waitcnt lgkmcnt(6)
    v_mfma_f32_16x16x32_bf16 v[216:219], a[20:23], a[60:63], v[216:219]
    buffer_load_dwordx4 v70, s[28:31], s71 offen lds
    v_mfma_f32_16x16x32_bf16 v[216:219], a[16:19], a[56:59], v[216:219]
    ds_read_b64_tr_b16 a[76:77], v15 offset:42616
    s_add_u32 s87, s64, s65
    v_mfma_f32_16x16x32_bf16 v[212:215], a[8:11], a[56:59], v[212:215]
    ds_read_b64_tr_b16 a[78:79], v15 offset:43256
    s_add_u32 s88, s64, s67
    v_mfma_f32_16x16x32_bf16 v[212:215], a[12:15], a[60:63], v[212:215]
    ds_read_b64_tr_b16 a[80:81], v16 offset:36864
    s_mul_i32 s3, s84, 303104
    v_mfma_f32_16x16x32_bf16 v[208:211], a[4:7], a[60:63], v[208:211]
    ds_read_b64_tr_b16 a[82:83], v16 offset:37504
    s_lshl_b32 s63, s63, 12
    v_mfma_f32_16x16x32_bf16 v[208:211], a[0:3], a[56:59], v[208:211]
    ds_read_b64_tr_b16 a[84:85], v16 offset:42496
    s_waitcnt lgkmcnt(7)
    v_mfma_f32_16x16x32_bf16 v[220:223], a[0:3], a[64:67], v[220:223]
    buffer_load_dwordx4 v71, s[28:31], s71 offen offset:1024 lds
    v_mfma_f32_16x16x32_bf16 v[220:223], a[4:7], a[68:71], v[220:223]
    ds_read_b64_tr_b16 a[86:87], v16 offset:43136
    s_add_u32 s89, s3, s63
    v_mfma_f32_16x16x32_bf16 v[224:227], a[12:15], a[68:71], v[224:227]
    ds_read_b64_tr_b16 a[48:49], v15 offset:49152
    v_lshlrev_b32 v3, 4, v1
    v_mfma_f32_16x16x32_bf16 v[224:227], a[8:11], a[64:67], v[224:227]
    ds_read_b64_tr_b16 a[50:51], v15 offset:49792
    v_add_u32 v4, 4096, v3
    v_mfma_f32_16x16x32_bf16 v[228:231], a[16:19], a[64:67], v[228:231]
    ds_read_b64_tr_b16 a[52:53], v15 offset:54784
    s_mul_i32 s63, s61, 11
    v_mfma_f32_16x16x32_bf16 v[228:231], a[20:23], a[68:71], v[228:231]
    buffer_load_dwordx4 v72, s[28:31], s71 offen offset:2048 lds
    s_waitcnt lgkmcnt(7)
    v_mfma_f32_16x16x32_bf16 v[240:243], a[20:23], a[76:79], v[240:243]
    ds_read_b64_tr_b16 a[54:55], v15 offset:55424
    s_mul_i32 s64, s60, 3
    v_mfma_f32_16x16x32_bf16 v[240:243], a[16:19], a[72:75], v[240:243]
    ds_read_b64_tr_b16 a[56:57], v15 offset:49192
    s_add_u32 s63, s63, s64
    v_mfma_f32_16x16x32_bf16 v[236:239], a[8:11], a[72:75], v[236:239]
    ds_read_b64_tr_b16 a[58:59], v15 offset:49832
    s_add_u32 s64, s63, -1
    v_mfma_f32_16x16x32_bf16 v[236:239], a[12:15], a[76:79], v[236:239]
    s_add_u32 m0, s68, 49152
    ds_read_b64_tr_b16 a[60:61], v15 offset:54824
    s_lshr_b32 s65, s64, 2
    v_mfma_f32_16x16x32_bf16 v[232:235], a[4:7], a[76:79], v[232:235]
    s_mov_b32 s71, 1477120
    ds_read_b64_tr_b16 a[62:63], v15 offset:55464
    s_mul_i32 s65, s65, 303104
    v_mfma_f32_16x16x32_bf16 v[232:235], a[0:3], a[72:75], v[232:235]
    buffer_load_dwordx4 v70, s[28:31], s71 offen lds
    s_waitcnt lgkmcnt(8)
    v_mfma_f32_16x16x32_bf16 v[244:247], a[0:3], a[80:83], v[244:247]
    ds_read_b64_tr_b16 a[64:65], v15 offset:49232
    s_cmp_ge_u32 s64, 128
    s_cselect_b32 s65, 2147418112, s65
L_pg7:
    s_cbranch_execz L_pg4
    v_mfma_f32_16x16x32_bf16 v[244:247], a[4:7], a[84:87], v[244:247]
    ds_read_b64_tr_b16 a[66:67], v15 offset:49872
    s_cmp_eq_u32 s60, 0
    s_cselect_b32 s65, 2147418112, s65
    v_mfma_f32_16x16x32_bf16 v[248:251], a[12:15], a[84:87], v[248:251]
    ds_read_b64_tr_b16 a[68:69], v15 offset:54864
    s_and_b32 s64, s64, 3
    v_mfma_f32_16x16x32_bf16 v[248:251], a[8:11], a[80:83], v[248:251]
    ds_read_b64_tr_b16 a[70:71], v15 offset:55504
    s_lshl_b32 s64, s64, 6
    v_mfma_f32_16x16x32_bf16 v[252:255], a[16:19], a[80:83], v[252:255]
    buffer_load_dwordx4 v71, s[28:31], s71 offen offset:1024 lds
    v_mfma_f32_16x16x32_bf16 v[252:255], a[20:23], a[84:87], v[252:255]
    ds_read_b64_tr_b16 a[72:73], v15 offset:49272
    s_waitcnt lgkmcnt(9)
    v_mfma_f32_16x16x32_bf16 v[144:147], a[52:55], a[20:23], v[144:147]
    ds_read_b64_tr_b16 a[74:75], v15 offset:49912
    v_add_u32 v60, s64, v1
    v_mfma_f32_16x16x32_bf16 v[144:147], a[48:51], a[16:19], v[144:147]
    ds_read_b64_tr_b16 a[76:77], v15 offset:54904
    v_lshl_add_u32 v54, v60, 4, s65
    v_mfma_f32_16x16x32_bf16 v[140:143], a[48:51], a[8:11], v[140:143]
    ds_read_b64_tr_b16 a[78:79], v15 offset:55544
    v_and_b32 v60, 31, v1
    v_mfma_f32_16x16x32_bf16 v[140:143], a[52:55], a[12:15], v[140:143]
    ds_read_b64_tr_b16 a[80:81], v16 offset:49152
    v_lshrrev_b32 v61, 5, v1
    v_mfma_f32_16x16x32_bf16 v[136:139], a[52:55], a[4:7], v[136:139]
    buffer_load_dwordx4 v72, s[28:31], s71 offen offset:2048 lds
    v_mfma_f32_16x16x32_bf16 v[136:139], a[48:51], a[0:3], v[136:139]
    ds_read_b64_tr_b16 a[82:83], v16 offset:49792
    s_waitcnt lgkmcnt(10)
    v_mfma_f32_16x16x32_bf16 v[148:151], a[56:59], a[0:3], v[148:151]
    ds_read_b64_tr_b16 a[84:85], v16 offset:54784
    v_lshl_add_u32 v60, v60, 1, v61
    v_mfma_f32_16x16x32_bf16 v[148:151], a[60:63], a[4:7], v[148:151]
    s_add_u32 m0, s68, 61440
    ds_read_b64_tr_b16 a[86:87], v16 offset:55424
    v_add_u32 v60, s64, v60
    v_mfma_f32_16x16x32_bf16 v[152:155], a[60:63], a[12:15], v[152:155]
    s_mov_b32 s71, 1475840
    ds_read_b64_tr_b16 a[48:49], v13 offset:0
    v_lshl_add_u32 v57, v60, 3, s65
    v_mfma_f32_16x16x32_bf16 v[152:155], a[56:59], a[8:11], v[152:155]
    buffer_load_dwordx4 v70, s[28:31], s71 offen lds
    v_mfma_f32_16x16x32_bf16 v[156:159], a[56:59], a[16:19], v[156:159]
    ds_read_b64_tr_b16 a[50:51], v13 offset:640
    s_add_u32 s64, s63, 0
    v_mfma_f32_16x16x32_bf16 v[156:159], a[60:63], a[20:23], v[156:159]
    ds_read_b64_tr_b16 a[52:53], v13 offset:5632
    s_waitcnt lgkmcnt(11)
    v_mfma_f32_16x16x32_bf16 v[168:171], a[68:71], a[20:23], v[168:171]
    ds_read_b64_tr_b16 a[54:55], v13 offset:6272
    s_lshr_b32 s65, s64, 2
    v_mfma_f32_16x16x32_bf16 v[168:171], a[64:67], a[16:19], v[168:171]
    ds_read_b64_tr_b16 a[56:57], v13 offset:40
    s_mul_i32 s65, s65, 303104
    v_mfma_f32_16x16x32_bf16 v[164:167], a[64:67], a[8:11], v[164:167]
    ds_read_b64_tr_b16 a[58:59], v13 offset:680
    s_cmp_ge_u32 s64, 128
    s_cselect_b32 s65, 2147418112, s65
    v_mfma_f32_16x16x32_bf16 v[164:167], a[68:71], a[12:15], v[164:167]
    ds_read_b64_tr_b16 a[60:61], v13 offset:5672
    s_and_b32 s64, s64, 3
    v_mfma_f32_16x16x32_bf16 v[160:163], a[68:71], a[4:7], v[160:163]
    buffer_load_dwordx4 v71, s[28:31], s71 offen offset:1024 lds
    v_mfma_f32_16x16x32_bf16 v[160:163], a[64:67], a[0:3], v[160:163]
    ds_read_b64_tr_b16 a[62:63], v13 offset:6312
    s_waitcnt lgkmcnt(12)
    v_mfma_f32_16x16x32_bf16 v[172:175], a[72:75], a[0:3], v[172:175]
    ds_read_b64_tr_b16 a[64:65], v13 offset:80
    s_lshl_b32 s64, s64, 6
    v_mfma_f32_16x16x32_bf16 v[172:175], a[76:79], a[4:7], v[172:175]
    ds_read_b64_tr_b16 a[66:67], v13 offset:720
    v_add_u32 v60, s64, v1
    v_mfma_f32_16x16x32_bf16 v[176:179], a[76:79], a[12:15], v[176:179]
    ds_read_b64_tr_b16 a[68:69], v13 offset:5712
    v_lshl_add_u32 v55, v60, 4, s65
    v_mfma_f32_16x16x32_bf16 v[176:179], a[72:75], a[8:11], v[176:179]
    buffer_load_dwordx4 v72, s[28:31], s71 offen offset:2048 lds
    v_mfma_f32_16x16x32_bf16 v[180:183], a[72:75], a[16:19], v[180:183]
    ds_read_b64_tr_b16 a[70:71], v13 offset:6352
    v_and_b32 v60, 31, v1
    v_mfma_f32_16x16x32_bf16 v[180:183], a[76:79], a[20:23], v[180:183]
    v_lshrrev_b32 v61, 5, v1
    s_waitcnt lgkmcnt(12)
    v_mfma_f32_16x16x32_bf16 v[192:195], a[84:87], a[20:23], v[192:195]
    ds_read_b64_tr_b16 a[72:73], v13 offset:120
    v_lshl_add_u32 v60, v60, 1, v61
    v_mfma_f32_16x16x32_bf16 v[192:195], a[80:83], a[16:19], v[192:195]
    s_add_u32 m0, s68, 73728
    ds_read_b64_tr_b16 a[74:75], v13 offset:760
    v_add_u32 v60, s64, v60
    v_mfma_f32_16x16x32_bf16 v[188:191], a[80:83], a[8:11], v[188:191]
    s_mov_b32 s71, 1474560
    ds_read_b64_tr_b16 a[76:77], v13 offset:5752
    v_lshl_add_u32 v58, v60, 3, s65
    v_mfma_f32_16x16x32_bf16 v[188:191], a[84:87], a[12:15], v[188:191]
    buffer_load_dwordx4 v70, s[28:31], s71 offen lds
    v_mfma_f32_16x16x32_bf16 v[184:187], a[84:87], a[4:7], v[184:187]
    ds_read_b64_tr_b16 a[78:79], v13 offset:6392
    s_add_u32 s64, s63, 1
    v_mfma_f32_16x16x32_bf16 v[184:187], a[80:83], a[0:3], v[184:187]
    s_lshr_b32 s65, s64, 2
    s_waitcnt lgkmcnt(12)
    v_mfma_f32_16x16x32_bf16 v[76:79], a[48:51], a[0:3], v[76:79]
    ds_read_b64_tr_b16 a[80:81], v14 offset:0
    s_mul_i32 s65, s65, 303104
    v_mfma_f32_16x16x32_bf16 v[76:79], a[52:55], a[4:7], v[76:79]
    ds_read_b64_tr_b16 a[82:83], v14 offset:640
    s_cmp_ge_u32 s64, 128
    s_cselect_b32 s65, 2147418112, s65
    v_mfma_f32_16x16x32_bf16 v[80:83], a[52:55], a[12:15], v[80:83]
    buffer_load_dwordx4 v71, s[28:31], s71 offen offset:1024 lds
    v_mfma_f32_16x16x32_bf16 v[80:83], a[48:51], a[8:11], v[80:83]
    ds_read_b64_tr_b16 a[84:85], v14 offset:5632
    s_and_b32 s64, s64, 3
    v_mfma_f32_16x16x32_bf16 v[84:87], a[48:51], a[16:19], v[84:87]
    ds_read_b64_tr_b16 a[86:87], v14 offset:6272
    s_lshl_b32 s64, s64, 6
    v_mfma_f32_16x16x32_bf16 v[84:87], a[52:55], a[20:23], v[84:87]
    v_add_u32 v60, s64, v1
    s_waitcnt lgkmcnt(12)
    v_mfma_f32_16x16x32_bf16 v[96:99], a[60:63], a[20:23], v[96:99]
    v_lshl_add_u32 v56, v60, 4, s65
    v_and_b32 v60, 31, v1
    v_mfma_f32_16x16x32_bf16 v[96:99], a[56:59], a[16:19], v[96:99]
    v_lshrrev_b32 v61, 5, v1
    v_lshl_add_u32 v60, v60, 1, v61
    v_mfma_f32_16x16x32_bf16 v[92:95], a[56:59], a[8:11], v[92:95]
    buffer_load_dwordx4 v72, s[28:31], s71 offen offset:2048 lds
    v_mfma_f32_16x16x32_bf16 v[92:95], a[60:63], a[12:15], v[92:95]
    v_add_u32 v60, s64, v60
    v_lshl_add_u32 v59, v60, 3, s65
    v_mfma_f32_16x16x32_bf16 v[88:91], a[60:63], a[4:7], v[88:91]
    v_mfma_f32_16x16x32_bf16 v[88:91], a[56:59], a[0:3], v[88:91]
    s_add_u32 m0, s67, 0
    s_waitcnt vmcnt(9) lgkmcnt(0)
    s_barrier
    v_mfma_f32_16x16x32_bf16 v[100:103], a[64:67], a[0:3], v[100:103]
    s_mov_b32 s70, 768
    ds_read_b64_tr_b16 a[48:49], v13 offset:12288
    v_mfma_f32_16x16x32_bf16 v[100:103], a[68:71], a[4:7], v[100:103]
    s_mov_b64 exec, s[72:73]
    buffer_load_dwordx4 v5, s[24:27], s70 offen lds
    s_mov_b64 exec, -1
    v_mfma_f32_16x16x32_bf16 v[104:107], a[68:71], a[12:15], v[104:107]
    ds_read_b64_tr_b16 a[50:51], v13 offset:12928
    v_mfma_f32_16x16x32_bf16 v[104:107], a[64:67], a[8:11], v[104:107]
    ds_read_b64_tr_b16 a[52:53], v13 offset:17920
    v_mfma_f32_16x16x32_bf16 v[108:111], a[64:67], a[16:19], v[108:111]
    ds_read_b64_tr_b16 a[54:55], v13 offset:18560
    v_mfma_f32_16x16x32_bf16 v[108:111], a[68:71], a[20:23], v[108:111]
    ds_read_b128 a[40:43], v11 offset:28672
    v_mfma_f32_16x16x32_bf16 v[120:123], a[76:79], a[20:23], v[120:123]
    s_add_u32 m0, s67, 4096
    ds_read_b128 a[44:47], v12 offset:28672
    v_mfma_f32_16x16x32_bf16 v[120:123], a[72:75], a[16:19], v[120:123]
    buffer_load_dwordx4 v6, s[24:27], s70 offen lds
    v_mfma_f32_16x16x32_bf16 v[116:119], a[72:75], a[8:11], v[116:119]
    ds_read_b128 a[32:35], v11 offset:26624
    v_mfma_f32_16x16x32_bf16 v[116:119], a[76:79], a[12:15], v[116:119]
    ds_read_b128 a[36:39], v12 offset:26624
    v_mfma_f32_16x16x32_bf16 v[112:115], a[76:79], a[4:7], v[112:115]
    ds_read_b128 a[24:27], v11 offset:24576
    v_mfma_f32_16x16x32_bf16 v[112:115], a[72:75], a[0:3], v[112:115]
    s_add_u32 m0, s67, 8192
    ds_read_b128 a[28:31], v12 offset:24576
    v_mfma_f32_16x16x32_bf16 v[124:127], a[80:83], a[0:3], v[124:127]
    buffer_load_dwordx4 v7, s[24:27], s70 offen lds
    v_mfma_f32_16x16x32_bf16 v[124:127], a[84:87], a[4:7], v[124:127]
    ds_read_b64_tr_b16 a[56:57], v13 offset:12328
    v_mfma_f32_16x16x32_bf16 v[128:131], a[84:87], a[12:15], v[128:131]
    ds_read_b64_tr_b16 a[58:59], v13 offset:12968
    v_mfma_f32_16x16x32_bf16 v[128:131], a[80:83], a[8:11], v[128:131]
    ds_read_b64_tr_b16 a[60:61], v13 offset:17960
    v_mfma_f32_16x16x32_bf16 v[132:135], a[80:83], a[16:19], v[132:135]
    ds_read_b64_tr_b16 a[62:63], v13 offset:18600
    v_mfma_f32_16x16x32_bf16 v[132:135], a[84:87], a[20:23], v[132:135]
    ds_read_b64_tr_b16 a[64:65], v13 offset:12368
    s_waitcnt lgkmcnt(9)
    v_mfma_f32_16x16x32_bf16 v[204:207], a[44:47], a[52:55], v[204:207]
    s_add_u32 m0, s67, 12288
    ds_read_b64_tr_b16 a[66:67], v13 offset:13008
    v_mfma_f32_16x16x32_bf16 v[204:207], a[40:43], a[48:51], v[204:207]
    buffer_load_dwordx4 v8, s[24:27], s70 offen lds
    s_waitcnt lgkmcnt(8)
    v_mfma_f32_16x16x32_bf16 v[200:203], a[32:35], a[48:51], v[200:203]
    ds_read_b64_tr_b16 a[68:69], v13 offset:18000
    v_mfma_f32_16x16x32_bf16 v[200:203], a[36:39], a[52:55], v[200:203]
    ds_read_b64_tr_b16 a[70:71], v13 offset:18640
    s_waitcnt lgkmcnt(8)
    v_mfma_f32_16x16x32_bf16 v[196:199], a[28:31], a[52:55], v[196:199]
    ds_read_b64_tr_b16 a[72:73], v13 offset:12408
    v_mfma_f32_16x16x32_bf16 v[196:199], a[24:27], a[48:51], v[196:199]
    s_add_u32 m0, s67, 16384
    ds_read_b64_tr_b16 a[74:75], v13 offset:13048
    s_waitcnt lgkmcnt(6)
    v_mfma_f32_16x16x32_bf16 v[208:211], a[24:27], a[56:59], v[208:211]
    buffer_load_dwordx4 v9, s[24:27], s70 offen lds
    v_mfma_f32_16x16x32_bf16 v[208:211], a[28:31], a[60:63], v[208:211]
    ds_read_b64_tr_b16 a[76:77], v13 offset:18040
    v_mfma_f32_16x16x32_bf16 v[212:215], a[36:39], a[60:63], v[212:215]
    ds_read_b64_tr_b16 a[78:79], v13 offset:18680
    v_mfma_f32_16x16x32_bf16 v[212:215], a[32:35], a[56:59], v[212:215]
    ds_read_b64_tr_b16 a[80:81], v14 offset:12288
    v_mfma_f32_16x16x32_bf16 v[216:219], a[40:43], a[56:59], v[216:219]
    ds_read_b64_tr_b16 a[82:83], v14 offset:12928
    v_mfma_f32_16x16x32_bf16 v[216:219], a[44:47], a[60:63], v[216:219]
    s_add_u32 m0, s67, 20480
    ds_read_b64_tr_b16 a[84:85], v14 offset:17920
    s_waitcnt lgkmcnt(7)
    v_mfma_f32_16x16x32_bf16 v[228:231], a[44:47], a[68:71], v[228:231]
    buffer_load_dwordx4 v10, s[24:27], s70 offen lds
    v_mfma_f32_16x16x32_bf16 v[228:231], a[40:43], a[64:67], v[228:231]
    ds_read_b64_tr_b16 a[86:87], v14 offset:18560
    v_mfma_f32_16x16x32_bf16 v[224:227], a[32:35], a[64:67], v[224:227]
    ds_read_b64_tr_b16 a[48:49], v13 offset:24576
    v_mfma_f32_16x16x32_bf16 v[224:227], a[36:39], a[68:71], v[224:227]
    s_add_u32 m0, s68, 86016
    ds_read_b64_tr_b16 a[50:51], v13 offset:25216
    v_mfma_f32_16x16x32_bf16 v[220:223], a[28:31], a[68:71], v[220:223]
    s_mov_b32 s71, 1722880
    ds_read_b64_tr_b16 a[52:53], v13 offset:30208
    v_mfma_f32_16x16x32_bf16 v[220:223], a[24:27], a[64:67], v[220:223]
    buffer_load_dwordx4 v70, s[28:31], s71 offen lds
    s_waitcnt lgkmcnt(7)
    v_mfma_f32_16x16x32_bf16 v[232:235], a[24:27], a[72:75], v[232:235]
    ds_read_b64_tr_b16 a[54:55], v13 offset:30848
    v_mfma_f32_16x16x32_bf16 v[232:235], a[28:31], a[76:79], v[232:235]
    ds_read_b64_tr_b16 a[56:57], v13 offset:24616
    v_mfma_f32_16x16x32_bf16 v[236:239], a[36:39], a[76:79], v[236:239]
    ds_read_b64_tr_b16 a[58:59], v13 offset:25256
    v_mfma_f32_16x16x32_bf16 v[236:239], a[32:35], a[72:75], v[236:239]
    ds_read_b64_tr_b16 a[60:61], v13 offset:30248
    v_mfma_f32_16x16x32_bf16 v[240:243], a[40:43], a[72:75], v[240:243]
    ds_read_b64_tr_b16 a[62:63], v13 offset:30888
    v_mfma_f32_16x16x32_bf16 v[240:243], a[44:47], a[76:79], v[240:243]
    buffer_load_dwordx4 v71, s[28:31], s71 offen offset:1024 lds
    s_waitcnt lgkmcnt(8)
    v_mfma_f32_16x16x32_bf16 v[252:255], a[44:47], a[84:87], v[252:255]
    ds_read_b64_tr_b16 a[64:65], v13 offset:24656
    v_mfma_f32_16x16x32_bf16 v[252:255], a[40:43], a[80:83], v[252:255]
    ds_read_b64_tr_b16 a[66:67], v13 offset:25296
    v_mfma_f32_16x16x32_bf16 v[248:251], a[32:35], a[80:83], v[248:251]
    ds_read_b64_tr_b16 a[68:69], v13 offset:30288
    v_mfma_f32_16x16x32_bf16 v[248:251], a[36:39], a[84:87], v[248:251]
    ds_read_b64_tr_b16 a[70:71], v13 offset:30928
    v_mfma_f32_16x16x32_bf16 v[244:247], a[28:31], a[84:87], v[244:247]
    buffer_load_dwordx4 v72, s[28:31], s71 offen offset:2048 lds
    v_mfma_f32_16x16x32_bf16 v[244:247], a[24:27], a[80:83], v[244:247]
    ds_read_b64_tr_b16 a[72:73], v13 offset:24696
    s_waitcnt lgkmcnt(9)
    v_mfma_f32_16x16x32_bf16 v[136:139], a[48:51], a[24:27], v[136:139]
    ds_read_b64_tr_b16 a[74:75], v13 offset:25336
    v_mfma_f32_16x16x32_bf16 v[136:139], a[52:55], a[28:31], v[136:139]
    ds_read_b64_tr_b16 a[76:77], v13 offset:30328
    v_mfma_f32_16x16x32_bf16 v[140:143], a[52:55], a[36:39], v[140:143]
    s_add_u32 m0, s68, 98304
    ds_read_b64_tr_b16 a[78:79], v13 offset:30968
    v_mfma_f32_16x16x32_bf16 v[140:143], a[48:51], a[32:35], v[140:143]
    s_mov_b32 s71, 1721600
    ds_read_b64_tr_b16 a[80:81], v14 offset:24576
    v_mfma_f32_16x16x32_bf16 v[144:147], a[48:51], a[40:43], v[144:147]
    buffer_load_dwordx4 v70, s[28:31], s71 offen lds
    v_mfma_f32_16x16x32_bf16 v[144:147], a[52:55], a[44:47], v[144:147]
    ds_read_b64_tr_b16 a[82:83], v14 offset:25216
    s_waitcnt lgkmcnt(10)
    v_mfma_f32_16x16x32_bf16 v[156:159], a[60:63], a[44:47], v[156:159]
    ds_read_b64_tr_b16 a[84:85], v14 offset:30208
    v_mfma_f32_16x16x32_bf16 v[156:159], a[56:59], a[40:43], v[156:159]
    ds_read_b64_tr_b16 a[86:87], v14 offset:30848
    v_mfma_f32_16x16x32_bf16 v[152:155], a[56:59], a[32:35], v[152:155]
    ds_read_b64_tr_b16 a[48:49], v13 offset:36864
    v_mfma_f32_16x16x32_bf16 v[152:155], a[60:63], a[36:39], v[152:155]
    buffer_load_dwordx4 v71, s[28:31], s71 offen offset:1024 lds
    v_mfma_f32_16x16x32_bf16 v[148:151], a[60:63], a[28:31], v[148:151]
    ds_read_b64_tr_b16 a[50:51], v13 offset:37504
    v_mfma_f32_16x16x32_bf16 v[148:151], a[56:59], a[24:27], v[148:151]
    ds_read_b64_tr_b16 a[52:53], v13 offset:42496
    s_waitcnt lgkmcnt(11)
    v_mfma_f32_16x16x32_bf16 v[160:163], a[64:67], a[24:27], v[160:163]
    ds_read_b64_tr_b16 a[54:55], v13 offset:43136
    v_mfma_f32_16x16x32_bf16 v[160:163], a[68:71], a[28:31], v[160:163]
    ds_read_b64_tr_b16 a[56:57], v13 offset:36904
    v_mfma_f32_16x16x32_bf16 v[164:167], a[68:71], a[36:39], v[164:167]
    ds_read_b64_tr_b16 a[58:59], v13 offset:37544
    v_mfma_f32_16x16x32_bf16 v[164:167], a[64:67], a[32:35], v[164:167]
    ds_read_b64_tr_b16 a[60:61], v13 offset:42536
    v_mfma_f32_16x16x32_bf16 v[168:171], a[64:67], a[40:43], v[168:171]
    buffer_load_dwordx4 v72, s[28:31], s71 offen offset:2048 lds
    v_mfma_f32_16x16x32_bf16 v[168:171], a[68:71], a[44:47], v[168:171]
    ds_read_b64_tr_b16 a[62:63], v13 offset:43176
    s_waitcnt lgkmcnt(12)
    v_mfma_f32_16x16x32_bf16 v[180:183], a[76:79], a[44:47], v[180:183]
    ds_read_b64_tr_b16 a[64:65], v13 offset:36944
    v_mfma_f32_16x16x32_bf16 v[180:183], a[72:75], a[40:43], v[180:183]
    s_add_u32 m0, s68, 110592
    ds_read_b64_tr_b16 a[66:67], v13 offset:37584
    v_mfma_f32_16x16x32_bf16 v[176:179], a[72:75], a[32:35], v[176:179]
    s_mov_b32 s71, 1720320
    ds_read_b64_tr_b16 a[68:69], v13 offset:42576
    v_mfma_f32_16x16x32_bf16 v[176:179], a[76:79], a[36:39], v[176:179]
    buffer_load_dwordx4 v70, s[28:31], s71 offen lds
    v_mfma_f32_16x16x32_bf16 v[172:175], a[76:79], a[28:31], v[172:175]
    ds_read_b64_tr_b16 a[70:71], v13 offset:43216
    v_mfma_f32_16x16x32_bf16 v[172:175], a[72:75], a[24:27], v[172:175]
    s_waitcnt lgkmcnt(12)
    v_mfma_f32_16x16x32_bf16 v[184:187], a[80:83], a[24:27], v[184:187]
    ds_read_b64_tr_b16 a[72:73], v13 offset:36984
    v_mfma_f32_16x16x32_bf16 v[184:187], a[84:87], a[28:31], v[184:187]
    ds_read_b64_tr_b16 a[74:75], v13 offset:37624
    v_mfma_f32_16x16x32_bf16 v[188:191], a[84:87], a[36:39], v[188:191]
    ds_read_b64_tr_b16 a[76:77], v13 offset:42616
    v_mfma_f32_16x16x32_bf16 v[188:191], a[80:83], a[32:35], v[188:191]
    buffer_load_dwordx4 v71, s[28:31], s71 offen offset:1024 lds
    v_mfma_f32_16x16x32_bf16 v[192:195], a[80:83], a[40:43], v[192:195]
    ds_read_b64_tr_b16 a[78:79], v13 offset:43256
    v_mfma_f32_16x16x32_bf16 v[192:195], a[84:87], a[44:47], v[192:195]
    s_waitcnt lgkmcnt(12)
    v_mfma_f32_16x16x32_bf16 v[84:87], a[52:55], a[44:47], v[84:87]
    ds_read_b64_tr_b16 a[80:81], v14 offset:36864
    v_mfma_f32_16x16x32_bf16 v[84:87], a[48:51], a[40:43], v[84:87]
    ds_read_b64_tr_b16 a[82:83], v14 offset:37504
    v_mfma_f32_16x16x32_bf16 v[80:83], a[48:51], a[32:35], v[80:83]
    buffer_load_dwordx4 v72, s[28:31], s71 offen offset:2048 lds
    v_mfma_f32_16x16x32_bf16 v[80:83], a[52:55], a[36:39], v[80:83]
    ds_read_b64_tr_b16 a[84:85], v14 offset:42496
    v_mfma_f32_16x16x32_bf16 v[76:79], a[52:55], a[28:31], v[76:79]
    ds_read_b64_tr_b16 a[86:87], v14 offset:43136
    v_mfma_f32_16x16x32_bf16 v[76:79], a[48:51], a[24:27], v[76:79]
    s_waitcnt lgkmcnt(12)
    v_mfma_f32_16x16x32_bf16 v[88:91], a[56:59], a[24:27], v[88:91]
    v_mfma_f32_16x16x32_bf16 v[88:91], a[60:63], a[28:31], v[88:91]
    v_mfma_f32_16x16x32_bf16 v[92:95], a[60:63], a[36:39], v[92:95]
    v_mfma_f32_16x16x32_bf16 v[92:95], a[56:59], a[32:35], v[92:95]
    v_mfma_f32_16x16x32_bf16 v[96:99], a[56:59], a[40:43], v[96:99]
    v_mfma_f32_16x16x32_bf16 v[96:99], a[60:63], a[44:47], v[96:99]
    s_add_u32 m0, s67, 24576
    s_waitcnt vmcnt(9) lgkmcnt(0)
    s_barrier
    v_mfma_f32_16x16x32_bf16 v[108:111], a[68:71], a[44:47], v[108:111]
    s_mov_b32 s70, 896
    ds_read_b64_tr_b16 a[48:49], v15 offset:0
    v_mfma_f32_16x16x32_bf16 v[108:111], a[64:67], a[40:43], v[108:111]
    s_mov_b64 exec, s[72:73]
    buffer_load_dwordx4 v5, s[24:27], s70 offen lds
    s_mov_b64 exec, -1
    v_mfma_f32_16x16x32_bf16 v[104:107], a[64:67], a[32:35], v[104:107]
    ds_read_b64_tr_b16 a[50:51], v15 offset:640
    v_mfma_f32_16x16x32_bf16 v[104:107], a[68:71], a[36:39], v[104:107]
    ds_read_b64_tr_b16 a[52:53], v15 offset:5632
    v_mfma_f32_16x16x32_bf16 v[100:103], a[68:71], a[28:31], v[100:103]
    ds_read_b64_tr_b16 a[54:55], v15 offset:6272
    v_mfma_f32_16x16x32_bf16 v[100:103], a[64:67], a[24:27], v[100:103]
    ds_read_b128 a[0:3], v11 offset:0
    v_mfma_f32_16x16x32_bf16 v[112:115], a[72:75], a[24:27], v[112:115]
    s_add_u32 m0, s67, 28672
    ds_read_b128 a[4:7], v12 offset:0
    v_mfma_f32_16x16x32_bf16 v[112:115], a[76:79], a[28:31], v[112:115]
    buffer_load_dwordx4 v6, s[24:27], s70 offen lds
    v_mfma_f32_16x16x32_bf16 v[116:119], a[76:79], a[36:39], v[116:119]
    ds_read_b128 a[8:11], v11 offset:2048
    v_mfma_f32_16x16x32_bf16 v[116:119], a[72:75], a[32:35], v[116:119]
    ds_read_b128 a[12:15], v12 offset:2048
    v_mfma_f32_16x16x32_bf16 v[120:123], a[72:75], a[40:43], v[120:123]
    ds_read_b128 a[16:19], v11 offset:4096
    v_mfma_f32_16x16x32_bf16 v[120:123], a[76:79], a[44:47], v[120:123]
    s_add_u32 m0, s67, 32768
    ds_read_b128 a[20:23], v12 offset:4096
    v_mfma_f32_16x16x32_bf16 v[132:135], a[84:87], a[44:47], v[132:135]
    buffer_load_dwordx4 v7, s[24:27], s70 offen lds
    v_mfma_f32_16x16x32_bf16 v[132:135], a[80:83], a[40:43], v[132:135]
    ds_read_b64_tr_b16 a[56:57], v15 offset:40
    v_mfma_f32_16x16x32_bf16 v[128:131], a[80:83], a[32:35], v[128:131]
    ds_read_b64_tr_b16 a[58:59], v15 offset:680
    v_mfma_f32_16x16x32_bf16 v[128:131], a[84:87], a[36:39], v[128:131]
    ds_read_b64_tr_b16 a[60:61], v15 offset:5672
    v_mfma_f32_16x16x32_bf16 v[124:127], a[84:87], a[28:31], v[124:127]
    ds_read_b64_tr_b16 a[62:63], v15 offset:6312
    v_mfma_f32_16x16x32_bf16 v[124:127], a[80:83], a[24:27], v[124:127]
    ds_read_b64_tr_b16 a[64:65], v15 offset:80
    s_waitcnt lgkmcnt(9)
    v_mfma_f32_16x16x32_bf16 v[196:199], a[0:3], a[48:51], v[196:199]
    s_add_u32 m0, s67, 36864
    ds_read_b64_tr_b16 a[66:67], v15 offset:720
    v_mfma_f32_16x16x32_bf16 v[196:199], a[4:7], a[52:55], v[196:199]
    buffer_load_dwordx4 v8, s[24:27], s70 offen lds
    s_waitcnt lgkmcnt(8)
    v_mfma_f32_16x16x32_bf16 v[200:203], a[12:15], a[52:55], v[200:203]
    ds_read_b64_tr_b16 a[68:69], v15 offset:5712
    v_mfma_f32_16x16x32_bf16 v[200:203], a[8:11], a[48:51], v[200:203]
    ds_read_b64_tr_b16 a[70:71], v15 offset:6352
    s_waitcnt lgkmcnt(8)
    v_mfma_f32_16x16x32_bf16 v[204:207], a[16:19], a[48:51], v[204:207]
    ds_read_b64_tr_b16 a[72:73], v15 offset:120
    v_mfma_f32_16x16x32_bf16 v[204:207], a[20:23], a[52:55], v[204:207]
    s_add_u32 m0, s67, 40960
    ds_read_b64_tr_b16 a[74:75], v15 offset:760
    s_waitcnt lgkmcnt(6)
    v_mfma_f32_16x16x32_bf16 v[216:219], a[20:23], a[60:63], v[216:219]
    buffer_load_dwordx4 v9, s[24:27], s70 offen lds
    v_mfma_f32_16x16x32_bf16 v[216:219], a[16:19], a[56:59], v[216:219]
    ds_read_b64_tr_b16 a[76:77], v15 offset:5752
    v_mfma_f32_16x16x32_bf16 v[212:215], a[8:11], a[56:59], v[212:215]
    ds_read_b64_tr_b16 a[78:79], v15 offset:6392
    v_mfma_f32_16x16x32_bf16 v[212:215], a[12:15], a[60:63], v[212:215]
    ds_read_b64_tr_b16 a[80:81], v16 offset:0
    v_mfma_f32_16x16x32_bf16 v[208:211], a[4:7], a[60:63], v[208:211]
    ds_read_b64_tr_b16 a[82:83], v16 offset:640
    v_mfma_f32_16x16x32_bf16 v[208:211], a[0:3], a[56:59], v[208:211]
    s_add_u32 m0, s67, 45056
    ds_read_b64_tr_b16 a[84:85], v16 offset:5632
    s_waitcnt lgkmcnt(7)
    v_mfma_f32_16x16x32_bf16 v[220:223], a[0:3], a[64:67], v[220:223]
    buffer_load_dwordx4 v10, s[24:27], s70 offen lds
    v_mfma_f32_16x16x32_bf16 v[220:223], a[4:7], a[68:71], v[220:223]
    ds_read_b64_tr_b16 a[86:87], v16 offset:6272
    v_mfma_f32_16x16x32_bf16 v[224:227], a[12:15], a[68:71], v[224:227]
    ds_read_b64_tr_b16 a[48:49], v15 offset:12288
    v_mfma_f32_16x16x32_bf16 v[224:227], a[8:11], a[64:67], v[224:227]
    s_add_u32 m0, s68, 122880
    ds_read_b64_tr_b16 a[50:51], v15 offset:12928
    v_mfma_f32_16x16x32_bf16 v[228:231], a[16:19], a[64:67], v[228:231]
    s_mov_b32 s71, 1968640
    ds_read_b64_tr_b16 a[52:53], v15 offset:17920
    v_mfma_f32_16x16x32_bf16 v[228:231], a[20:23], a[68:71], v[228:231]
    buffer_load_dwordx4 v70, s[28:31], s71 offen lds
    s_waitcnt lgkmcnt(7)
    v_mfma_f32_16x16x32_bf16 v[240:243], a[20:23], a[76:79], v[240:243]
    ds_read_b64_tr_b16 a[54:55], v15 offset:18560
    v_mfma_f32_16x16x32_bf16 v[240:243], a[16:19], a[72:75], v[240:243]
    ds_read_b64_tr_b16 a[56:57], v15 offset:12328
    v_mfma_f32_16x16x32_bf16 v[236:239], a[8:11], a[72:75], v[236:239]
    ds_read_b64_tr_b16 a[58:59], v15 offset:12968
    v_mfma_f32_16x16x32_bf16 v[236:239], a[12:15], a[76:79], v[236:239]
    ds_read_b64_tr_b16 a[60:61], v15 offset:17960
    v_mfma_f32_16x16x32_bf16 v[232:235], a[4:7], a[76:79], v[232:235]
    ds_read_b64_tr_b16 a[62:63], v15 offset:18600
    v_mfma_f32_16x16x32_bf16 v[232:235], a[0:3], a[72:75], v[232:235]
    buffer_load_dwordx4 v71, s[28:31], s71 offen offset:1024 lds
    s_waitcnt lgkmcnt(8)
    v_mfma_f32_16x16x32_bf16 v[244:247], a[0:3], a[80:83], v[244:247]
    ds_read_b64_tr_b16 a[64:65], v15 offset:12368
    v_mfma_f32_16x16x32_bf16 v[244:247], a[4:7], a[84:87], v[244:247]
    ds_read_b64_tr_b16 a[66:67], v15 offset:13008
    v_mfma_f32_16x16x32_bf16 v[248:251], a[12:15], a[84:87], v[248:251]
    ds_read_b64_tr_b16 a[68:69], v15 offset:18000
    v_mfma_f32_16x16x32_bf16 v[248:251], a[8:11], a[80:83], v[248:251]
    ds_read_b64_tr_b16 a[70:71], v15 offset:18640
    v_mfma_f32_16x16x32_bf16 v[252:255], a[16:19], a[80:83], v[252:255]
    buffer_load_dwordx4 v72, s[28:31], s71 offen offset:2048 lds
    v_mfma_f32_16x16x32_bf16 v[252:255], a[20:23], a[84:87], v[252:255]
    ds_read_b64_tr_b16 a[72:73], v15 offset:12408
    s_waitcnt lgkmcnt(9)
    v_mfma_f32_16x16x32_bf16 v[144:147], a[52:55], a[20:23], v[144:147]
    ds_read_b64_tr_b16 a[74:75], v15 offset:13048
    v_mfma_f32_16x16x32_bf16 v[144:147], a[48:51], a[16:19], v[144:147]
    ds_read_b64_tr_b16 a[76:77], v15 offset:18040
    v_mfma_f32_16x16x32_bf16 v[140:143], a[48:51], a[8:11], v[140:143]
    s_add_u32 m0, s68, 135168
    ds_read_b64_tr_b16 a[78:79], v15 offset:18680
    v_mfma_f32_16x16x32_bf16 v[140:143], a[52:55], a[12:15], v[140:143]
    s_mov_b32 s71, 1967360
    ds_read_b64_tr_b16 a[80:81], v16 offset:12288
    v_mfma_f32_16x16x32_bf16 v[136:139], a[52:55], a[4:7], v[136:139]
    buffer_load_dwordx4 v70, s[28:31], s71 offen lds
    v_mfma_f32_16x16x32_bf16 v[136:139], a[48:51], a[0:3], v[136:139]
    ds_read_b64_tr_b16 a[82:83], v16 offset:12928
    s_waitcnt lgkmcnt(10)
    v_mfma_f32_16x16x32_bf16 v[148:151], a[56:59], a[0:3], v[148:151]
    ds_read_b64_tr_b16 a[84:85], v16 offset:17920
    v_mfma_f32_16x16x32_bf16 v[148:151], a[60:63], a[4:7], v[148:151]
    ds_read_b64_tr_b16 a[86:87], v16 offset:18560
    v_mfma_f32_16x16x32_bf16 v[152:155], a[60:63], a[12:15], v[152:155]
    ds_read_b64_tr_b16 a[48:49], v15 offset:24576
    v_mfma_f32_16x16x32_bf16 v[152:155], a[56:59], a[8:11], v[152:155]
    buffer_load_dwordx4 v71, s[28:31], s71 offen offset:1024 lds
    v_mfma_f32_16x16x32_bf16 v[156:159], a[56:59], a[16:19], v[156:159]
    ds_read_b64_tr_b16 a[50:51], v15 offset:25216
    v_mfma_f32_16x16x32_bf16 v[156:159], a[60:63], a[20:23], v[156:159]
    ds_read_b64_tr_b16 a[52:53], v15 offset:30208
    s_waitcnt lgkmcnt(11)
    v_mfma_f32_16x16x32_bf16 v[168:171], a[68:71], a[20:23], v[168:171]
    ds_read_b64_tr_b16 a[54:55], v15 offset:30848
    v_mfma_f32_16x16x32_bf16 v[168:171], a[64:67], a[16:19], v[168:171]
    ds_read_b64_tr_b16 a[56:57], v15 offset:24616
    v_mfma_f32_16x16x32_bf16 v[164:167], a[64:67], a[8:11], v[164:167]
    ds_read_b64_tr_b16 a[58:59], v15 offset:25256
    v_mfma_f32_16x16x32_bf16 v[164:167], a[68:71], a[12:15], v[164:167]
    ds_read_b64_tr_b16 a[60:61], v15 offset:30248
    v_mfma_f32_16x16x32_bf16 v[160:163], a[68:71], a[4:7], v[160:163]
    buffer_load_dwordx4 v72, s[28:31], s71 offen offset:2048 lds
    v_mfma_f32_16x16x32_bf16 v[160:163], a[64:67], a[0:3], v[160:163]
    ds_read_b64_tr_b16 a[62:63], v15 offset:30888
    s_waitcnt lgkmcnt(12)
    v_mfma_f32_16x16x32_bf16 v[172:175], a[72:75], a[0:3], v[172:175]
    ds_read_b64_tr_b16 a[64:65], v15 offset:24656
    v_mfma_f32_16x16x32_bf16 v[172:175], a[76:79], a[4:7], v[172:175]
    s_add_u32 m0, s68, 147456
    ds_read_b64_tr_b16 a[66:67], v15 offset:25296
    v_mfma_f32_16x16x32_bf16 v[176:179], a[76:79], a[12:15], v[176:179]
    s_mov_b32 s71, 1966080
    ds_read_b64_tr_b16 a[68:69], v15 offset:30288
    v_mfma_f32_16x16x32_bf16 v[176:179], a[72:75], a[8:11], v[176:179]
    buffer_load_dwordx4 v70, s[28:31], s71 offen lds
    v_mfma_f32_16x16x32_bf16 v[180:183], a[72:75], a[16:19], v[180:183]
    ds_read_b64_tr_b16 a[70:71], v15 offset:30928
    v_mfma_f32_16x16x32_bf16 v[180:183], a[76:79], a[20:23], v[180:183]
    s_waitcnt lgkmcnt(12)
    v_mfma_f32_16x16x32_bf16 v[192:195], a[84:87], a[20:23], v[192:195]
    ds_read_b64_tr_b16 a[72:73], v15 offset:24696
    v_mfma_f32_16x16x32_bf16 v[192:195], a[80:83], a[16:19], v[192:195]
    ds_read_b64_tr_b16 a[74:75], v15 offset:25336
    v_mfma_f32_16x16x32_bf16 v[188:191], a[80:83], a[8:11], v[188:191]
    ds_read_b64_tr_b16 a[76:77], v15 offset:30328
    v_mfma_f32_16x16x32_bf16 v[188:191], a[84:87], a[12:15], v[188:191]
    buffer_load_dwordx4 v71, s[28:31], s71 offen offset:1024 lds
    v_mfma_f32_16x16x32_bf16 v[184:187], a[84:87], a[4:7], v[184:187]
    ds_read_b64_tr_b16 a[78:79], v15 offset:30968
    v_mfma_f32_16x16x32_bf16 v[184:187], a[80:83], a[0:3], v[184:187]
    s_waitcnt lgkmcnt(12)
    v_mfma_f32_16x16x32_bf16 v[76:79], a[48:51], a[0:3], v[76:79]
    ds_read_b64_tr_b16 a[80:81], v16 offset:24576
    v_mfma_f32_16x16x32_bf16 v[76:79], a[52:55], a[4:7], v[76:79]
    ds_read_b64_tr_b16 a[82:83], v16 offset:25216
    v_mfma_f32_16x16x32_bf16 v[80:83], a[52:55], a[12:15], v[80:83]
    buffer_load_dwordx4 v72, s[28:31], s71 offen offset:2048 lds
    v_mfma_f32_16x16x32_bf16 v[80:83], a[48:51], a[8:11], v[80:83]
    ds_read_b64_tr_b16 a[84:85], v16 offset:30208
    v_mfma_f32_16x16x32_bf16 v[84:87], a[48:51], a[16:19], v[84:87]
    ds_read_b64_tr_b16 a[86:87], v16 offset:30848
    v_mfma_f32_16x16x32_bf16 v[84:87], a[52:55], a[20:23], v[84:87]
    s_waitcnt lgkmcnt(12)
    v_mfma_f32_16x16x32_bf16 v[96:99], a[60:63], a[20:23], v[96:99]
    v_mfma_f32_16x16x32_bf16 v[96:99], a[56:59], a[16:19], v[96:99]
    v_mfma_f32_16x16x32_bf16 v[92:95], a[56:59], a[8:11], v[92:95]
    v_mfma_f32_16x16x32_bf16 v[92:95], a[60:63], a[12:15], v[92:95]
    v_mfma_f32_16x16x32_bf16 v[88:91], a[60:63], a[4:7], v[88:91]
    v_mfma_f32_16x16x32_bf16 v[88:91], a[56:59], a[0:3], v[88:91]
    s_add_u32 m0, s67, 0
    s_waitcnt vmcnt(9) lgkmcnt(0)
    s_barrier
    v_mfma_f32_16x16x32_bf16 v[100:103], a[64:67], a[0:3], v[100:103]
    s_mov_b32 s70, 1024
    ds_read_b64_tr_b16 a[48:49], v15 offset:36864
L_pg8:
    s_cbranch_execz L_pg5
    v_mfma_f32_16x16x32_bf16 v[100:103], a[68:71], a[4:7], v[100:103]
    s_mov_b64 exec, s[72:73]
    buffer_load_dwordx4 v5, s[24:27], s70 offen lds
    s_mov_b64 exec, -1
    v_mfma_f32_16x16x32_bf16 v[104:107], a[68:71], a[12:15], v[104:107]
    ds_read_b64_tr_b16 a[50:51], v15 offset:37504
    v_mfma_f32_16x16x32_bf16 v[104:107], a[64:67], a[8:11], v[104:107]
    ds_read_b64_tr_b16 a[52:53], v15 offset:42496
    v_mfma_f32_16x16x32_bf16 v[108:111], a[64:67], a[16:19], v[108:111]
    ds_read_b64_tr_b16 a[54:55], v15 offset:43136
    v_mfma_f32_16x16x32_bf16 v[108:111], a[68:71], a[20:23], v[108:111]
    ds_read_b128 a[40:43], v11 offset:28672
    v_mfma_f32_16x16x32_bf16 v[120:123], a[76:79], a[20:23], v[120:123]
    s_add_u32 m0, s67, 4096
    ds_read_b128 a[44:47], v12 offset:28672
    v_mfma_f32_16x16x32_bf16 v[120:123], a[72:75], a[16:19], v[120:123]
    buffer_load_dwordx4 v6, s[24:27], s70 offen lds
    v_mfma_f32_16x16x32_bf16 v[116:119], a[72:75], a[8:11], v[116:119]
    ds_read_b128 a[32:35], v11 offset:26624
    v_mfma_f32_16x16x32_bf16 v[116:119], a[76:79], a[12:15], v[116:119]
    ds_read_b128 a[36:39], v12 offset:26624
    v_mfma_f32_16x16x32_bf16 v[112:115], a[76:79], a[4:7], v[112:115]
    ds_read_b128 a[24:27], v11 offset:24576
    v_mfma_f32_16x16x32_bf16 v[112:115], a[72:75], a[0:3], v[112:115]
    s_add_u32 m0, s67, 8192
    ds_read_b128 a[28:31], v12 offset:24576
    v_mfma_f32_16x16x32_bf16 v[124:127], a[80:83], a[0:3], v[124:127]
    buffer_load_dwordx4 v7, s[24:27], s70 offen lds
    v_mfma_f32_16x16x32_bf16 v[124:127], a[84:87], a[4:7], v[124:127]
    ds_read_b64_tr_b16 a[56:57], v15 offset:36904
    v_mfma_f32_16x16x32_bf16 v[128:131], a[84:87], a[12:15], v[128:131]
    ds_read_b64_tr_b16 a[58:59], v15 offset:37544
    v_lshrrev_b32 v60, 1, v1
    v_mfma_f32_16x16x32_bf16 v[128:131], a[80:83], a[8:11], v[128:131]
    ds_read_b64_tr_b16 a[60:61], v15 offset:42536
    v_lshlrev_b32 v60, 3, v60
    v_mfma_f32_16x16x32_bf16 v[132:135], a[80:83], a[16:19], v[132:135]
    ds_read_b64_tr_b16 a[62:63], v15 offset:43176
    v_and_or_b32 v60, v1, 1, v60
    v_mfma_f32_16x16x32_bf16 v[132:135], a[84:87], a[20:23], v[132:135]
    ds_read_b64_tr_b16 a[64:65], v15 offset:36944
    s_waitcnt lgkmcnt(9)
    v_mfma_f32_16x16x32_bf16 v[204:207], a[44:47], a[52:55], v[204:207]
    s_add_u32 m0, s67, 12288
    ds_read_b64_tr_b16 a[66:67], v15 offset:37584
    s_lshl_b32 s63, s60, 16
    v_mfma_f32_16x16x32_bf16 v[204:207], a[40:43], a[48:51], v[204:207]
    buffer_load_dwordx4 v8, s[24:27], s70 offen lds
    s_waitcnt lgkmcnt(8)
    v_mfma_f32_16x16x32_bf16 v[200:203], a[32:35], a[48:51], v[200:203]
    ds_read_b64_tr_b16 a[68:69], v15 offset:42576
    s_add_u32 s63, s63, 20480
    v_mfma_f32_16x16x32_bf16 v[200:203], a[36:39], a[52:55], v[200:203]
    ds_read_b64_tr_b16 a[70:71], v15 offset:43216
    s_waitcnt lgkmcnt(8)
    v_mfma_f32_16x16x32_bf16 v[196:199], a[28:31], a[52:55], v[196:199]
    ds_read_b64_tr_b16 a[72:73], v15 offset:36984
    v_lshl_add_u32 v60, v60, 4, s63
    v_mfma_f32_16x16x32_bf16 v[196:199], a[24:27], a[48:51], v[196:199]
    s_add_u32 m0, s67, 16384
    ds_read_b64_tr_b16 a[74:75], v15 offset:37624
    s_waitcnt lgkmcnt(6)
    v_mfma_f32_16x16x32_bf16 v[208:211], a[24:27], a[56:59], v[208:211]
    buffer_load_dwordx4 v9, s[24:27], s70 offen lds
    v_mfma_f32_16x16x32_bf16 v[208:211], a[28:31], a[60:63], v[208:211]
    ds_read_b64_tr_b16 a[76:77], v15 offset:42616
    s_cmp_eq_u32 s60, 0
    s_cselect_b32 s83, 1, 0
    v_mfma_f32_16x16x32_bf16 v[212:215], a[36:39], a[60:63], v[212:215]
    ds_read_b64_tr_b16 a[78:79], v15 offset:43256
    buffer_load_dwordx4 v[22:25], v60, s[44:47], 0 offen sc1
    v_mfma_f32_16x16x32_bf16 v[212:215], a[32:35], a[56:59], v[212:215]
    ds_read_b64_tr_b16 a[80:81], v16 offset:36864
    v_mfma_f32_16x16x32_bf16 v[216:219], a[40:43], a[56:59], v[216:219]
    ds_read_b64_tr_b16 a[82:83], v16 offset:37504
    v_mfma_f32_16x16x32_bf16 v[216:219], a[44:47], a[60:63], v[216:219]
    s_add_u32 m0, s67, 20480
    ds_read_b64_tr_b16 a[84:85], v16 offset:42496
    s_waitcnt lgkmcnt(7)
    v_mfma_f32_16x16x32_bf16 v[228:231], a[44:47], a[68:71], v[228:231]
    buffer_load_dwordx4 v10, s[24:27], s70 offen lds
    v_mfma_f32_16x16x32_bf16 v[228:231], a[40:43], a[64:67], v[228:231]
    ds_read_b64_tr_b16 a[86:87], v16 offset:43136
    v_mfma_f32_16x16x32_bf16 v[224:227], a[32:35], a[64:67], v[224:227]
    ds_read_b64_tr_b16 a[48:49], v15 offset:49152
    v_mfma_f32_16x16x32_bf16 v[224:227], a[36:39], a[68:71], v[224:227]
    s_add_u32 m0, s68, 49152
    ds_read_b64_tr_b16 a[50:51], v15 offset:49792
    v_mfma_f32_16x16x32_bf16 v[220:223], a[28:31], a[68:71], v[220:223]
    s_mov_b32 s71, 2214400
    ds_read_b64_tr_b16 a[52:53], v15 offset:54784
    v_mfma_f32_16x16x32_bf16 v[220:223], a[24:27], a[64:67], v[220:223]
    buffer_load_dwordx4 v70, s[28:31], s71 offen lds
    s_waitcnt lgkmcnt(7)
    v_mfma_f32_16x16x32_bf16 v[232:235], a[24:27], a[72:75], v[232:235]
    ds_read_b64_tr_b16 a[54:55], v15 offset:55424
    v_mfma_f32_16x16x32_bf16 v[232:235], a[28:31], a[76:79], v[232:235]
    ds_read_b64_tr_b16 a[56:57], v15 offset:49192
    v_mfma_f32_16x16x32_bf16 v[236:239], a[36:39], a[76:79], v[236:239]
    ds_read_b64_tr_b16 a[58:59], v15 offset:49832
    v_mfma_f32_16x16x32_bf16 v[236:239], a[32:35], a[72:75], v[236:239]
    ds_read_b64_tr_b16 a[60:61], v15 offset:54824
    v_mfma_f32_16x16x32_bf16 v[240:243], a[40:43], a[72:75], v[240:243]
    ds_read_b64_tr_b16 a[62:63], v15 offset:55464
    v_mfma_f32_16x16x32_bf16 v[240:243], a[44:47], a[76:79], v[240:243]
    buffer_load_dwordx4 v71, s[28:31], s71 offen offset:1024 lds
    s_waitcnt lgkmcnt(8)
    v_mfma_f32_16x16x32_bf16 v[252:255], a[44:47], a[84:87], v[252:255]
    ds_read_b64_tr_b16 a[64:65], v15 offset:49232
    v_mfma_f32_16x16x32_bf16 v[252:255], a[40:43], a[80:83], v[252:255]
    ds_read_b64_tr_b16 a[66:67], v15 offset:49872
    v_mfma_f32_16x16x32_bf16 v[248:251], a[32:35], a[80:83], v[248:251]
    ds_read_b64_tr_b16 a[68:69], v15 offset:54864
    v_mfma_f32_16x16x32_bf16 v[248:251], a[36:39], a[84:87], v[248:251]
    ds_read_b64_tr_b16 a[70:71], v15 offset:55504
    v_mfma_f32_16x16x32_bf16 v[244:247], a[28:31], a[84:87], v[244:247]
    buffer_load_dwordx4 v72, s[28:31], s71 offen offset:2048 lds
    v_mfma_f32_16x16x32_bf16 v[244:247], a[24:27], a[80:83], v[244:247]
    ds_read_b64_tr_b16 a[72:73], v15 offset:49272
    s_waitcnt lgkmcnt(9)
    v_mfma_f32_16x16x32_bf16 v[136:139], a[48:51], a[24:27], v[136:139]
    ds_read_b64_tr_b16 a[74:75], v15 offset:49912
    v_mfma_f32_16x16x32_bf16 v[136:139], a[52:55], a[28:31], v[136:139]
    ds_read_b64_tr_b16 a[76:77], v15 offset:54904
    v_mfma_f32_16x16x32_bf16 v[140:143], a[52:55], a[36:39], v[140:143]
    s_add_u32 m0, s68, 61440
    ds_read_b64_tr_b16 a[78:79], v15 offset:55544
    v_mfma_f32_16x16x32_bf16 v[140:143], a[48:51], a[32:35], v[140:143]
    s_mov_b32 s71, 2213120
    ds_read_b64_tr_b16 a[80:81], v16 offset:49152
    v_mfma_f32_16x16x32_bf16 v[144:147], a[48:51], a[40:43], v[144:147]
    buffer_load_dwordx4 v70, s[28:31], s71 offen lds
    v_mfma_f32_16x16x32_bf16 v[144:147], a[52:55], a[44:47], v[144:147]
    ds_read_b64_tr_b16 a[82:83], v16 offset:49792
    s_waitcnt lgkmcnt(10)
    v_mfma_f32_16x16x32_bf16 v[156:159], a[60:63], a[44:47], v[156:159]
    ds_read_b64_tr_b16 a[84:85], v16 offset:54784
    v_mfma_f32_16x16x32_bf16 v[156:159], a[56:59], a[40:43], v[156:159]
    ds_read_b64_tr_b16 a[86:87], v16 offset:55424
    v_mfma_f32_16x16x32_bf16 v[152:155], a[56:59], a[32:35], v[152:155]
    ds_read_b64_tr_b16 a[48:49], v13 offset:0
    v_mfma_f32_16x16x32_bf16 v[152:155], a[60:63], a[36:39], v[152:155]
    buffer_load_dwordx4 v71, s[28:31], s71 offen offset:1024 lds
    v_mfma_f32_16x16x32_bf16 v[148:151], a[60:63], a[28:31], v[148:151]
    ds_read_b64_tr_b16 a[50:51], v13 offset:640
    v_mfma_f32_16x16x32_bf16 v[148:151], a[56:59], a[24:27], v[148:151]
    ds_read_b64_tr_b16 a[52:53], v13 offset:5632
    s_waitcnt lgkmcnt(11)
    v_mfma_f32_16x16x32_bf16 v[160:163], a[64:67], a[24:27], v[160:163]
    ds_read_b64_tr_b16 a[54:55], v13 offset:6272
    v_mfma_f32_16x16x32_bf16 v[160:163], a[68:71], a[28:31], v[160:163]
    ds_read_b64_tr_b16 a[56:57], v13 offset:40
    v_mfma_f32_16x16x32_bf16 v[164:167], a[68:71], a[36:39], v[164:167]
    ds_read_b64_tr_b16 a[58:59], v13 offset:680
    v_mfma_f32_16x16x32_bf16 v[164:167], a[64:67], a[32:35], v[164:167]
    ds_read_b64_tr_b16 a[60:61], v13 offset:5672
    v_mfma_f32_16x16x32_bf16 v[168:171], a[64:67], a[40:43], v[168:171]
    buffer_load_dwordx4 v72, s[28:31], s71 offen offset:2048 lds
    v_mfma_f32_16x16x32_bf16 v[168:171], a[68:71], a[44:47], v[168:171]
    ds_read_b64_tr_b16 a[62:63], v13 offset:6312
    s_waitcnt lgkmcnt(12)
    v_mfma_f32_16x16x32_bf16 v[180:183], a[76:79], a[44:47], v[180:183]
    ds_read_b64_tr_b16 a[64:65], v13 offset:80
    v_mfma_f32_16x16x32_bf16 v[180:183], a[72:75], a[40:43], v[180:183]
    s_add_u32 m0, s68, 73728
    ds_read_b64_tr_b16 a[66:67], v13 offset:720
    v_mfma_f32_16x16x32_bf16 v[176:179], a[72:75], a[32:35], v[176:179]
    s_mov_b32 s71, 2211840
    ds_read_b64_tr_b16 a[68:69], v13 offset:5712
    s_waitcnt vmcnt(7)
    v_mfma_f32_16x16x32_bf16 v[176:179], a[76:79], a[36:39], v[176:179]
    buffer_load_dwordx4 v70, s[28:31], s71 offen lds
    v_mfma_f32_16x16x32_bf16 v[172:175], a[76:79], a[28:31], v[172:175]
    ds_read_b64_tr_b16 a[70:71], v13 offset:6352
    v_and_b32 v22, v22, v23
    v_mfma_f32_16x16x32_bf16 v[172:175], a[72:75], a[24:27], v[172:175]
    v_and_b32 v24, v24, v25
    s_waitcnt lgkmcnt(12)
    v_mfma_f32_16x16x32_bf16 v[184:187], a[80:83], a[24:27], v[184:187]
    ds_read_b64_tr_b16 a[72:73], v13 offset:120
    v_and_b32 v22, v22, v24
    v_mfma_f32_16x16x32_bf16 v[184:187], a[84:87], a[28:31], v[184:187]
    ds_read_b64_tr_b16 a[74:75], v13 offset:760
    v_cmp_ne_u32 vcc, s83, v22
    v_mfma_f32_16x16x32_bf16 v[188:191], a[84:87], a[36:39], v[188:191]
    ds_read_b64_tr_b16 a[76:77], v13 offset:5752
    v_mfma_f32_16x16x32_bf16 v[188:191], a[80:83], a[32:35], v[188:191]
    buffer_load_dwordx4 v71, s[28:31], s71 offen offset:1024 lds
    v_mfma_f32_16x16x32_bf16 v[192:195], a[80:83], a[40:43], v[192:195]
    ds_read_b64_tr_b16 a[78:79], v13 offset:6392
    v_mfma_f32_16x16x32_bf16 v[192:195], a[84:87], a[44:47], v[192:195]
    s_waitcnt lgkmcnt(12)
    v_mfma_f32_16x16x32_bf16 v[84:87], a[52:55], a[44:47], v[84:87]
    ds_read_b64_tr_b16 a[80:81], v14 offset:0
    v_mfma_f32_16x16x32_bf16 v[84:87], a[48:51], a[40:43], v[84:87]
    ds_read_b64_tr_b16 a[82:83], v14 offset:640
    v_mfma_f32_16x16x32_bf16 v[80:83], a[48:51], a[32:35], v[80:83]
    buffer_load_dwordx4 v72, s[28:31], s71 offen offset:2048 lds
    v_mfma_f32_16x16x32_bf16 v[80:83], a[52:55], a[36:39], v[80:83]
    ds_read_b64_tr_b16 a[84:85], v14 offset:5632
    v_mfma_f32_16x16x32_bf16 v[76:79], a[52:55], a[28:31], v[76:79]
    ds_read_b64_tr_b16 a[86:87], v14 offset:6272
    s_nop 0
    s_cbranch_vccnz L_spin_qkve
L_back_qkve:
    v_mfma_f32_16x16x32_bf16 v[76:79], a[48:51], a[24:27], v[76:79]
    s_movk_i32 s101, 0x2000
    s_waitcnt lgkmcnt(12)
    v_mfma_f32_16x16x32_bf16 v[88:91], a[56:59], a[24:27], v[88:91]
    v_mfma_f32_16x16x32_bf16 v[88:91], a[60:63], a[28:31], v[88:91]
    v_mfma_f32_16x16x32_bf16 v[92:95], a[60:63], a[36:39], v[92:95]
    v_mfma_f32_16x16x32_bf16 v[92:95], a[56:59], a[32:35], v[92:95]
    v_mfma_f32_16x16x32_bf16 v[96:99], a[56:59], a[40:43], v[96:99]
    v_mfma_f32_16x16x32_bf16 v[96:99], a[60:63], a[44:47], v[96:99]
    s_add_u32 m0, s67, 24576
    s_waitcnt vmcnt(9) lgkmcnt(0)
    s_barrier
    v_mfma_f32_16x16x32_bf16 v[108:111], a[68:71], a[44:47], v[108:111]
    s_mov_b32 s70, 1152
    ds_read_b64_tr_b16 a[48:49], v13 offset:12288
    v_mfma_f32_16x16x32_bf16 v[108:111], a[64:67], a[40:43], v[108:111]
    s_mov_b64 exec, s[72:73]
    buffer_load_dwordx4 v5, s[24:27], s70 offen lds
    s_mov_b64 exec, -1
    v_mfma_f32_16x16x32_bf16 v[104:107], a[64:67], a[32:35], v[104:107]
    ds_read_b64_tr_b16 a[50:51], v13 offset:12928
    v_mfma_f32_16x16x32_bf16 v[104:107], a[68:71], a[36:39], v[104:107]
    ds_read_b64_tr_b16 a[52:53], v13 offset:17920
    v_mfma_f32_16x16x32_bf16 v[100:103], a[68:71], a[28:31], v[100:103]
    ds_read_b64_tr_b16 a[54:55], v13 offset:18560
    v_mfma_f32_16x16x32_bf16 v[100:103], a[64:67], a[24:27], v[100:103]
    ds_read_b128 a[0:3], v11 offset:0
    v_mfma_f32_16x16x32_bf16 v[112:115], a[72:75], a[24:27], v[112:115]
    s_add_u32 m0, s67, 28672
    ds_read_b128 a[4:7], v12 offset:0
    v_mfma_f32_16x16x32_bf16 v[112:115], a[76:79], a[28:31], v[112:115]
    buffer_load_dwordx4 v6, s[24:27], s70 offen lds
    v_mfma_f32_16x16x32_bf16 v[116:119], a[76:79], a[36:39], v[116:119]
    ds_read_b128 a[8:11], v11 offset:2048
    v_mfma_f32_16x16x32_bf16 v[116:119], a[72:75], a[32:35], v[116:119]
    ds_read_b128 a[12:15], v12 offset:2048
    v_mfma_f32_16x16x32_bf16 v[120:123], a[72:75], a[40:43], v[120:123]
    ds_read_b128 a[16:19], v11 offset:4096
    v_mfma_f32_16x16x32_bf16 v[120:123], a[76:79], a[44:47], v[120:123]
    s_add_u32 m0, s67, 32768
    ds_read_b128 a[20:23], v12 offset:4096
    v_mfma_f32_16x16x32_bf16 v[132:135], a[84:87], a[44:47], v[132:135]
    buffer_load_dwordx4 v7, s[24:27], s70 offen lds
    v_mfma_f32_16x16x32_bf16 v[132:135], a[80:83], a[40:43], v[132:135]
    ds_read_b64_tr_b16 a[56:57], v13 offset:12328
    v_mfma_f32_16x16x32_bf16 v[128:131], a[80:83], a[32:35], v[128:131]
    ds_read_b64_tr_b16 a[58:59], v13 offset:12968
    v_mfma_f32_16x16x32_bf16 v[128:131], a[84:87], a[36:39], v[128:131]
    ds_read_b64_tr_b16 a[60:61], v13 offset:17960
    v_mfma_f32_16x16x32_bf16 v[124:127], a[84:87], a[28:31], v[124:127]
    ds_read_b64_tr_b16 a[62:63], v13 offset:18600
    v_mfma_f32_16x16x32_bf16 v[124:127], a[80:83], a[24:27], v[124:127]
    ds_read_b64_tr_b16 a[64:65], v13 offset:12368
    s_waitcnt lgkmcnt(9)
    v_mfma_f32_16x16x32_bf16 v[196:199], a[0:3], a[48:51], v[196:199]
    s_add_u32 m0, s67, 36864
    ds_read_b64_tr_b16 a[66:67], v13 offset:13008
    v_mfma_f32_16x16x32_bf16 v[196:199], a[4:7], a[52:55], v[196:199]
    buffer_load_dwordx4 v8, s[24:27], s70 offen lds
    s_waitcnt lgkmcnt(8)
    v_mfma_f32_16x16x32_bf16 v[200:203], a[12:15], a[52:55], v[200:203]
    ds_read_b64_tr_b16 a[68:69], v13 offset:18000
    v_mfma_f32_16x16x32_bf16 v[200:203], a[8:11], a[48:51], v[200:203]
    ds_read_b64_tr_b16 a[70:71], v13 offset:18640
    s_waitcnt lgkmcnt(8)
    v_mfma_f32_16x16x32_bf16 v[204:207], a[16:19], a[48:51], v[204:207]
    s_add_u32 m0, s67, 40960
    ds_read_b64_tr_b16 a[72:73], v13 offset:12408
    v_mfma_f32_16x16x32_bf16 v[204:207], a[20:23], a[52:55], v[204:207]
    buffer_load_dwordx4 v9, s[24:27], s70 offen lds
    s_waitcnt lgkmcnt(5)
    v_mfma_f32_16x16x32_bf16 v[216:219], a[20:23], a[60:63], v[216:219]
    ds_read_b64_tr_b16 a[74:75], v13 offset:13048
    v_mfma_f32_16x16x32_bf16 v[216:219], a[16:19], a[56:59], v[216:219]
    ds_read_b64_tr_b16 a[76:77], v13 offset:18040
    v_mfma_f32_16x16x32_bf16 v[212:215], a[8:11], a[56:59], v[212:215]
    s_add_u32 m0, s67, 45056
    ds_read_b64_tr_b16 a[78:79], v13 offset:18680
    v_mfma_f32_16x16x32_bf16 v[212:215], a[12:15], a[60:63], v[212:215]
    buffer_load_dwordx4 v10, s[24:27], s70 offen lds
    v_mfma_f32_16x16x32_bf16 v[208:211], a[4:7], a[60:63], v[208:211]
    ds_read_b64_tr_b16 a[80:81], v14 offset:12288
    v_mfma_f32_16x16x32_bf16 v[208:211], a[0:3], a[56:59], v[208:211]
    ds_read_b64_tr_b16 a[82:83], v14 offset:12928
    s_waitcnt lgkmcnt(6)
    v_mfma_f32_16x16x32_bf16 v[220:223], a[0:3], a[64:67], v[220:223]
    ds_read_b64_tr_b16 a[84:85], v14 offset:17920
    v_mfma_f32_16x16x32_bf16 v[220:223], a[4:7], a[68:71], v[220:223]
    s_add_u32 m0, s69, 0
    ds_read_b64_tr_b16 a[86:87], v14 offset:18560
    v_mfma_f32_16x16x32_bf16 v[224:227], a[12:15], a[68:71], v[224:227]
    buffer_load_dword v64, s[44:47], 0 offen sc1 lds
    v_mfma_f32_16x16x32_bf16 v[224:227], a[8:11], a[64:67], v[224:227]
    ds_read_b64_tr_b16 a[48:49], v13 offset:24576
    v_mfma_f32_16x16x32_bf16 v[228:231], a[16:19], a[64:67], v[228:231]
    ds_read_b64_tr_b16 a[50:51], v13 offset:25216
    v_mfma_f32_16x16x32_bf16 v[228:231], a[20:23], a[68:71], v[228:231]
    s_add_u32 m0, s69, 256
    ds_read_b64_tr_b16 a[52:53], v13 offset:30208
    s_waitcnt lgkmcnt(7)
    v_mfma_f32_16x16x32_bf16 v[240:243], a[20:23], a[76:79], v[240:243]
    buffer_load_dword v64, s[44:47], s101 offen sc1 lds
    v_mfma_f32_16x16x32_bf16 v[240:243], a[16:19], a[72:75], v[240:243]
    ds_read_b64_tr_b16 a[54:55], v13 offset:30848
    v_mfma_f32_16x16x32_bf16 v[236:239], a[8:11], a[72:75], v[236:239]
    ds_read_b64_tr_b16 a[56:57], v13 offset:24616
    v_mfma_f32_16x16x32_bf16 v[236:239], a[12:15], a[76:79], v[236:239]
    ds_read_b64_tr_b16 a[58:59], v13 offset:25256
    v_mfma_f32_16x16x32_bf16 v[232:235], a[4:7], a[76:79], v[232:235]
    s_add_u32 s86, s87, 0
    ds_read_b64_tr_b16 a[60:61], v13 offset:30248
    v_mfma_f32_16x16x32_bf16 v[232:235], a[0:3], a[72:75], v[232:235]
    buffer_load_dwordx4 a[88:91], v3, s[40:43], s86 offen sc1
    s_waitcnt lgkmcnt(7)
    v_mfma_f32_16x16x32_bf16 v[244:247], a[0:3], a[80:83], v[244:247]
    ds_read_b64_tr_b16 a[62:63], v13 offset:30888
    v_mfma_f32_16x16x32_bf16 v[244:247], a[4:7], a[84:87], v[244:247]
    ds_read_b64_tr_b16 a[64:65], v13 offset:24656
    v_mfma_f32_16x16x32_bf16 v[248:251], a[12:15], a[84:87], v[248:251]
    ds_read_b64_tr_b16 a[66:67], v13 offset:25296
    v_mfma_f32_16x16x32_bf16 v[248:251], a[8:11], a[80:83], v[248:251]
    buffer_load_dwordx4 a[92:95], v3, s[40:43], s86 offen offset:1024 sc1
    v_mfma_f32_16x16x32_bf16 v[252:255], a[16:19], a[80:83], v[252:255]
    ds_read_b64_tr_b16 a[68:69], v13 offset:30288
    v_and_b32 v5, 48, v0
    v_mfma_f32_16x16x32_bf16 v[252:255], a[20:23], a[84:87], v[252:255]
    ds_read_b64_tr_b16 a[70:71], v13 offset:30928
    s_waitcnt lgkmcnt(8)
    v_mfma_f32_16x16x32_bf16 v[144:147], a[52:55], a[20:23], v[144:147]
    ds_read_b64_tr_b16 a[72:73], v13 offset:24696
    v_and_b32 v6, 15, v0
    v_mfma_f32_16x16x32_bf16 v[144:147], a[48:51], a[16:19], v[144:147]
    buffer_load_dwordx4 a[96:99], v3, s[40:43], s86 offen offset:2048 sc1
    v_mfma_f32_16x16x32_bf16 v[140:143], a[48:51], a[8:11], v[140:143]
    ds_read_b64_tr_b16 a[74:75], v13 offset:25336
    v_lshlrev_b32 v6, 2, v6
    v_mfma_f32_16x16x32_bf16 v[140:143], a[52:55], a[12:15], v[140:143]
    ds_read_b64_tr_b16 a[76:77], v13 offset:30328
    s_mul_i32 s63, s60, 5632
    v_mfma_f32_16x16x32_bf16 v[136:139], a[52:55], a[4:7], v[136:139]
    ds_read_b64_tr_b16 a[78:79], v13 offset:30968
    s_add_u32 s63, s63, 16384
    v_mfma_f32_16x16x32_bf16 v[136:139], a[48:51], a[0:3], v[136:139]
    ds_read_b64_tr_b16 a[80:81], v14 offset:24576
    s_waitcnt lgkmcnt(9)
    v_mfma_f32_16x16x32_bf16 v[148:151], a[56:59], a[0:3], v[148:151]
    buffer_load_dwordx4 a[100:103], v3, s[40:43], s86 offen offset:3072 sc1
    v_mfma_f32_16x16x32_bf16 v[148:151], a[60:63], a[4:7], v[148:151]
    ds_read_b64_tr_b16 a[82:83], v14 offset:25216
    v_lshl_add_u32 v7, v1, 4, s63
    v_mfma_f32_16x16x32_bf16 v[152:155], a[60:63], a[12:15], v[152:155]
    ds_read_b64_tr_b16 a[84:85], v14 offset:30208
    v_lshl_add_u32 v8, v1, 3, s63
    v_mfma_f32_16x16x32_bf16 v[152:155], a[56:59], a[8:11], v[152:155]
    ds_read_b64_tr_b16 a[86:87], v14 offset:30848
    s_add_u32 s63, s60, 3
    v_mfma_f32_16x16x32_bf16 v[156:159], a[56:59], a[16:19], v[156:159]
    buffer_load_dwordx4 a[104:107], v4, s[40:43], s86 offen sc1
    v_mfma_f32_16x16x32_bf16 v[156:159], a[60:63], a[20:23], v[156:159]
    ds_read_b64_tr_b16 a[48:49], v13 offset:36864
    s_waitcnt lgkmcnt(9)
    v_mfma_f32_16x16x32_bf16 v[168:171], a[68:71], a[20:23], v[168:171]
    ds_read_b64_tr_b16 a[50:51], v13 offset:37504
    s_and_b32 s63, s63, 3
    v_mfma_f32_16x16x32_bf16 v[168:171], a[64:67], a[16:19], v[168:171]
    ds_read_b64_tr_b16 a[52:53], v13 offset:42496
    s_mul_i32 s63, s63, 5632
    v_mfma_f32_16x16x32_bf16 v[164:167], a[64:67], a[8:11], v[164:167]
    ds_read_b64_tr_b16 a[54:55], v13 offset:43136
    s_add_u32 s63, s63, 16384
    v_mfma_f32_16x16x32_bf16 v[164:167], a[68:71], a[12:15], v[164:167]
    s_add_u32 s86, s87, 5120
    ds_read_b64_tr_b16 a[56:57], v13 offset:36904
    v_lshl_add_u32 v9, v1, 4, s63
    v_mfma_f32_16x16x32_bf16 v[160:163], a[68:71], a[4:7], v[160:163]
    buffer_load_dwordx4 a[108:111], v3, s[40:43], s86 offen sc1
    v_mfma_f32_16x16x32_bf16 v[160:163], a[64:67], a[0:3], v[160:163]
    ds_read_b64_tr_b16 a[58:59], v13 offset:37544
    s_waitcnt lgkmcnt(10)
    v_mfma_f32_16x16x32_bf16 v[172:175], a[72:75], a[0:3], v[172:175]
    ds_read_b64_tr_b16 a[60:61], v13 offset:42536
    v_lshl_add_u32 v10, v1, 3, s63
    v_mfma_f32_16x16x32_bf16 v[172:175], a[76:79], a[4:7], v[172:175]
    ds_read_b64_tr_b16 a[62:63], v13 offset:43176
    v_mfma_f32_16x16x32_bf16 v[176:179], a[76:79], a[12:15], v[176:179]
    buffer_load_dwordx4 a[112:115], v3, s[40:43], s86 offen offset:1024 sc1
    v_mfma_f32_16x16x32_bf16 v[176:179], a[72:75], a[8:11], v[176:179]
    ds_read_b64_tr_b16 a[64:65], v13 offset:36944
    v_mfma_f32_16x16x32_bf16 v[180:183], a[72:75], a[16:19], v[180:183]
    ds_read_b64_tr_b16 a[66:67], v13 offset:37584
    v_mfma_f32_16x16x32_bf16 v[180:183], a[76:79], a[20:23], v[180:183]
    ds_read_b64_tr_b16 a[68:69], v13 offset:42576
    s_waitcnt lgkmcnt(11)
    v_mfma_f32_16x16x32_bf16 v[192:195], a[84:87], a[20:23], v[192:195]
    buffer_load_dwordx4 a[116:119], v3, s[40:43], s86 offen offset:2048 sc1
    v_mfma_f32_16x16x32_bf16 v[192:195], a[80:83], a[16:19], v[192:195]
    ds_read_b64_tr_b16 a[70:71], v13 offset:43216
    v_mfma_f32_16x16x32_bf16 v[188:191], a[80:83], a[8:11], v[188:191]
    ds_read_b64_tr_b16 a[72:73], v13 offset:36984
    v_mfma_f32_16x16x32_bf16 v[188:191], a[84:87], a[12:15], v[188:191]
    ds_read_b64_tr_b16 a[74:75], v13 offset:37624
    v_mfma_f32_16x16x32_bf16 v[184:187], a[84:87], a[4:7], v[184:187]
    ds_read_b64_tr_b16 a[76:77], v13 offset:42616
    s_cmp_eq_u32 s60, 0
    s_cselect_b32 s14, 0x00010001, 0
    s_cselect_b32 s16, 0xffff, 0
    v_mfma_f32_16x16x32_bf16 v[184:187], a[80:83], a[0:3], v[184:187]
    buffer_load_dwordx4 a[120:123], v3, s[40:43], s86 offen offset:3072 sc1
    s_waitcnt lgkmcnt(11)
    v_mfma_f32_16x16x32_bf16 v[76:79], a[48:51], a[0:3], v[76:79]
    ds_read_b64_tr_b16 a[78:79], v13 offset:43256
    s_mov_b32 s15, s14
    v_mfma_f32_16x16x32_bf16 v[76:79], a[52:55], a[4:7], v[76:79]
    ds_read_b64_tr_b16 a[80:81], v14 offset:36864
    s_mov_b32 s17, 0
    v_mfma_f32_16x16x32_bf16 v[80:83], a[52:55], a[12:15], v[80:83]
    ds_read_b64_tr_b16 a[82:83], v14 offset:37504
    v_lshlrev_b32 v49, 4, v0
    v_mfma_f32_16x16x32_bf16 v[80:83], a[48:51], a[8:11], v[80:83]
    buffer_load_dwordx4 a[124:127], v4, s[40:43], s86 offen sc1
    v_mfma_f32_16x16x32_bf16 v[84:87], a[48:51], a[16:19], v[84:87]
    ds_read_b64_tr_b16 a[84:85], v14 offset:42496
    v_add_u32 v49, 4096, v49
    v_mfma_f32_16x16x32_bf16 v[84:87], a[52:55], a[20:23], v[84:87]
    ds_read_b64_tr_b16 a[86:87], v14 offset:43136
    s_waitcnt lgkmcnt(12)
    v_mfma_f32_16x16x32_bf16 v[96:99], a[60:63], a[20:23], v[96:99]
    v_cndmask_b32 v21, v49, v6, s[16:17]
    v_cndmask_b32 v49, v49, v5, s[14:15]
    v_mfma_f32_16x16x32_bf16 v[96:99], a[56:59], a[16:19], v[96:99]
    s_add_u32 s86, s87, 10240
    s_or_b32 s66, s61, s60
    s_cmp_eq_u32 s66, 0
    s_cselect_b32 s66, 0xf149f2ca, 0
    v_mfma_f32_16x16x32_bf16 v[92:95], a[56:59], a[8:11], v[92:95]
    buffer_load_dwordx4 a[128:131], v3, s[40:43], s86 offen sc1
    v_mfma_f32_16x16x32_bf16 v[92:95], a[60:63], a[12:15], v[92:95]
    s_lshl_b32 s63, s62, 13
    s_add_u32 s64, s63, 4096
    s_lshl_b32 s65, s62, 11
    v_mfma_f32_16x16x32_bf16 v[88:91], a[60:63], a[4:7], v[88:91]
    s_add_u32 s65, s65, 65536
    v_mfma_f32_16x16x32_bf16 v[88:91], a[56:59], a[0:3], v[88:91]
    s_waitcnt vmcnt(13) lgkmcnt(0)
    s_barrier
    v_mfma_f32_16x16x32_bf16 v[100:103], a[64:67], a[0:3], v[100:103]
    buffer_load_dwordx4 a[132:135], v3, s[40:43], s86 offen offset:1024 sc1
    v_mfma_f32_16x16x32_bf16 v[100:103], a[68:71], a[4:7], v[100:103]
    ds_read_b64_tr_b16 a[48:49], v15 offset:0
    v_mfma_f32_16x16x32_bf16 v[104:107], a[68:71], a[12:15], v[104:107]
    ds_read_b64_tr_b16 a[50:51], v15 offset:640
    v_mfma_f32_16x16x32_bf16 v[104:107], a[64:67], a[8:11], v[104:107]
    ds_read_b64_tr_b16 a[52:53], v15 offset:5632
    v_mfma_f32_16x16x32_bf16 v[108:111], a[64:67], a[16:19], v[108:111]
    buffer_load_dwordx4 a[136:139], v3, s[40:43], s86 offen offset:2048 sc1
    v_mfma_f32_16x16x32_bf16 v[108:111], a[68:71], a[20:23], v[108:111]
    ds_read_b64_tr_b16 a[54:55], v15 offset:6272
    v_mfma_f32_16x16x32_bf16 v[120:123], a[76:79], a[20:23], v[120:123]
    ds_read_b128 a[40:43], v11 offset:28672
    v_mfma_f32_16x16x32_bf16 v[120:123], a[72:75], a[16:19], v[120:123]
    ds_read_b128 a[44:47], v12 offset:28672
    v_mfma_f32_16x16x32_bf16 v[116:119], a[72:75], a[8:11], v[116:119]
    ds_read_b128 a[32:35], v11 offset:26624
    v_mfma_f32_16x16x32_bf16 v[116:119], a[76:79], a[12:15], v[116:119]
    buffer_load_dwordx4 a[140:143], v3, s[40:43], s86 offen offset:3072 sc1
    v_mfma_f32_16x16x32_bf16 v[112:115], a[76:79], a[4:7], v[112:115]
    ds_read_b128 a[36:39], v12 offset:26624
    v_mfma_f32_16x16x32_bf16 v[112:115], a[72:75], a[0:3], v[112:115]
    ds_read_b128 a[24:27], v11 offset:24576
    v_mfma_f32_16x16x32_bf16 v[124:127], a[80:83], a[0:3], v[124:127]
    ds_read_b128 a[28:31], v12 offset:24576
    v_mfma_f32_16x16x32_bf16 v[124:127], a[84:87], a[4:7], v[124:127]
    buffer_load_dwordx4 a[144:147], v4, s[40:43], s86 offen sc1
    v_mfma_f32_16x16x32_bf16 v[128:131], a[84:87], a[12:15], v[128:131]
    ds_read_b64_tr_b16 a[56:57], v15 offset:40
    s_waitcnt vmcnt(15)
    v_mfma_f32_16x16x32_bf16 v[128:131], a[80:83], a[8:11], v[128:131]
    ds_read_b64_tr_b16 a[58:59], v15 offset:680
    ds_read_b128 v[22:25], v66 offset:0
    v_mfma_f32_16x16x32_bf16 v[132:135], a[80:83], a[16:19], v[132:135]
    ds_read_b64_tr_b16 a[60:61], v15 offset:5672
    ds_read_b32 v46, v65 offset:0
    v_mfma_f32_16x16x32_bf16 v[132:135], a[84:87], a[20:23], v[132:135]
    ds_read_b64_tr_b16 a[62:63], v15 offset:6312
    s_waitcnt lgkmcnt(10)
    v_mfma_f32_16x16x32_bf16 v[204:207], a[44:47], a[52:55], v[204:207]
    s_add_u32 s86, s87, 15360
    ds_read_b64_tr_b16 a[64:65], v15 offset:80
    ds_read_b128 v[26:29], v66 offset:256
    v_mfma_f32_16x16x32_bf16 v[204:207], a[40:43], a[48:51], v[204:207]
    buffer_load_dwordx4 a[148:151], v3, s[40:43], s86 offen sc1
    s_waitcnt lgkmcnt(10)
    v_mfma_f32_16x16x32_bf16 v[200:203], a[32:35], a[48:51], v[200:203]
    ds_read_b64_tr_b16 a[66:67], v15 offset:720
    ds_read_b32 v50, v65 offset:256
    v_mfma_f32_16x16x32_bf16 v[200:203], a[36:39], a[52:55], v[200:203]
    ds_read_b64_tr_b16 a[68:69], v15 offset:5712
    s_waitcnt lgkmcnt(11)
    v_mfma_f32_16x16x32_bf16 v[196:199], a[28:31], a[52:55], v[196:199]
    ds_read_b64_tr_b16 a[70:71], v15 offset:6352
    ds_read_b128 v[30:33], v66 offset:64
    v_mfma_f32_16x16x32_bf16 v[196:199], a[24:27], a[48:51], v[196:199]
    buffer_load_dwordx4 a[152:155], v3, s[40:43], s86 offen offset:1024 sc1
    s_waitcnt lgkmcnt(7)
    v_mfma_f32_16x16x32_bf16 v[208:211], a[24:27], a[56:59], v[208:211]
    ds_read_b64_tr_b16 a[72:73], v15 offset:120
    ds_read_b32 v47, v65 offset:64
    v_mfma_f32_16x16x32_bf16 v[208:211], a[28:31], a[60:63], v[208:211]
    ds_read_b64_tr_b16 a[74:75], v15 offset:760
    ds_read_b128 v[34:37], v66 offset:320
    v_mfma_f32_16x16x32_bf16 v[212:215], a[36:39], a[60:63], v[212:215]
    ds_read_b64_tr_b16 a[76:77], v15 offset:5752
    ds_read_b32 v51, v65 offset:320
    v_mfma_f32_16x16x32_bf16 v[212:215], a[32:35], a[56:59], v[212:215]
    buffer_load_dwordx4 a[156:159], v3, s[40:43], s86 offen offset:2048 sc1
    v_mfma_f32_16x16x32_bf16 v[216:219], a[40:43], a[56:59], v[216:219]
    ds_read_b64_tr_b16 a[78:79], v15 offset:6392
    ds_read_b128 v[38:41], v66 offset:128
    v_mfma_f32_16x16x32_bf16 v[216:219], a[44:47], a[60:63], v[216:219]
    ds_read_b64_tr_b16 a[80:81], v16 offset:0
    s_waitcnt lgkmcnt(10)
    v_mfma_f32_16x16x32_bf16 v[228:231], a[44:47], a[68:71], v[228:231]
    ds_read_b64_tr_b16 a[82:83], v16 offset:640
    ds_read_b32 v48, v65 offset:128
    v_mfma_f32_16x16x32_bf16 v[228:231], a[40:43], a[64:67], v[228:231]
    ds_read_b64_tr_b16 a[84:85], v16 offset:5632
    ds_read_b128 v[42:45], v66 offset:384
    v_mfma_f32_16x16x32_bf16 v[224:227], a[32:35], a[64:67], v[224:227]
    buffer_load_dwordx4 a[160:163], v3, s[40:43], s86 offen offset:3072 sc1
    v_mfma_f32_16x16x32_bf16 v[224:227], a[36:39], a[68:71], v[224:227]
    ds_read_b64_tr_b16 a[86:87], v16 offset:6272
    ds_read_b32 v52, v65 offset:384
    v_mfma_f32_16x16x32_bf16 v[220:223], a[28:31], a[68:71], v[220:223]
    ds_read_b64_tr_b16 a[48:49], v15 offset:12288
    v_mfma_f32_16x16x32_bf16 v[220:223], a[24:27], a[64:67], v[220:223]
    ds_read_b64_tr_b16 a[50:51], v15 offset:12928
    s_waitcnt lgkmcnt(10)
    v_mfma_f32_16x16x32_bf16 v[232:235], a[24:27], a[72:75], v[232:235]
    buffer_load_dwordx4 a[164:167], v4, s[40:43], s86 offen sc1
    v_mfma_f32_16x16x32_bf16 v[232:235], a[28:31], a[76:79], v[232:235]
    ds_read_b64_tr_b16 a[52:53], v15 offset:17920
    v_mfma_f32_16x16x32_bf16 v[236:239], a[36:39], a[76:79], v[236:239]
    ds_read_b64_tr_b16 a[54:55], v15 offset:18560
L_pg9:
    s_cbranch_execz L_p2
    v_mfma_f32_16x16x32_bf16 v[236:239], a[32:35], a[72:75], v[236:239]
    ds_read_b64_tr_b16 a[56:57], v15 offset:12328
    v_mfma_f32_16x16x32_bf16 v[240:243], a[40:43], a[72:75], v[240:243]
    s_add_u32 s86, s87, 20480
    ds_read_b64_tr_b16 a[58:59], v15 offset:12968
    v_mfma_f32_16x16x32_bf16 v[240:243], a[44:47], a[76:79], v[240:243]
    buffer_load_dwordx4 a[168:171], v3, s[40:43], s86 offen sc1
    s_waitcnt lgkmcnt(7)
    v_mfma_f32_16x16x32_bf16 v[252:255], a[44:47], a[84:87], v[252:255]
    ds_read_b64_tr_b16 a[60:61], v15 offset:17960
    v_mfma_f32_16x16x32_bf16 v[252:255], a[40:43], a[80:83], v[252:255]
    ds_read_b64_tr_b16 a[62:63], v15 offset:18600
    v_mfma_f32_16x16x32_bf16 v[248:251], a[32:35], a[80:83], v[248:251]
    ds_read_b64_tr_b16 a[64:65], v15 offset:12368
    v_mfma_f32_16x16x32_bf16 v[248:251], a[36:39], a[84:87], v[248:251]
    buffer_load_dwordx4 a[172:175], v3, s[40:43], s86 offen offset:1024 sc1
    v_mfma_f32_16x16x32_bf16 v[244:247], a[28:31], a[84:87], v[244:247]
    ds_read_b64_tr_b16 a[66:67], v15 offset:13008
    v_mfma_f32_16x16x32_bf16 v[244:247], a[24:27], a[80:83], v[244:247]
    ds_write_b32 v21, v196 offset:640
    s_waitcnt lgkmcnt(7)
    v_mfma_f32_16x16x32_bf16 v[136:139], a[48:51], a[24:27], v[136:139]
    ds_read_b64_tr_b16 a[68:69], v15 offset:18000
    ds_read_b64_tr_b16 a[80:81], v16 offset:12288
    v_mfma_f32_16x16x32_bf16 v[136:139], a[52:55], a[28:31], v[136:139]
    buffer_load_dwordx4 a[176:179], v3, s[40:43], s86 offen offset:2048 sc1
    ds_write_b32 v21, v208 offset:704
    v_mfma_f32_16x16x32_bf16 v[140:143], a[52:55], a[36:39], v[140:143]
    ds_read_b64_tr_b16 a[70:71], v15 offset:18640
    ds_read_b64_tr_b16 a[82:83], v16 offset:12928
    v_mfma_f32_16x16x32_bf16 v[140:143], a[48:51], a[32:35], v[140:143]
    ds_write_b32 v21, v220 offset:768
    ds_read_b64_tr_b16 a[72:73], v15 offset:12408
    v_mfma_f32_16x16x32_bf16 v[144:147], a[48:51], a[40:43], v[144:147]
    ds_read_b64_tr_b16 a[74:75], v15 offset:13048
    ds_read_b64_tr_b16 a[84:85], v16 offset:17920
    v_mfma_f32_16x16x32_bf16 v[144:147], a[52:55], a[44:47], v[144:147]
    ds_write_b32 v21, v232 offset:832
    s_waitcnt lgkmcnt(13)
    v_mfma_f32_16x16x32_bf16 v[156:159], a[60:63], a[44:47], v[156:159]
    buffer_load_dwordx4 a[180:183], v3, s[40:43], s86 offen offset:3072 sc1
    v_mfma_f32_16x16x32_bf16 v[156:159], a[56:59], a[40:43], v[156:159]
    ds_write_b32 v21, v244 offset:896
    ds_read_b64_tr_b16 a[76:77], v15 offset:18040
    v_mfma_f32_16x16x32_bf16 v[152:155], a[56:59], a[32:35], v[152:155]
    ds_read_b64_tr_b16 a[78:79], v15 offset:18680
    v_mfma_f32_16x16x32_bf16 v[152:155], a[60:63], a[36:39], v[152:155]
    ds_read_b64_tr_b16 a[86:87], v16 offset:18560
    v_mfma_f32_16x16x32_bf16 v[148:151], a[60:63], a[28:31], v[148:151]
    buffer_load_dwordx4 a[184:187], v4, s[40:43], s86 offen sc1
    v_mfma_f32_16x16x32_bf16 v[148:151], a[56:59], a[24:27], v[148:151]
    s_waitcnt lgkmcnt(10)
    v_mfma_f32_16x16x32_bf16 v[160:163], a[64:67], a[24:27], v[160:163]
    v_mfma_f32_16x16x32_bf16 v[160:163], a[68:71], a[28:31], v[160:163]
    v_mfma_f32_16x16x32_bf16 v[164:167], a[68:71], a[36:39], v[164:167]
    s_waitcnt lgkmcnt(0)
    s_barrier
    v_mfma_f32_16x16x32_bf16 v[164:167], a[64:67], a[32:35], v[164:167]
    s_add_u32 s86, s87, 25600
    ds_read_b32 v64, v6 offset:896
    ds_read_b64_tr_b16 a[48:49], v15 offset:24576
    v_mfma_f32_16x16x32_bf16 v[168:171], a[64:67], a[40:43], v[168:171]
    buffer_load_dwordx4 a[188:191], v3, s[40:43], s86 offen sc1
    ds_read_b32 v63, v6 offset:832
    v_mfma_f32_16x16x32_bf16 v[168:171], a[68:71], a[44:47], v[168:171]
    ds_read_b32 v62, v6 offset:768
    v_mfma_f32_16x16x32_bf16 v[180:183], a[76:79], a[44:47], v[180:183]
    ds_read_b32 v61, v6 offset:704
    ds_read_b64_tr_b16 a[50:51], v15 offset:25216
    v_mfma_f32_16x16x32_bf16 v[180:183], a[72:75], a[40:43], v[180:183]
    ds_read_b32 v60, v6 offset:640
    ds_read_b64_tr_b16 a[52:53], v15 offset:30208
    v_mfma_f32_16x16x32_bf16 v[176:179], a[72:75], a[32:35], v[176:179]
    buffer_load_dwordx4 a[192:195], v3, s[40:43], s86 offen offset:1024 sc1
    v_mfma_f32_16x16x32_bf16 v[176:179], a[76:79], a[36:39], v[176:179]
    ds_read_b64_tr_b16 a[54:55], v15 offset:30848
    v_mfma_f32_16x16x32_bf16 v[172:175], a[76:79], a[28:31], v[172:175]
    ds_write_b128 v49, v[136:139] offset:320
    v_mfma_f32_16x16x32_bf16 v[172:175], a[72:75], a[24:27], v[172:175]
    ds_read_b64_tr_b16 a[56:57], v15 offset:24616
    v_mfma_f32_16x16x32_bf16 v[184:187], a[80:83], a[24:27], v[184:187]
    buffer_load_dwordx4 a[196:199], v3, s[40:43], s86 offen offset:2048 sc1
    v_mfma_f32_16x16x32_bf16 v[184:187], a[84:87], a[28:31], v[184:187]
    ds_read_b64_tr_b16 a[58:59], v15 offset:25256
    ds_read_b64_tr_b16 a[72:73], v15 offset:24696
    v_mfma_f32_16x16x32_bf16 v[188:191], a[84:87], a[36:39], v[188:191]
    ds_write_b128 v49, v[148:151] offset:384
    v_mfma_f32_16x16x32_bf16 v[188:191], a[80:83], a[32:35], v[188:191]
    ds_read_b64_tr_b16 a[60:61], v15 offset:30248
    ds_read_b64_tr_b16 a[74:75], v15 offset:25336
    v_mfma_f32_16x16x32_bf16 v[192:195], a[80:83], a[40:43], v[192:195]
    ds_read_b64_tr_b16 a[62:63], v15 offset:30888
    ds_read_b64_tr_b16 a[76:77], v15 offset:30328
    v_mfma_f32_16x16x32_bf16 v[192:195], a[84:87], a[44:47], v[192:195]
    buffer_load_dwordx4 a[200:203], v3, s[40:43], s86 offen offset:3072 sc1
    s_waitcnt lgkmcnt(9)
    v_mfma_f32_16x16x32_bf16 v[84:87], a[52:55], a[44:47], v[84:87]
    ds_read_b64_tr_b16 a[64:65], v15 offset:24656
    ds_read_b64_tr_b16 a[80:81], v16 offset:24576
    v_mfma_f32_16x16x32_bf16 v[84:87], a[48:51], a[40:43], v[84:87]
    ds_read_b64_tr_b16 a[66:67], v15 offset:25296
    ds_read_b64_tr_b16 a[82:83], v16 offset:25216
    v_mfma_f32_16x16x32_bf16 v[80:83], a[48:51], a[32:35], v[80:83]
    ds_read_b64_tr_b16 a[68:69], v15 offset:30288
    ds_read_b64_tr_b16 a[84:85], v16 offset:30208
    v_mfma_f32_16x16x32_bf16 v[80:83], a[52:55], a[36:39], v[80:83]
    buffer_load_dwordx4 a[204:207], v4, s[40:43], s86 offen sc1
    v_mfma_f32_16x16x32_bf16 v[76:79], a[52:55], a[28:31], v[76:79]
    ds_write_b128 v49, v[160:163] offset:448
    v_mfma_f32_16x16x32_bf16 v[76:79], a[48:51], a[24:27], v[76:79]
    ds_read_b64_tr_b16 a[70:71], v15 offset:30928
    s_waitcnt lgkmcnt(9)
    v_mfma_f32_16x16x32_bf16 v[88:91], a[56:59], a[24:27], v[88:91]
    ds_read_b64_tr_b16 a[78:79], v15 offset:30968
    ds_read_b64_tr_b16 a[86:87], v16 offset:30848
    v_mfma_f32_16x16x32_bf16 v[88:91], a[60:63], a[28:31], v[88:91]
    s_add_u32 s86, s87, 30720
    v_mfma_f32_16x16x32_bf16 v[92:95], a[60:63], a[36:39], v[92:95]
    buffer_load_dwordx4 a[208:211], v3, s[40:43], s86 offen sc1
    v_mfma_f32_16x16x32_bf16 v[92:95], a[56:59], a[32:35], v[92:95]
    v_mfma_f32_16x16x32_bf16 v[96:99], a[56:59], a[40:43], v[96:99]
    v_mfma_f32_16x16x32_bf16 v[96:99], a[60:63], a[44:47], v[96:99]
    s_waitcnt lgkmcnt(0)
    s_barrier
    v_mfma_f32_16x16x32_bf16 v[108:111], a[68:71], a[44:47], v[108:111]
    buffer_load_dwordx4 a[212:215], v3, s[40:43], s86 offen offset:1024 sc1
    v_mfma_f32_16x16x32_bf16 v[108:111], a[64:67], a[40:43], v[108:111]
    v_mfma_f32_16x16x32_bf16 v[104:107], a[64:67], a[32:35], v[104:107]
    v_mfma_f32_16x16x32_bf16 v[104:107], a[68:71], a[36:39], v[104:107]
    v_mfma_f32_16x16x32_bf16 v[100:103], a[68:71], a[28:31], v[100:103]
    buffer_load_dwordx4 a[216:219], v3, s[40:43], s86 offen offset:2048 sc1
    ds_write_b128 v49, v[172:175] offset:512
    v_mfma_f32_16x16x32_bf16 v[100:103], a[64:67], a[24:27], v[100:103]
    v_mfma_f32_16x16x32_bf16 v[112:115], a[72:75], a[24:27], v[112:115]
    v_mfma_f32_16x16x32_bf16 v[112:115], a[76:79], a[28:31], v[112:115]
    ds_write_b128 v49, v[184:187] offset:576
    v_mfma_f32_16x16x32_bf16 v[116:119], a[76:79], a[36:39], v[116:119]
    v_mfma_f32_16x16x32_bf16 v[116:119], a[72:75], a[32:35], v[116:119]
    buffer_load_dwordx4 a[220:223], v3, s[40:43], s86 offen offset:3072 sc1
    v_mfma_f32_16x16x32_bf16 v[120:123], a[72:75], a[40:43], v[120:123]
    ds_write_b128 v49, v[76:79] offset:0
    v_mfma_f32_16x16x32_bf16 v[120:123], a[76:79], a[44:47], v[120:123]
    v_mfma_f32_16x16x32_bf16 v[132:135], a[84:87], a[44:47], v[132:135]
    v_mfma_f32_16x16x32_bf16 v[132:135], a[80:83], a[40:43], v[132:135]
    buffer_load_dwordx4 a[224:227], v4, s[40:43], s86 offen sc1
    ds_write_b128 v49, v[88:91] offset:64
    v_mfma_f32_16x16x32_bf16 v[128:131], a[80:83], a[32:35], v[128:131]
    v_mfma_f32_16x16x32_bf16 v[128:131], a[84:87], a[36:39], v[128:131]
    v_mfma_f32_16x16x32_bf16 v[124:127], a[84:87], a[28:31], v[124:127]
    ds_write_b128 v49, v[100:103] offset:128
    v_mfma_f32_16x16x32_bf16 v[124:127], a[80:83], a[24:27], v[124:127]
    v_mov_b32 v12, s66
    v_mov_b32 v13, s66
    v_mov_b32 v14, s66
    v_mov_b32_e64 v15, s66
    v_pk_fma_f32 v[252:253], v[38:39], v[64:65], v[252:253] op_sel:[0,0,0] op_sel_hi:[1,0,1] neg_lo:[0,1,0] neg_hi:[0,1,0]
    v_pk_fma_f32 v[254:255], v[40:41], v[64:65], v[254:255] op_sel:[0,0,0] op_sel_hi:[1,0,1] neg_lo:[0,1,0] neg_hi:[0,1,0]
    v_pk_mul_f32 v[252:253], v[252:253], v[42:43]
    ds_write_b128 v49, v[112:115] offset:192
    v_pk_mul_f32 v[254:255], v[254:255], v[44:45]
    v_cvt_pk_bf16_f32 v66, v252, v253
    v_cvt_pk_bf16_f32 v67, v254, v255
    s_add_u32 s86, s87, 35840
    buffer_load_dwordx4 a[228:231], v3, s[40:43], s86 offen sc1
    ds_write_b64 v8, v[66:67] offset:5120
    v_pk_fma_f32 v[244:245], v[22:23], v[64:65], v[244:245] op_sel:[0,0,0] op_sel_hi:[1,0,1] neg_lo:[0,1,0] neg_hi:[0,1,0]
    v_pk_fma_f32 v[246:247], v[24:25], v[64:65], v[246:247] op_sel:[0,0,0] op_sel_hi:[1,0,1] neg_lo:[0,1,0] neg_hi:[0,1,0]
    ds_write_b128 v49, v[124:127] offset:256
    v_pk_mul_f32 v[244:245], v[244:245], v[26:27]
    v_pk_mul_f32 v[246:247], v[246:247], v[28:29]
    v_cvt_pk_bf16_f32 v70, v244, v245
    v_cvt_pk_bf16_f32 v71, v246, v247
    v_pk_fma_f32 v[248:249], v[30:31], v[64:65], v[248:249] op_sel:[0,0,0] op_sel_hi:[1,0,1] neg_lo:[0,1,0] neg_hi:[0,1,0]
    v_pk_fma_f32 v[250:251], v[32:33], v[64:65], v[250:251] op_sel:[0,0,0] op_sel_hi:[1,0,1] neg_lo:[0,1,0] neg_hi:[0,1,0]
    v_pk_mul_f32 v[248:249], v[248:249], v[34:35]
    v_pk_mul_f32 v[250:251], v[250:251], v[36:37]
    buffer_load_dwordx4 a[232:235], v3, s[40:43], s86 offen offset:1024 sc1
    v_cvt_pk_bf16_f32 v68, v248, v249
    v_cvt_pk_bf16_f32 v69, v250, v251
    v_pk_fma_f32 v[240:241], v[38:39], v[62:63], v[240:241] op_sel:[0,1,0] op_sel_hi:[1,1,1] neg_lo:[0,1,0] neg_hi:[0,1,0]
    v_pk_fma_f32 v[242:243], v[40:41], v[62:63], v[242:243] op_sel:[0,1,0] op_sel_hi:[1,1,1] neg_lo:[0,1,0] neg_hi:[0,1,0]
    v_pk_mul_f32 v[240:241], v[240:241], v[42:43]
    v_pk_mul_f32 v[242:243], v[242:243], v[44:45]
    s_waitcnt lgkmcnt(0)
    s_barrier
    v_cvt_pk_bf16_f32 v248, v240, v241
    ds_read_b128 v[244:247], v5 offset:576
    v_cvt_pk_bf16_f32 v249, v242, v243
    ds_write_b64 v8, v[248:249] offset:4608
    v_pk_fma_f32 v[232:233], v[22:23], v[62:63], v[232:233] op_sel:[0,1,0] op_sel_hi:[1,1,1] neg_lo:[0,1,0] neg_hi:[0,1,0]
    v_pk_fma_f32 v[234:235], v[24:25], v[62:63], v[234:235] op_sel:[0,1,0] op_sel_hi:[1,1,1] neg_lo:[0,1,0] neg_hi:[0,1,0]
    buffer_load_dwordx4 a[236:239], v3, s[40:43], s86 offen offset:2048 sc1
    v_pk_mul_f32 v[232:233], v[232:233], v[26:27]
    v_pk_mul_f32 v[234:235], v[234:235], v[28:29]
    v_cvt_pk_bf16_f32 v252, v232, v233
    v_cvt_pk_bf16_f32 v253, v234, v235
    v_pk_fma_f32 v[236:237], v[30:31], v[62:63], v[236:237] op_sel:[0,1,0] op_sel_hi:[1,1,1] neg_lo:[0,1,0] neg_hi:[0,1,0]
    v_pk_fma_f32 v[238:239], v[32:33], v[62:63], v[238:239] op_sel:[0,1,0] op_sel_hi:[1,1,1] neg_lo:[0,1,0] neg_hi:[0,1,0]
    v_pk_mul_f32 v[236:237], v[236:237], v[34:35]
    v_pk_mul_f32 v[238:239], v[238:239], v[36:37]
    v_cvt_pk_bf16_f32 v250, v236, v237
    v_cvt_pk_bf16_f32 v251, v238, v239
    buffer_load_dwordx4 a[240:243], v3, s[40:43], s86 offen offset:3072 sc1
    ds_read_b128 v[232:235], v5 offset:512
    v_pk_fma_f32 v[228:229], v[38:39], v[62:63], v[228:229] op_sel:[0,0,0] op_sel_hi:[1,0,1] neg_lo:[0,1,0] neg_hi:[0,1,0]
    v_pk_fma_f32 v[230:231], v[40:41], v[62:63], v[230:231] op_sel:[0,0,0] op_sel_hi:[1,0,1] neg_lo:[0,1,0] neg_hi:[0,1,0]
    v_pk_mul_f32 v[228:229], v[228:229], v[42:43]
    v_pk_mul_f32 v[230:231], v[230:231], v[44:45]
    v_cvt_pk_bf16_f32 v236, v228, v229
    v_cvt_pk_bf16_f32 v237, v230, v231
    ds_write_b64 v8, v[236:237] offset:4096
    v_pk_fma_f32 v[220:221], v[22:23], v[62:63], v[220:221] op_sel:[0,0,0] op_sel_hi:[1,0,1] neg_lo:[0,1,0] neg_hi:[0,1,0]
    v_pk_fma_f32 v[222:223], v[24:25], v[62:63], v[222:223] op_sel:[0,0,0] op_sel_hi:[1,0,1] neg_lo:[0,1,0] neg_hi:[0,1,0]
    v_pk_mul_f32 v[220:221], v[220:221], v[26:27]
    v_pk_mul_f32 v[222:223], v[222:223], v[28:29]
    buffer_load_dwordx4 a[244:247], v4, s[40:43], s86 offen sc1
    v_cvt_pk_bf16_f32 v240, v220, v221
    v_cvt_pk_bf16_f32 v241, v222, v223
    v_pk_fma_f32 v[224:225], v[30:31], v[62:63], v[224:225] op_sel:[0,0,0] op_sel_hi:[1,0,1] neg_lo:[0,1,0] neg_hi:[0,1,0]
    v_pk_fma_f32 v[226:227], v[32:33], v[62:63], v[226:227] op_sel:[0,0,0] op_sel_hi:[1,0,1] neg_lo:[0,1,0] neg_hi:[0,1,0]
    v_pk_mul_f32 v[224:225], v[224:225], v[34:35]
    v_pk_mul_f32 v[226:227], v[226:227], v[36:37]
    v_cvt_pk_bf16_f32 v238, v224, v225
    v_cvt_pk_bf16_f32 v239, v226, v227
    ds_read_b128 v[220:223], v5 offset:448
    v_pk_fma_f32 v[216:217], v[38:39], v[60:61], v[216:217] op_sel:[0,1,0] op_sel_hi:[1,1,1] neg_lo:[0,1,0] neg_hi:[0,1,0]
    v_pk_fma_f32 v[218:219], v[40:41], v[60:61], v[218:219] op_sel:[0,1,0] op_sel_hi:[1,1,1] neg_lo:[0,1,0] neg_hi:[0,1,0]
    s_add_u32 s86, s87, 40960
    buffer_load_dwordx4 a[0:3], v3, s[40:43], s86 offen sc1
    v_pk_mul_f32 v[216:217], v[216:217], v[42:43]
    v_pk_mul_f32 v[218:219], v[218:219], v[44:45]
    v_cvt_pk_bf16_f32 v224, v216, v217
    v_cvt_pk_bf16_f32 v225, v218, v219
    ds_write_b64 v8, v[224:225] offset:3584
    v_pk_fma_f32 v[208:209], v[22:23], v[60:61], v[208:209] op_sel:[0,1,0] op_sel_hi:[1,1,1] neg_lo:[0,1,0] neg_hi:[0,1,0]
    v_pk_fma_f32 v[210:211], v[24:25], v[60:61], v[210:211] op_sel:[0,1,0] op_sel_hi:[1,1,1] neg_lo:[0,1,0] neg_hi:[0,1,0]
    v_pk_mul_f32 v[208:209], v[208:209], v[26:27]
    v_pk_mul_f32 v[210:211], v[210:211], v[28:29]
    v_cvt_pk_bf16_f32 v228, v208, v209
    v_cvt_pk_bf16_f32 v229, v210, v211
    buffer_load_dwordx4 a[4:7], v3, s[40:43], s86 offen offset:1024 sc1
    v_pk_fma_f32 v[212:213], v[30:31], v[60:61], v[212:213] op_sel:[0,1,0] op_sel_hi:[1,1,1] neg_lo:[0,1,0] neg_hi:[0,1,0]
    v_pk_fma_f32 v[214:215], v[32:33], v[60:61], v[214:215] op_sel:[0,1,0] op_sel_hi:[1,1,1] neg_lo:[0,1,0] neg_hi:[0,1,0]
    v_pk_mul_f32 v[212:213], v[212:213], v[34:35]
    v_pk_mul_f32 v[214:215], v[214:215], v[36:37]
    v_cvt_pk_bf16_f32 v226, v212, v213
    v_cvt_pk_bf16_f32 v227, v214, v215
    ds_read_b128 v[208:211], v5 offset:384
    v_pk_fma_f32 v[204:205], v[38:39], v[60:61], v[204:205] op_sel:[0,0,0] op_sel_hi:[1,0,1] neg_lo:[0,1,0] neg_hi:[0,1,0]
    v_pk_fma_f32 v[206:207], v[40:41], v[60:61], v[206:207] op_sel:[0,0,0] op_sel_hi:[1,0,1] neg_lo:[0,1,0] neg_hi:[0,1,0]
    v_pk_mul_f32 v[204:205], v[204:205], v[42:43]
    v_pk_mul_f32 v[206:207], v[206:207], v[44:45]
    buffer_load_dwordx4 a[8:11], v3, s[40:43], s86 offen offset:2048 sc1
    v_cvt_pk_bf16_f32 v212, v204, v205
    v_cvt_pk_bf16_f32 v213, v206, v207
    ds_write_b64 v8, v[212:213] offset:3072
    v_pk_fma_f32 v[196:197], v[22:23], v[60:61], v[196:197] op_sel:[0,0,0] op_sel_hi:[1,0,1] neg_lo:[0,1,0] neg_hi:[0,1,0]
    v_pk_fma_f32 v[198:199], v[24:25], v[60:61], v[198:199] op_sel:[0,0,0] op_sel_hi:[1,0,1] neg_lo:[0,1,0] neg_hi:[0,1,0]
    v_pk_mul_f32 v[196:197], v[196:197], v[26:27]
    v_pk_mul_f32 v[198:199], v[198:199], v[28:29]
    v_cvt_pk_bf16_f32 v216, v196, v197
    v_cvt_pk_bf16_f32 v217, v198, v199
    v_pk_fma_f32 v[200:201], v[30:31], v[60:61], v[200:201] op_sel:[0,0,0] op_sel_hi:[1,0,1] neg_lo:[0,1,0] neg_hi:[0,1,0]
    v_pk_fma_f32 v[202:203], v[32:33], v[60:61], v[202:203] op_sel:[0,0,0] op_sel_hi:[1,0,1] neg_lo:[0,1,0] neg_hi:[0,1,0]
    buffer_load_dwordx4 a[12:15], v3, s[40:43], s86 offen offset:3072 sc1
    v_pk_mul_f32 v[200:201], v[200:201], v[34:35]
    v_pk_mul_f32 v[202:203], v[202:203], v[36:37]
    v_cvt_pk_bf16_f32 v214, v200, v201
    v_cvt_pk_bf16_f32 v215, v202, v203
    ds_read_b128 v[196:199], v5 offset:320
    s_waitcnt lgkmcnt(8)
    s_nop 0
    v_pk_fma_f32 v[192:193], v[244:245], v[48:49], v[192:193] op_sel:[0,0,0] op_sel_hi:[1,0,1] neg_lo:[0,1,0] neg_hi:[0,1,0]
    v_pk_fma_f32 v[194:195], v[246:247], v[48:49], v[194:195] op_sel:[0,0,0] op_sel_hi:[1,0,1] neg_lo:[0,1,0] neg_hi:[0,1,0]
    v_pk_mul_f32 v[192:193], v[192:193], v[52:53] op_sel:[0,0] op_sel_hi:[1,0]
    v_pk_mul_f32 v[194:195], v[194:195], v[52:53] op_sel:[0,0] op_sel_hi:[1,0]
    v_cvt_pk_bf16_f32 v24, v192, v193
    v_cvt_pk_bf16_f32 v25, v194, v195
    buffer_load_dwordx4 a[16:19], v4, s[40:43], s86 offen sc1
    v_cvt_pk_bf16_f32 v30, v192, v193
    v_cvt_pk_bf16_f32 v31, v194, v195
    v_pk_fma_f32 v[188:189], v[244:245], v[46:47], v[188:189] op_sel:[0,1,0] op_sel_hi:[1,1,1] neg_lo:[0,1,0] neg_hi:[0,1,0]
    v_pk_fma_f32 v[190:191], v[246:247], v[46:47], v[190:191] op_sel:[0,1,0] op_sel_hi:[1,1,1] neg_lo:[0,1,0] neg_hi:[0,1,0]
    v_pk_mul_f32 v[188:189], v[188:189], v[50:51] op_sel:[0,1] op_sel_hi:[1,1]
    v_pk_mul_f32 v[190:191], v[190:191], v[50:51] op_sel:[0,1] op_sel_hi:[1,1]
    v_cvt_pk_bf16_f32 v62, v188, v189
    v_cvt_pk_bf16_f32 v63, v190, v191
    v_cvt_pk_bf16_f32 v202, v188, v189
    v_cvt_pk_bf16_f32 v203, v190, v191
    s_add_u32 s86, s87, 46080
    buffer_load_dwordx4 a[20:23], v3, s[40:43], s86 offen sc1
    v_pk_fma_f32 v[184:185], v[244:245], v[46:47], v[184:185] op_sel:[0,0,0] op_sel_hi:[1,0,1] neg_lo:[0,1,0] neg_hi:[0,1,0]
    v_pk_fma_f32 v[186:187], v[246:247], v[46:47], v[186:187] op_sel:[0,0,0] op_sel_hi:[1,0,1] neg_lo:[0,1,0] neg_hi:[0,1,0]
    v_pk_mul_f32 v[184:185], v[184:185], v[50:51] op_sel:[0,0] op_sel_hi:[1,0]
    v_pk_mul_f32 v[186:187], v[186:187], v[50:51] op_sel:[0,0] op_sel_hi:[1,0]
    v_cvt_pk_bf16_f32 v36, v184, v185
    v_cvt_pk_bf16_f32 v37, v186, v187
    v_cvt_pk_bf16_f32 v42, v184, v185
    v_cvt_pk_bf16_f32 v43, v186, v187
    ds_read_b128 v[244:247], v5 offset:256
    s_waitcnt lgkmcnt(7)
    s_nop 0
    v_pk_fma_f32 v[180:181], v[232:233], v[48:49], v[180:181] op_sel:[0,0,0] op_sel_hi:[1,0,1] neg_lo:[0,1,0] neg_hi:[0,1,0]
    v_pk_fma_f32 v[182:183], v[234:235], v[48:49], v[182:183] op_sel:[0,0,0] op_sel_hi:[1,0,1] neg_lo:[0,1,0] neg_hi:[0,1,0]
    buffer_load_dwordx4 a[24:27], v3, s[40:43], s86 offen offset:1024 sc1
    v_pk_mul_f32 v[180:181], v[180:181], v[52:53] op_sel:[0,0] op_sel_hi:[1,0]
    v_pk_mul_f32 v[182:183], v[182:183], v[52:53] op_sel:[0,0] op_sel_hi:[1,0]
    v_cvt_pk_bf16_f32 v32, v180, v181
    v_cvt_pk_bf16_f32 v33, v182, v183
    ds_write_b128 v7, v[30:33] offset:2048
    v_pk_fma_f32 v[176:177], v[232:233], v[46:47], v[176:177] op_sel:[0,1,0] op_sel_hi:[1,1,1] neg_lo:[0,1,0] neg_hi:[0,1,0]
    v_pk_fma_f32 v[178:179], v[234:235], v[46:47], v[178:179] op_sel:[0,1,0] op_sel_hi:[1,1,1] neg_lo:[0,1,0] neg_hi:[0,1,0]
    v_pk_mul_f32 v[176:177], v[176:177], v[50:51] op_sel:[0,1] op_sel_hi:[1,1]
    v_pk_mul_f32 v[178:179], v[178:179], v[50:51] op_sel:[0,1] op_sel_hi:[1,1]
    v_cvt_pk_bf16_f32 v204, v176, v177
    v_cvt_pk_bf16_f32 v205, v178, v179
    buffer_load_dwordx4 a[28:31], v3, s[40:43], s86 offen offset:2048 sc1
    v_pk_fma_f32 v[172:173], v[232:233], v[46:47], v[172:173] op_sel:[0,0,0] op_sel_hi:[1,0,1] neg_lo:[0,1,0] neg_hi:[0,1,0]
    v_pk_fma_f32 v[174:175], v[234:235], v[46:47], v[174:175] op_sel:[0,0,0] op_sel_hi:[1,0,1] neg_lo:[0,1,0] neg_hi:[0,1,0]
    v_pk_mul_f32 v[172:173], v[172:173], v[50:51] op_sel:[0,0] op_sel_hi:[1,0]
    v_pk_mul_f32 v[174:175], v[174:175], v[50:51] op_sel:[0,0] op_sel_hi:[1,0]
    v_cvt_pk_bf16_f32 v44, v172, v173
    v_cvt_pk_bf16_f32 v45, v174, v175
    ds_read_b128 v[232:235], v5 offset:192
    s_waitcnt lgkmcnt(7)
    s_nop 0
    v_pk_fma_f32 v[168:169], v[220:221], v[48:49], v[168:169] op_sel:[0,0,0] op_sel_hi:[1,0,1] neg_lo:[0,1,0] neg_hi:[0,1,0]
    v_pk_fma_f32 v[170:171], v[222:223], v[48:49], v[170:171] op_sel:[0,0,0] op_sel_hi:[1,0,1] neg_lo:[0,1,0] neg_hi:[0,1,0]
    v_pk_mul_f32 v[168:169], v[168:169], v[52:53] op_sel:[0,0] op_sel_hi:[1,0]
    v_pk_mul_f32 v[170:171], v[170:171], v[52:53] op_sel:[0,0] op_sel_hi:[1,0]
    buffer_load_dwordx4 a[32:35], v3, s[40:43], s86 offen offset:3072 sc1
    v_cvt_pk_bf16_f32 v28, v168, v169
    v_cvt_pk_bf16_f32 v29, v170, v171
    v_pk_fma_f32 v[164:165], v[220:221], v[46:47], v[164:165] op_sel:[0,1,0] op_sel_hi:[1,1,1] neg_lo:[0,1,0] neg_hi:[0,1,0]
    v_pk_fma_f32 v[166:167], v[222:223], v[46:47], v[166:167] op_sel:[0,1,0] op_sel_hi:[1,1,1] neg_lo:[0,1,0] neg_hi:[0,1,0]
    v_pk_mul_f32 v[164:165], v[164:165], v[50:51] op_sel:[0,1] op_sel_hi:[1,1]
    v_pk_mul_f32 v[166:167], v[166:167], v[50:51] op_sel:[0,1] op_sel_hi:[1,1]
    v_cvt_pk_bf16_f32 v200, v164, v165
    v_cvt_pk_bf16_f32 v201, v166, v167
    v_pk_fma_f32 v[160:161], v[220:221], v[46:47], v[160:161] op_sel:[0,0,0] op_sel_hi:[1,0,1] neg_lo:[0,1,0] neg_hi:[0,1,0]
    v_pk_fma_f32 v[162:163], v[222:223], v[46:47], v[162:163] op_sel:[0,0,0] op_sel_hi:[1,0,1] neg_lo:[0,1,0] neg_hi:[0,1,0]
    buffer_load_dwordx4 a[36:39], v4, s[40:43], s86 offen sc1
    v_pk_mul_f32 v[160:161], v[160:161], v[50:51] op_sel:[0,0] op_sel_hi:[1,0]
    v_pk_mul_f32 v[162:163], v[162:163], v[50:51] op_sel:[0,0] op_sel_hi:[1,0]
    v_cvt_pk_bf16_f32 v40, v160, v161
    v_cvt_pk_bf16_f32 v41, v162, v163
    ds_read_b128 v[220:223], v5 offset:128
    s_waitcnt lgkmcnt(6)
    s_nop 0
    v_pk_fma_f32 v[156:157], v[208:209], v[48:49], v[156:157] op_sel:[0,0,0] op_sel_hi:[1,0,1] neg_lo:[0,1,0] neg_hi:[0,1,0]
    v_pk_fma_f32 v[158:159], v[210:211], v[48:49], v[158:159] op_sel:[0,0,0] op_sel_hi:[1,0,1] neg_lo:[0,1,0] neg_hi:[0,1,0]
    v_pk_mul_f32 v[156:157], v[156:157], v[52:53] op_sel:[0,0] op_sel_hi:[1,0]
    v_pk_mul_f32 v[158:159], v[158:159], v[52:53] op_sel:[0,0] op_sel_hi:[1,0]
    v_cvt_pk_bf16_f32 v26, v156, v157
    v_cvt_pk_bf16_f32 v27, v158, v159
    s_add_u32 s86, s87, 51200
    buffer_load_dwordx4 a[40:43], v3, s[40:43], s86 offen sc1
    ds_write_b128 v7, v[26:29] offset:1024
    v_pk_fma_f32 v[152:153], v[208:209], v[46:47], v[152:153] op_sel:[0,1,0] op_sel_hi:[1,1,1] neg_lo:[0,1,0] neg_hi:[0,1,0]
    v_pk_fma_f32 v[154:155], v[210:211], v[46:47], v[154:155] op_sel:[0,1,0] op_sel_hi:[1,1,1] neg_lo:[0,1,0] neg_hi:[0,1,0]
    v_pk_mul_f32 v[152:153], v[152:153], v[50:51] op_sel:[0,1] op_sel_hi:[1,1]
    v_pk_mul_f32 v[154:155], v[154:155], v[50:51] op_sel:[0,1] op_sel_hi:[1,1]
    v_cvt_pk_bf16_f32 v64, v152, v153
    v_cvt_pk_bf16_f32 v65, v154, v155
    v_pk_fma_f32 v[148:149], v[208:209], v[46:47], v[148:149] op_sel:[0,0,0] op_sel_hi:[1,0,1] neg_lo:[0,1,0] neg_hi:[0,1,0]
    v_pk_fma_f32 v[150:151], v[210:211], v[46:47], v[150:151] op_sel:[0,0,0] op_sel_hi:[1,0,1] neg_lo:[0,1,0] neg_hi:[0,1,0]
    v_pk_mul_f32 v[148:149], v[148:149], v[50:51] op_sel:[0,0] op_sel_hi:[1,0]
    v_pk_mul_f32 v[150:151], v[150:151], v[50:51] op_sel:[0,0] op_sel_hi:[1,0]
    buffer_load_dwordx4 a[44:47], v3, s[40:43], s86 offen offset:1024 sc1
    v_cvt_pk_bf16_f32 v38, v148, v149
    v_cvt_pk_bf16_f32 v39, v150, v151
    ds_read_b128 v[208:211], v5 offset:64
    s_waitcnt lgkmcnt(6)
    s_nop 0
    v_pk_fma_f32 v[144:145], v[196:197], v[48:49], v[144:145] op_sel:[0,0,0] op_sel_hi:[1,0,1] neg_lo:[0,1,0] neg_hi:[0,1,0]
    v_pk_fma_f32 v[146:147], v[198:199], v[48:49], v[146:147] op_sel:[0,0,0] op_sel_hi:[1,0,1] neg_lo:[0,1,0] neg_hi:[0,1,0]
    v_pk_mul_f32 v[144:145], v[144:145], v[52:53] op_sel:[0,0] op_sel_hi:[1,0]
    v_pk_mul_f32 v[146:147], v[146:147], v[52:53] op_sel:[0,0] op_sel_hi:[1,0]
    v_cvt_pk_bf16_f32 v22, v144, v145
    v_cvt_pk_bf16_f32 v23, v146, v147
    ds_write_b128 v7, v[22:25] offset:0
    v_pk_fma_f32 v[140:141], v[196:197], v[46:47], v[140:141] op_sel:[0,1,0] op_sel_hi:[1,1,1] neg_lo:[0,1,0] neg_hi:[0,1,0]
    v_pk_fma_f32 v[142:143], v[198:199], v[46:47], v[142:143] op_sel:[0,1,0] op_sel_hi:[1,1,1] neg_lo:[0,1,0] neg_hi:[0,1,0]
    buffer_load_dwordx4 a[48:51], v3, s[40:43], s86 offen offset:2048 sc1
    v_pk_mul_f32 v[140:141], v[140:141], v[50:51] op_sel:[0,1] op_sel_hi:[1,1]
    v_pk_mul_f32 v[142:143], v[142:143], v[50:51] op_sel:[0,1] op_sel_hi:[1,1]
    v_cvt_pk_bf16_f32 v60, v140, v141
    v_cvt_pk_bf16_f32 v61, v142, v143
    v_pk_fma_f32 v[136:137], v[196:197], v[46:47], v[136:137] op_sel:[0,0,0] op_sel_hi:[1,0,1] neg_lo:[0,1,0] neg_hi:[0,1,0]
    v_pk_fma_f32 v[138:139], v[198:199], v[46:47], v[138:139] op_sel:[0,0,0] op_sel_hi:[1,0,1] neg_lo:[0,1,0] neg_hi:[0,1,0]
    v_pk_mul_f32 v[136:137], v[136:137], v[50:51] op_sel:[0,0] op_sel_hi:[1,0]
    v_pk_mul_f32 v[138:139], v[138:139], v[50:51] op_sel:[0,0] op_sel_hi:[1,0]
    v_cvt_pk_bf16_f32 v34, v136, v137
    v_cvt_pk_bf16_f32 v35, v138, v139
    buffer_load_dwordx4 a[52:55], v3, s[40:43], s86 offen offset:3072 sc1
    ds_read_b128 v[196:199], v5 offset:0
    s_waitcnt lgkmcnt(7)
    v_pk_fma_f32 v[132:133], v[244:245], v[48:49], v[132:133] op_sel:[0,0,0] op_sel_hi:[1,0,1] neg_lo:[0,1,0] neg_hi:[0,1,0]
    v_pk_fma_f32 v[134:135], v[246:247], v[48:49], v[134:135] op_sel:[0,0,0] op_sel_hi:[1,0,1] neg_lo:[0,1,0] neg_hi:[0,1,0]
    v_pk_fma_f32 v[128:129], v[244:245], v[46:47], v[128:129] op_sel:[0,1,0] op_sel_hi:[1,1,1] neg_lo:[0,1,0] neg_hi:[0,1,0]
    v_pk_fma_f32 v[130:131], v[246:247], v[46:47], v[130:131] op_sel:[0,1,0] op_sel_hi:[1,1,1] neg_lo:[0,1,0] neg_hi:[0,1,0]
    v_pk_fma_f32 v[124:125], v[244:245], v[46:47], v[124:125] op_sel:[0,0,0] op_sel_hi:[1,0,1] neg_lo:[0,1,0] neg_hi:[0,1,0]
    v_pk_fma_f32 v[126:127], v[246:247], v[46:47], v[126:127] op_sel:[0,0,0] op_sel_hi:[1,0,1] neg_lo:[0,1,0] neg_hi:[0,1,0]
    s_waitcnt lgkmcnt(5)
    v_pk_fma_f32 v[120:121], v[232:233], v[48:49], v[120:121] op_sel:[0,0,0] op_sel_hi:[1,0,1] neg_lo:[0,1,0] neg_hi:[0,1,0]
    v_pk_fma_f32 v[122:123], v[234:235], v[48:49], v[122:123] op_sel:[0,0,0] op_sel_hi:[1,0,1] neg_lo:[0,1,0] neg_hi:[0,1,0]
    v_pk_fma_f32 v[116:117], v[232:233], v[46:47], v[116:117] op_sel:[0,1,0] op_sel_hi:[1,1,1] neg_lo:[0,1,0] neg_hi:[0,1,0]
    v_pk_fma_f32 v[118:119], v[234:235], v[46:47], v[118:119] op_sel:[0,1,0] op_sel_hi:[1,1,1] neg_lo:[0,1,0] neg_hi:[0,1,0]
    buffer_load_dwordx4 a[56:59], v4, s[40:43], s86 offen sc1
    v_pk_fma_f32 v[112:113], v[232:233], v[46:47], v[112:113] op_sel:[0,0,0] op_sel_hi:[1,0,1] neg_lo:[0,1,0] neg_hi:[0,1,0]
    v_pk_fma_f32 v[114:115], v[234:235], v[46:47], v[114:115] op_sel:[0,0,0] op_sel_hi:[1,0,1] neg_lo:[0,1,0] neg_hi:[0,1,0]
    s_waitcnt lgkmcnt(4)
    v_pk_fma_f32 v[108:109], v[220:221], v[48:49], v[108:109] op_sel:[0,0,0] op_sel_hi:[1,0,1] neg_lo:[0,1,0] neg_hi:[0,1,0]
    v_pk_fma_f32 v[110:111], v[222:223], v[48:49], v[110:111] op_sel:[0,0,0] op_sel_hi:[1,0,1] neg_lo:[0,1,0] neg_hi:[0,1,0]
    v_pk_fma_f32 v[104:105], v[220:221], v[46:47], v[104:105] op_sel:[0,1,0] op_sel_hi:[1,1,1] neg_lo:[0,1,0] neg_hi:[0,1,0]
    v_pk_fma_f32 v[106:107], v[222:223], v[46:47], v[106:107] op_sel:[0,1,0] op_sel_hi:[1,1,1] neg_lo:[0,1,0] neg_hi:[0,1,0]
    v_pk_fma_f32 v[100:101], v[220:221], v[46:47], v[100:101] op_sel:[0,0,0] op_sel_hi:[1,0,1] neg_lo:[0,1,0] neg_hi:[0,1,0]
    v_pk_fma_f32 v[102:103], v[222:223], v[46:47], v[102:103] op_sel:[0,0,0] op_sel_hi:[1,0,1] neg_lo:[0,1,0] neg_hi:[0,1,0]
    s_waitcnt lgkmcnt(2)
    v_pk_fma_f32 v[96:97], v[208:209], v[48:49], v[96:97] op_sel:[0,0,0] op_sel_hi:[1,0,1] neg_lo:[0,1,0] neg_hi:[0,1,0]
    v_pk_fma_f32 v[98:99], v[210:211], v[48:49], v[98:99] op_sel:[0,0,0] op_sel_hi:[1,0,1] neg_lo:[0,1,0] neg_hi:[0,1,0]
    s_add_u32 s86, s87, 56320
    buffer_load_dwordx4 a[60:63], v3, s[40:43], s86 offen sc1
    v_pk_fma_f32 v[92:93], v[208:209], v[46:47], v[92:93] op_sel:[0,1,0] op_sel_hi:[1,1,1] neg_lo:[0,1,0] neg_hi:[0,1,0]
    v_pk_fma_f32 v[94:95], v[210:211], v[46:47], v[94:95] op_sel:[0,1,0] op_sel_hi:[1,1,1] neg_lo:[0,1,0] neg_hi:[0,1,0]
    v_pk_fma_f32 v[88:89], v[208:209], v[46:47], v[88:89] op_sel:[0,0,0] op_sel_hi:[1,0,1] neg_lo:[0,1,0] neg_hi:[0,1,0]
    v_pk_fma_f32 v[90:91], v[210:211], v[46:47], v[90:91] op_sel:[0,0,0] op_sel_hi:[1,0,1] neg_lo:[0,1,0] neg_hi:[0,1,0]
    s_waitcnt lgkmcnt(0)
    v_pk_fma_f32 v[84:85], v[196:197], v[48:49], v[84:85] op_sel:[0,0,0] op_sel_hi:[1,0,1] neg_lo:[0,1,0] neg_hi:[0,1,0]
    v_pk_fma_f32 v[86:87], v[198:199], v[48:49], v[86:87] op_sel:[0,0,0] op_sel_hi:[1,0,1] neg_lo:[0,1,0] neg_hi:[0,1,0]
    v_pk_fma_f32 v[80:81], v[196:197], v[46:47], v[80:81] op_sel:[0,1,0] op_sel_hi:[1,1,1] neg_lo:[0,1,0] neg_hi:[0,1,0]
    v_pk_fma_f32 v[82:83], v[198:199], v[46:47], v[82:83] op_sel:[0,1,0] op_sel_hi:[1,1,1] neg_lo:[0,1,0] neg_hi:[0,1,0]
    v_pk_fma_f32 v[76:77], v[196:197], v[46:47], v[76:77] op_sel:[0,0,0] op_sel_hi:[1,0,1] neg_lo:[0,1,0] neg_hi:[0,1,0]
    v_pk_fma_f32 v[78:79], v[198:199], v[46:47], v[78:79] op_sel:[0,0,0] op_sel_hi:[1,0,1] neg_lo:[0,1,0] neg_hi:[0,1,0]
    buffer_load_dwordx4 a[64:67], v3, s[40:43], s86 offen offset:1024 sc1
    s_barrier
    ds_read_b128 v[136:139], v9 offset:0
    ds_read_b128 v[140:143], v9 offset:1024
    ds_read_b128 v[144:147], v9 offset:2048
    ds_read_b64 v[218:219], v10 offset:3072
    ds_read_b64 v[230:231], v10 offset:3584
    ds_read_b64 v[242:243], v10 offset:4096
    ds_read_b64 v[254:255], v10 offset:4608
    ds_read_b64 v[72:73], v10 offset:5120
    s_mov_b64 vcc, s[74:75]
    s_nop 0
    v_cvt_pk_bf16_f32 v132, v132, v133
    v_cvt_pk_bf16_f32 v133, v134, v135
    v_cndmask_b32 v150, 0, v132, s[4:5]
    v_cndmask_b32 v151, 0, v133, s[4:5]
    v_cvt_pk_bf16_f32 v148, v84, v85
    v_cvt_pk_bf16_f32 v149, v86, v87
    v_cndmask_b32 v152, 0, v132, s[6:7]
    v_cndmask_b32 v153, 0, v133, s[6:7]
    v_cvt_pk_bf16_f32 v154, v96, v97
    v_cvt_pk_bf16_f32 v155, v98, v99
    buffer_load_dwordx4 a[68:71], v3, s[40:43], s86 offen offset:2048 sc1
    v_cndmask_b32 v158, 0, v132, s[8:9]
    v_cndmask_b32 v159, 0, v133, s[8:9]
    v_cvt_pk_bf16_f32 v156, v108, v109
    v_cvt_pk_bf16_f32 v157, v110, v111
    v_cndmask_b32 v160, 0, v132, s[10:11]
    v_cndmask_b32 v161, 0, v133, s[10:11]
    v_cvt_pk_bf16_f32 v162, v120, v121
    v_cvt_pk_bf16_f32 v163, v122, v123
    v_cvt_pk_bf16_f32 v128, v128, v129
    v_cvt_pk_bf16_f32 v129, v130, v131
    buffer_load_dwordx4 a[72:75], v3, s[40:43], s86 offen offset:3072 sc1
    v_mfma_f32_16x16x32_bf16 v[84:87], v[22:25], v[148:151], 0
    v_cndmask_b32 v178, 0, v128, s[4:5]
    v_cndmask_b32 v179, 0, v129, s[4:5]
    v_mfma_f32_16x16x32_bf16 v[96:99], v[60:63], v[148:151], 0
    v_cvt_pk_bf16_f32 v176, v80, v81
    v_cvt_pk_bf16_f32 v177, v82, v83
    v_mfma_f32_16x16x32_bf16 v[108:111], v[24:27], v[152:155], 0
    v_cndmask_b32 v180, 0, v128, s[6:7]
    v_cndmask_b32 v181, 0, v129, s[6:7]
    v_mfma_f32_16x16x32_bf16 v[120:123], v[62:65], v[152:155], 0
    v_cvt_pk_bf16_f32 v182, v92, v93
    v_cvt_pk_bf16_f32 v183, v94, v95
    v_mfma_f32_16x16x32_bf16 v[132:135], v[28:31], v[156:159], 0
    v_cndmask_b32 v186, 0, v128, s[8:9]
    v_cndmask_b32 v187, 0, v129, s[8:9]
    buffer_load_dwordx4 a[76:79], v4, s[40:43], s86 offen sc1
    v_mfma_f32_16x16x32_bf16 v[164:167], v[200:203], v[156:159], 0
    v_cvt_pk_bf16_f32 v184, v104, v105
    v_cvt_pk_bf16_f32 v185, v106, v107
    v_mfma_f32_16x16x32_bf16 v[168:171], v[30:33], v[160:163], 0
    v_cndmask_b32 v188, 0, v128, s[10:11]
    v_cndmask_b32 v189, 0, v129, s[10:11]
    v_mfma_f32_16x16x32_bf16 v[172:175], v[202:205], v[160:163], 0
    v_cvt_pk_bf16_f32 v190, v116, v117
    v_cvt_pk_bf16_f32 v191, v118, v119
    v_cvt_pk_bf16_f32 v124, v124, v125
    v_cvt_pk_bf16_f32 v125, v126, v127
    v_mfma_f32_16x16x32_bf16 v[22:25], v[60:63], v[176:179], 0
    v_cndmask_b32 v150, 0, v124, s[4:5]
    v_cndmask_b32 v151, 0, v125, s[4:5]
    s_add_u32 m0, s67, 86016
    s_add_u32 s86, s88, 24576
    buffer_load_dwordx4 v3, s[40:43], s86 offen sc1 lds
    v_mfma_f32_16x16x32_bf16 v[26:29], v[34:37], v[176:179], v[12:15]
    v_cvt_pk_bf16_f32 v148, v76, v77
    v_cvt_pk_bf16_f32 v149, v78, v79
    v_mfma_f32_16x16x32_bf16 v[30:33], v[62:65], v[180:183], 0
    v_cndmask_b32 v152, 0, v124, s[6:7]
    v_cndmask_b32 v153, 0, v125, s[6:7]
    v_mfma_f32_16x16x32_bf16 v[80:83], v[36:39], v[180:183], v[12:15]
    v_cvt_pk_bf16_f32 v154, v88, v89
    v_cvt_pk_bf16_f32 v155, v90, v91
    v_mfma_f32_16x16x32_bf16 v[92:95], v[200:203], v[184:187], 0
    v_cndmask_b32 v158, 0, v124, s[8:9]
    v_cndmask_b32 v159, 0, v125, s[8:9]
    v_mfma_f32_16x16x32_bf16 v[104:107], v[40:43], v[184:187], v[12:15]
    v_cvt_pk_bf16_f32 v156, v100, v101
    v_cvt_pk_bf16_f32 v157, v102, v103
    s_add_u32 m0, s67, 90112
    s_add_u32 s86, s88, 28672
    buffer_load_dwordx4 v3, s[40:43], s86 offen sc1 lds
    v_mfma_f32_16x16x32_bf16 v[116:119], v[202:205], v[188:191], 0
    v_cndmask_b32 v160, 0, v124, s[10:11]
    v_cndmask_b32 v161, 0, v125, s[10:11]
    v_mfma_f32_16x16x32_bf16 v[128:131], v[42:45], v[188:191], v[12:15]
    v_cvt_pk_bf16_f32 v162, v112, v113
    v_cvt_pk_bf16_f32 v163, v114, v115
    v_cndmask_b32 v84, v84, v85, vcc
    v_cndmask_b32 v96, v96, v97, vcc
    v_mfma_f32_16x16x32_bf16 v[60:63], v[34:37], v[148:151], 0
    v_cndmask_b32 v86, v86, v87, vcc
    v_cndmask_b32 v98, v98, v99, vcc
L_pg10:
    s_cbranch_execz L_ret
    s_waitcnt lgkmcnt(0)
    v_mfma_f32_16x16x32_bf16 v[74:77], v[136:139], v[148:151], 0
    v_cndmask_b32 v184, v96, v84, s[76:77]
    v_cndmask_b32 v185, v98, v86, s[78:79]
    s_add_u32 m0, s67, 94208
    s_add_u32 s86, s88, 32768
    buffer_load_dwordx4 v3, s[40:43], s86 offen sc1 lds
    v_mfma_f32_16x16x32_bf16 v[88:91], v[36:39], v[152:155], 0
    v_cndmask_b32 v108, v108, v109, vcc
    v_cndmask_b32 v120, v120, v121, vcc
    v_mfma_f32_16x16x32_bf16 v[100:103], v[138:141], v[152:155], 0
    v_cndmask_b32 v110, v110, v111, vcc
    v_cndmask_b32 v122, v122, v123, vcc
    v_mfma_f32_16x16x32_bf16 v[112:115], v[40:43], v[156:159], 0
    v_cndmask_b32 v186, v120, v108, s[76:77]
    v_cndmask_b32 v187, v122, v110, s[78:79]
    v_mfma_f32_16x16x32_bf16 v[124:127], v[142:145], v[156:159], 0
    v_cndmask_b32 v132, v132, v133, vcc
    v_cndmask_b32 v164, v164, v165, vcc
    v_mfma_f32_16x16x32_bf16 v[176:179], v[42:45], v[160:163], 0
    v_cndmask_b32 v134, v134, v135, vcc
    v_cndmask_b32 v166, v166, v167, vcc
    s_add_u32 m0, s67, 98304
    s_add_u32 s86, s88, 36864
    buffer_load_dwordx4 v3, s[40:43], s86 offen sc1 lds
    v_mfma_f32_16x16x32_bf16 v[180:183], v[144:147], v[160:163], 0
    v_cndmask_b32 v188, v164, v132, s[76:77]
    v_cndmask_b32 v189, v166, v134, s[78:79]
    v_cndmask_b32 v168, v168, v169, vcc
    v_cndmask_b32 v172, v172, v173, vcc
    v_cndmask_b32 v170, v170, v171, vcc
    v_cndmask_b32 v174, v174, v175, vcc
    v_cndmask_b32 v190, v172, v168, s[76:77]
    v_cndmask_b32 v191, v174, v170, s[78:79]
    v_cndmask_b32 v22, v22, v23, vcc
    v_cndmask_b32 v26, v26, v27, vcc
    s_add_u32 m0, s67, 102400
    s_add_u32 s86, s88, 40960
    buffer_load_dwordx4 v3, s[40:43], s86 offen sc1 lds
    v_cndmask_b32 v24, v24, v25, vcc
    v_cndmask_b32 v28, v28, v29, vcc
    v_cndmask_b32 v164, v26, v22, s[76:77]
    v_cndmask_b32 v165, v28, v24, s[78:79]
    v_cndmask_b32 v30, v30, v31, vcc
    v_cndmask_b32 v80, v80, v81, vcc
    v_cndmask_b32 v32, v32, v33, vcc
    v_cndmask_b32 v82, v82, v83, vcc
    v_cndmask_b32 v166, v80, v30, s[76:77]
    v_cndmask_b32 v167, v82, v32, s[78:79]
    s_add_u32 m0, s67, 106496
    s_add_u32 s86, s88, 45056
    buffer_load_dwordx4 v3, s[40:43], s86 offen sc1 lds
    v_cndmask_b32 v92, v92, v93, vcc
    v_cndmask_b32 v104, v104, v105, vcc
    v_cndmask_b32 v94, v94, v95, vcc
    v_cndmask_b32 v106, v106, v107, vcc
    v_cndmask_b32 v168, v104, v92, s[76:77]
    v_cndmask_b32 v169, v106, v94, s[78:79]
    v_cndmask_b32 v116, v116, v117, vcc
    v_cndmask_b32 v128, v128, v129, vcc
    v_cndmask_b32 v118, v118, v119, vcc
    v_cndmask_b32 v130, v130, v131, vcc
    s_add_u32 m0, s67, 110592
    s_add_u32 s86, s88, 49152
    buffer_load_dwordx4 v3, s[40:43], s86 offen sc1 lds
    v_cndmask_b32 v170, v128, v116, s[76:77]
    v_cndmask_b32 v171, v130, v118, s[78:79]
    v_cndmask_b32 v60, v60, v61, vcc
    v_cndmask_b32 v74, v74, v75, vcc
    v_cndmask_b32 v62, v62, v63, vcc
    v_cndmask_b32 v76, v76, v77, vcc
    v_cndmask_b32 v22, v74, v60, s[76:77]
    v_cndmask_b32 v23, v76, v62, s[78:79]
    v_cndmask_b32 v88, v88, v89, vcc
    v_cndmask_b32 v100, v100, v101, vcc
    s_add_u32 m0, s67, 114688
    s_add_u32 s86, s88, 53248
    buffer_load_dwordx4 v3, s[40:43], s86 offen sc1 lds
    v_cndmask_b32 v90, v90, v91, vcc
    v_cndmask_b32 v102, v102, v103, vcc
    v_cndmask_b32 v24, v100, v88, s[76:77]
    v_cndmask_b32 v25, v102, v90, s[78:79]
    v_cndmask_b32 v112, v112, v113, vcc
    v_cndmask_b32 v124, v124, v125, vcc
    v_cndmask_b32 v114, v114, v115, vcc
    v_cndmask_b32 v126, v126, v127, vcc
    v_cndmask_b32 v26, v124, v112, s[76:77]
    v_cndmask_b32 v27, v126, v114, s[78:79]
    s_add_u32 m0, s67, 118784
    s_add_u32 s86, s88, 57344
    buffer_load_dwordx4 v3, s[40:43], s86 offen sc1 lds
    v_cndmask_b32 v176, v176, v177, vcc
    v_cndmask_b32 v180, v180, v181, vcc
    v_cndmask_b32 v178, v178, v179, vcc
    v_cndmask_b32 v182, v182, v183, vcc
    v_cndmask_b32 v28, v180, v176, s[76:77]
    v_cndmask_b32 v29, v182, v178, s[78:79]
    v_mul_f32 v30, 0x3ea52b5c, v52
    v_permlane32_swap_b32 v184, v188
    v_permlane32_swap_b32 v186, v190
    v_permlane32_swap_b32 v185, v189
    s_add_u32 m0, s67, 122880
    s_add_u32 s86, s88, 61440
    buffer_load_dwordx4 v3, s[40:43], s86 offen sc1 lds
    v_permlane32_swap_b32 v187, v191
    v_permlane16_swap_b32 v184, v186
    v_permlane16_swap_b32 v188, v190
    v_permlane16_swap_b32 v185, v187
    v_permlane16_swap_b32 v189, v191
    v_mul_f32 v32, 0x3ea52b5c, v51
    v_permlane32_swap_b32 v164, v168
    v_permlane32_swap_b32 v166, v170
    v_permlane32_swap_b32 v165, v169
    v_permlane32_swap_b32 v167, v171
    s_add_u32 m0, s67, 126976
    s_add_u32 s86, s88, 65536
    buffer_load_dwordx4 v3, s[40:43], s86 offen sc1 lds
    v_permlane16_swap_b32 v164, v166
    v_permlane16_swap_b32 v168, v170
    v_permlane16_swap_b32 v165, v167
    v_permlane16_swap_b32 v169, v171
    v_mul_f32 v34, 0x3ea52b5c, v50
    v_permlane32_swap_b32 v22, v26
    v_permlane32_swap_b32 v24, v28
    v_permlane32_swap_b32 v23, v27
    v_permlane32_swap_b32 v25, v29
    v_permlane16_swap_b32 v22, v24
    s_add_u32 m0, s67, 131072
    s_add_u32 s86, s88, 69632
    buffer_load_dwordx4 v3, s[40:43], s86 offen sc1 lds
    v_permlane16_swap_b32 v26, v28
    v_permlane16_swap_b32 v23, v25
    v_permlane16_swap_b32 v27, v29
    v_max3_f32 v31, v184, v185, v186
    v_max3_f32 v31, v31, v187, v188
    v_max3_f32 v31, v31, v189, v190
    v_max_f32 v31, v31, v191
    v_mul_f32 v31, v31, v30
    v_pk_fma_f32 v[184:185], v[184:185], v[30:31], v[30:31] op_sel:[0,0,1] op_sel_hi:[1,0,1] neg_lo:[0,0,1] neg_hi:[0,0,1]
    v_pk_fma_f32 v[186:187], v[186:187], v[30:31], v[30:31] op_sel:[0,0,1] op_sel_hi:[1,0,1] neg_lo:[0,0,1] neg_hi:[0,0,1]
    s_add_u32 m0, s67, 135168
    s_add_u32 s86, s88, 73728
    buffer_load_dwordx4 v3, s[40:43], s86 offen sc1 lds
    v_pk_fma_f32 v[188:189], v[188:189], v[30:31], v[30:31] op_sel:[0,0,1] op_sel_hi:[1,0,1] neg_lo:[0,0,1] neg_hi:[0,0,1]
    v_pk_fma_f32 v[190:191], v[190:191], v[30:31], v[30:31] op_sel:[0,0,1] op_sel_hi:[1,0,1] neg_lo:[0,0,1] neg_hi:[0,0,1]
    v_exp_f32 v184, v184
    v_exp_f32 v185, v185
    v_exp_f32 v186, v186
    v_exp_f32 v187, v187
    v_exp_f32 v188, v188
    v_exp_f32 v189, v189
    v_exp_f32 v190, v190
    v_exp_f32 v191, v191
    s_add_u32 m0, s67, 139264
    s_add_u32 s86, s88, 77824
    buffer_load_dwordx4 v3, s[40:43], s86 offen sc1 lds
    v_pk_add_f32 v[36:37], v[184:185], v[186:187]
    v_pk_add_f32 v[38:39], v[188:189], v[190:191]
    v_pk_add_f32 v[36:37], v[36:37], v[38:39]
    v_add_f32 v36, v36, v37
    v_rcp_f32 v30, v36
    v_max3_f32 v33, v164, v165, v166
    v_max3_f32 v33, v33, v167, v168
    v_max3_f32 v33, v33, v169, v170
    v_max_f32 v33, v33, v171
    v_mul_f32 v33, v33, v32
    s_add_u32 m0, s67, 143360
    s_add_u32 s86, s88, 81920
    buffer_load_dwordx4 v3, s[40:43], s86 offen sc1 lds
    v_pk_fma_f32 v[164:165], v[164:165], v[32:33], v[32:33] op_sel:[0,0,1] op_sel_hi:[1,0,1] neg_lo:[0,0,1] neg_hi:[0,0,1]
    v_pk_fma_f32 v[166:167], v[166:167], v[32:33], v[32:33] op_sel:[0,0,1] op_sel_hi:[1,0,1] neg_lo:[0,0,1] neg_hi:[0,0,1]
    v_pk_fma_f32 v[168:169], v[168:169], v[32:33], v[32:33] op_sel:[0,0,1] op_sel_hi:[1,0,1] neg_lo:[0,0,1] neg_hi:[0,0,1]
    v_pk_fma_f32 v[170:171], v[170:171], v[32:33], v[32:33] op_sel:[0,0,1] op_sel_hi:[1,0,1] neg_lo:[0,0,1] neg_hi:[0,0,1]
    v_exp_f32 v164, v164
    v_exp_f32 v165, v165
    v_exp_f32 v166, v166
    v_exp_f32 v167, v167
    v_exp_f32 v168, v168
    v_exp_f32 v169, v169
    s_add_u32 m0, s67, 147456
    s_add_u32 s86, s88, 86016
    buffer_load_dwordx4 v3, s[40:43], s86 offen sc1 lds
    v_exp_f32 v170, v170
    v_exp_f32 v171, v171
    v_pk_add_f32 v[40:41], v[164:165], v[166:167]
    v_pk_add_f32 v[42:43], v[168:169], v[170:171]
    v_pk_add_f32 v[40:41], v[40:41], v[42:43]
    v_add_f32 v40, v40, v41
    v_rcp_f32 v32, v40
    v_max3_f32 v35, v22, v23, v24
    v_max3_f32 v35, v35, v25, v26
    v_max3_f32 v35, v35, v27, v28
    s_add_u32 m0, s67, 151552
    s_add_u32 s86, s88, 90112
    buffer_load_dwordx4 v3, s[40:43], s86 offen sc1 lds
    v_max_f32 v35, v35, v29
    v_mul_f32 v35, v35, v34
    v_pk_fma_f32 v[22:23], v[22:23], v[34:35], v[34:35] op_sel:[0,0,1] op_sel_hi:[1,0,1] neg_lo:[0,0,1] neg_hi:[0,0,1]
    v_pk_fma_f32 v[24:25], v[24:25], v[34:35], v[34:35] op_sel:[0,0,1] op_sel_hi:[1,0,1] neg_lo:[0,0,1] neg_hi:[0,0,1]
    v_pk_fma_f32 v[26:27], v[26:27], v[34:35], v[34:35] op_sel:[0,0,1] op_sel_hi:[1,0,1] neg_lo:[0,0,1] neg_hi:[0,0,1]
    v_pk_fma_f32 v[28:29], v[28:29], v[34:35], v[34:35] op_sel:[0,0,1] op_sel_hi:[1,0,1] neg_lo:[0,0,1] neg_hi:[0,0,1]
    v_exp_f32 v22, v22
    v_exp_f32 v23, v23
    v_exp_f32 v24, v24
    v_exp_f32 v25, v25
    s_add_u32 m0, s67, 155648
    s_add_u32 s86, s88, 94208
    buffer_load_dwordx4 v3, s[40:43], s86 offen sc1 lds
    v_exp_f32 v26, v26
    v_exp_f32 v27, v27
    v_exp_f32 v28, v28
    v_exp_f32 v29, v29
    v_pk_add_f32 v[60:61], v[22:23], v[24:25]
    v_pk_add_f32 v[62:63], v[26:27], v[28:29]
    v_pk_add_f32 v[60:61], v[60:61], v[62:63]
    v_add_f32 v60, v60, v61
    v_rcp_f32 v34, v60
    v_pk_mul_f32 v[184:185], v[184:185], v[30:31] op_sel:[0,0] op_sel_hi:[1,0]
    s_add_u32 m0, s67, 159744
    s_add_u32 s86, s88, 98304
    buffer_load_dwordx4 v3, s[40:43], s86 offen sc1 lds
    v_pk_mul_f32 v[186:187], v[186:187], v[30:31] op_sel:[0,0] op_sel_hi:[1,0]
    v_pk_mul_f32 v[188:189], v[188:189], v[30:31] op_sel:[0,0] op_sel_hi:[1,0]
    v_pk_mul_f32 v[190:191], v[190:191], v[30:31] op_sel:[0,0] op_sel_hi:[1,0]
    v_cvt_pk_bf16_f32 v36, v184, v185
    v_cvt_pk_bf16_f32 v38, v188, v189
    v_cvt_pk_bf16_f32 v37, v186, v187
    v_cvt_pk_bf16_f32 v39, v190, v191
    v_pk_mul_f32 v[164:165], v[164:165], v[32:33] op_sel:[0,0] op_sel_hi:[1,0]
    v_pk_mul_f32 v[166:167], v[166:167], v[32:33] op_sel:[0,0] op_sel_hi:[1,0]
    v_pk_mul_f32 v[168:169], v[168:169], v[32:33] op_sel:[0,0] op_sel_hi:[1,0]
    s_add_u32 m0, s67, 73728
    s_add_u32 s86, s88, 12288
    buffer_load_dwordx4 v3, s[40:43], s86 offen sc1 lds
    v_pk_mul_f32 v[170:171], v[170:171], v[32:33] op_sel:[0,0] op_sel_hi:[1,0]
    v_cvt_pk_bf16_f32 v40, v164, v165
    v_cvt_pk_bf16_f32 v42, v168, v169
    v_cvt_pk_bf16_f32 v41, v166, v167
    v_cvt_pk_bf16_f32 v43, v170, v171
    v_pk_mul_f32 v[22:23], v[22:23], v[34:35] op_sel:[0,0] op_sel_hi:[1,0]
    v_pk_mul_f32 v[24:25], v[24:25], v[34:35] op_sel:[0,0] op_sel_hi:[1,0]
    v_pk_mul_f32 v[26:27], v[26:27], v[34:35] op_sel:[0,0] op_sel_hi:[1,0]
    v_pk_mul_f32 v[28:29], v[28:29], v[34:35] op_sel:[0,0] op_sel_hi:[1,0]
    v_cvt_pk_bf16_f32 v60, v22, v23
    s_add_u32 m0, s67, 77824
    s_add_u32 s86, s88, 16384
    buffer_load_dwordx4 v3, s[40:43], s86 offen sc1 lds
    v_cvt_pk_bf16_f32 v62, v26, v27
    v_cvt_pk_bf16_f32 v61, v24, v25
    v_cvt_pk_bf16_f32 v63, v28, v29
    v_permlane32_swap_b32 v36, v38
    v_permlane32_swap_b32 v37, v39
    v_permlane32_swap_b32 v40, v42
    v_permlane32_swap_b32 v41, v43
    v_permlane32_swap_b32 v60, v62
    v_permlane32_swap_b32 v61, v63
    v_permlane16_swap_b32 v36, v37
    s_add_u32 m0, s67, 81920
    s_add_u32 s86, s88, 20480
    buffer_load_dwordx4 v3, s[40:43], s86 offen sc1 lds
    v_permlane16_swap_b32 v38, v39
    v_permlane16_swap_b32 v40, v41
    v_permlane16_swap_b32 v42, v43
    v_permlane16_swap_b32 v60, v61
    v_permlane16_swap_b32 v62, v63
    v_perm_b32 v22, v36, v36, v17
    v_perm_b32 v23, v36, v36, v18
    v_perm_b32 v24, v36, v36, v19
    v_perm_b32 v25, v36, v36, v20
    v_perm_b32 v26, v37, v37, v17
    v_perm_b32 v27, v37, v37, v18
    v_mfma_f32_16x16x32_bf16 v[82:85], v[212:215], v[22:25], 0
    v_perm_b32 v28, v37, v37, v19
    v_perm_b32 v29, v37, v37, v20
    v_mfma_f32_16x16x32_bf16 v[98:101], v[66:69], v[22:25], 0
    v_perm_b32 v74, v38, v38, v17
    v_perm_b32 v75, v38, v38, v18
    v_mfma_f32_16x16x32_bf16 v[86:89], v[224:227], v[26:29], 0
    v_perm_b32 v76, v38, v38, v19
    v_perm_b32 v77, v38, v38, v20
    v_mfma_f32_16x16x32_bf16 v[102:105], v[66:69], v[26:29], 0
    v_perm_b32 v78, v39, v39, v17
    v_perm_b32 v79, v39, v39, v18
    v_mfma_f32_16x16x32_bf16 v[90:93], v[236:239], v[74:77], 0
    v_perm_b32 v80, v39, v39, v19
    v_perm_b32 v81, v39, v39, v20
    v_mfma_f32_16x16x32_bf16 v[106:109], v[66:69], v[74:77], 0
    v_perm_b32 v114, v40, v40, v17
    v_perm_b32 v115, v40, v40, v18
    v_mfma_f32_16x16x32_bf16 v[94:97], v[248:251], v[78:81], 0
    v_perm_b32 v116, v40, v40, v19
    v_perm_b32 v117, v40, v40, v20
    v_mfma_f32_16x16x32_bf16 v[110:113], v[66:69], v[78:81], 0
    v_perm_b32 v118, v41, v41, v17
    v_perm_b32 v119, v41, v41, v18
    v_mfma_f32_16x16x32_bf16 v[130:133], v[214:217], v[114:117], 0
    v_perm_b32 v120, v41, v41, v19
    v_perm_b32 v121, v41, v41, v20
    v_mfma_f32_16x16x32_bf16 v[146:149], v[68:71], v[114:117], 0
    v_perm_b32 v122, v42, v42, v17
    v_perm_b32 v123, v42, v42, v18
    v_mfma_f32_16x16x32_bf16 v[134:137], v[226:229], v[118:121], 0
    v_perm_b32 v124, v42, v42, v19
    v_perm_b32 v125, v42, v42, v20
    v_mfma_f32_16x16x32_bf16 v[150:153], v[68:71], v[118:121], 0
    v_perm_b32 v126, v43, v43, v17
    v_perm_b32 v127, v43, v43, v18
    v_mfma_f32_16x16x32_bf16 v[138:141], v[238:241], v[122:125], 0
    v_perm_b32 v128, v43, v43, v19
    v_perm_b32 v129, v43, v43, v20
    v_mfma_f32_16x16x32_bf16 v[154:157], v[68:71], v[122:125], 0
    v_cvt_pk_bf16_f32 v22, v82, v83
    v_cvt_pk_bf16_f32 v23, v84, v85
    v_mfma_f32_16x16x32_bf16 v[142:145], v[250:253], v[126:129], 0
    v_cvt_pk_bf16_f32 v24, v86, v87
    v_cvt_pk_bf16_f32 v25, v88, v89
    v_mfma_f32_16x16x32_bf16 v[158:161], v[68:71], v[126:129], 0
    buffer_store_dwordx4 v[22:25], v56, s[36:39], s63 offen sc1
    v_cvt_pk_bf16_f32 v26, v90, v91
    v_cvt_pk_bf16_f32 v27, v92, v93
    v_cvt_pk_bf16_f32 v28, v94, v95
    v_cvt_pk_bf16_f32 v29, v96, v97
    buffer_store_dwordx4 v[26:29], v56, s[36:39], s64 offen sc1
    v_perm_b32 v74, v60, v60, v17
    v_perm_b32 v75, v60, v60, v18
    v_perm_b32 v76, v60, v60, v19
    v_perm_b32 v77, v60, v60, v20
    v_perm_b32 v78, v61, v61, v17
    v_perm_b32 v79, v61, v61, v18
    v_mfma_f32_16x16x32_bf16 v[170:173], v[216:219], v[74:77], 0
    v_perm_b32 v80, v61, v61, v19
    v_perm_b32 v81, v61, v61, v20
    v_mfma_f32_16x16x32_bf16 v[186:189], v[70:73], v[74:77], 0
    v_perm_b32 v162, v62, v62, v17
    v_perm_b32 v163, v62, v62, v18
    v_mfma_f32_16x16x32_bf16 v[174:177], v[228:231], v[78:81], 0
    v_perm_b32 v164, v62, v62, v19
    v_perm_b32 v165, v62, v62, v20
    v_mfma_f32_16x16x32_bf16 v[190:193], v[70:73], v[78:81], 0
    v_perm_b32 v166, v63, v63, v17
    v_perm_b32 v167, v63, v63, v18
    v_mfma_f32_16x16x32_bf16 v[178:181], v[240:243], v[162:165], 0
    v_perm_b32 v168, v63, v63, v19
    v_perm_b32 v169, v63, v63, v20
    v_mfma_f32_16x16x32_bf16 v[194:197], v[70:73], v[162:165], 0
    v_cvt_pk_bf16_f32 v202, v130, v131
    v_cvt_pk_bf16_f32 v203, v132, v133
    v_mfma_f32_16x16x32_bf16 v[182:185], v[252:255], v[166:169], 0
    v_cvt_pk_bf16_f32 v204, v134, v135
    v_cvt_pk_bf16_f32 v205, v136, v137
    v_mfma_f32_16x16x32_bf16 v[198:201], v[70:73], v[166:169], 0
    buffer_store_dwordx4 v[202:205], v55, s[36:39], s63 offen sc1
    v_cvt_pk_bf16_f32 v206, v138, v139
    v_cvt_pk_bf16_f32 v207, v140, v141
    v_cvt_pk_bf16_f32 v208, v142, v143
    v_cvt_pk_bf16_f32 v209, v144, v145
    buffer_store_dwordx4 v[206:209], v55, s[36:39], s64 offen sc1
    v_cvt_pk_bf16_f32 v220, v170, v171
    v_cvt_pk_bf16_f32 v221, v172, v173
    v_cvt_pk_bf16_f32 v222, v174, v175
    v_cvt_pk_bf16_f32 v223, v176, v177
    buffer_store_dwordx4 v[220:223], v54, s[36:39], s63 offen sc1
    v_cvt_pk_bf16_f32 v232, v178, v179
    v_cvt_pk_bf16_f32 v233, v180, v181
    v_cvt_pk_bf16_f32 v234, v182, v183
    v_cvt_pk_bf16_f32 v235, v184, v185
    buffer_store_dwordx4 v[232:235], v54, s[36:39], s64 offen sc1
    s_mov_b64 exec, s[4:5]
    v_cvt_pk_bf16_f32 v44, v98, v99
    v_cvt_pk_bf16_f32 v45, v100, v101
    v_cvt_pk_bf16_f32 v210, v146, v147
    v_cvt_pk_bf16_f32 v211, v148, v149
    v_cvt_pk_bf16_f32 v244, v186, v187
    v_cvt_pk_bf16_f32 v245, v188, v189
    s_mov_b64 exec, s[6:7]
    v_cvt_pk_bf16_f32 v44, v102, v103
    v_cvt_pk_bf16_f32 v45, v104, v105
    v_cvt_pk_bf16_f32 v210, v150, v151
    v_cvt_pk_bf16_f32 v211, v152, v153
    v_cvt_pk_bf16_f32 v244, v190, v191
    v_cvt_pk_bf16_f32 v245, v192, v193
    s_mov_b64 exec, s[8:9]
    v_cvt_pk_bf16_f32 v44, v106, v107
    v_cvt_pk_bf16_f32 v45, v108, v109
    v_cvt_pk_bf16_f32 v210, v154, v155
    v_cvt_pk_bf16_f32 v211, v156, v157
    v_cvt_pk_bf16_f32 v244, v194, v195
    v_cvt_pk_bf16_f32 v245, v196, v197
    s_mov_b64 exec, s[10:11]
    v_cvt_pk_bf16_f32 v44, v110, v111
    v_cvt_pk_bf16_f32 v45, v112, v113
    v_cvt_pk_bf16_f32 v210, v158, v159
    v_cvt_pk_bf16_f32 v211, v160, v161
    v_cvt_pk_bf16_f32 v244, v198, v199
    v_cvt_pk_bf16_f32 v245, v200, v201
    s_mov_b64 exec, -1
    buffer_store_dwordx2 v[44:45], v59, s[36:39], s65 offen sc1
    buffer_store_dwordx2 v[210:211], v58, s[36:39], s65 offen sc1
    buffer_store_dwordx2 v[244:245], v57, s[36:39], s65 offen sc1
    s_nop 1
    s_add_u32 s86, s87, 61440
    buffer_load_dwordx4 v[96:99], v3, s[40:43], s86 offen sc1
    buffer_load_dwordx4 v[100:103], v3, s[40:43], s86 offen offset:1024 sc1
    buffer_load_dwordx4 v[104:107], v3, s[40:43], s86 offen offset:2048 sc1
    buffer_load_dwordx4 v[108:111], v3, s[40:43], s86 offen offset:3072 sc1
    buffer_load_dwordx4 v[112:115], v4, s[40:43], s86 offen sc1
    s_add_u32 s12, s89, 0
    s_sub_u32 s13, s89, 0
    v_lshlrev_b32_e64 v5, 4, v0
    v_add_u32 v6, 1024, v5
    v_and_b32 v6, 4095, v6
    v_add_u32 v7, 2048, v5
    v_and_b32 v7, 4095, v7
    v_add_u32 v8, 3072, v5
    v_and_b32 v8, 4095, v8
    s_mul_i32 s70, s84, 178496
    v_bfe_u32 v14, v0, 3, 1
    v_mul_u32_u24 v14, 175707, v14
    v_add_u32 v14, s70, v14
    v_lshrrev_b32 v12, 19, v14
    v_and_b32 v14, 7, v0
    v_cmp_gt_u32 vcc, 4, v14
    s_mul_i32 s70, s60, 3
    v_add_u32 v14, s70, v14
    v_cndmask_b32 v14, 13, v14, vcc
    v_mad_u32_u24 v12, v12, 14, v14
    v_lshlrev_b32 v12, 7, v12
    v_add_u32 v12, 32768, v12
    s_mov_b32 s56, s18
    s_mov_b32 s57, s19
    s_mov_b32 s58, 2621440
    s_mov_b32 s59, 0x20000
    s_and_b32 s70, s60, 1
    s_add_u32 s70, s70, 72
    s_mul_i32 s28, s70, 5120
    s_add_u32 s28, s28, s88
    s_sub_u32 s28, s28, s67
    s_lshl_b32 s29, s70, 12
    s_add_u32 s29, s29, s3
    s_add_u32 s70, s60, 0
    s_and_b32 s70, s70, 3
    s_mul_i32 s71, s70, 15360
    v_add_u32 v27, s71, v3
    s_add_u32 s70, s60, 1
    s_and_b32 s70, s70, 3
    s_mul_i32 s71, s70, 15360
    v_add_u32 v24, s71, v3
    s_add_u32 s70, s60, 2
    s_and_b32 s70, s70, 3
    s_mul_i32 s71, s70, 15360
    s_add_u32 s71, s71, 5120
    v_add_u32 v25, s71, v3
    s_add_u32 s70, s60, 3
    s_and_b32 s70, s70, 3
    s_mul_i32 s71, s70, 15360
    s_add_u32 s71, s71, 10240
    v_add_u32 v26, s71, v3
    s_lshl_b32 s70, s84, 6
    s_lshl4_add_u32 s71, s60, s70
    s_lshl_b32 s80, s84, 6
    s_lshl4_add_u32 s80, s60, s80
    s_lshl3_add_u32 s80, s80, s85
    s_mul_i32 s80, s80, 160
    v_cmp_gt_u32 vcc, 32, v1
    v_mul_u32_u24 v22, 6554, v1
    v_lshrrev_b32 v22, 16, v22
    v_mul_u32_u24 v22, 1120, v22
    v_add3_u32 v136, v22, v3, s80
    v_add_u32 v22, 64, v1
    v_mul_u32_u24 v22, 6554, v22
    v_lshrrev_b32 v22, 16, v22
    v_mul_u32_u24 v22, 1120, v22
    v_add3_u32 v137, v22, v3, s80
    v_add_u32 v22, 128, v1
    v_mul_u32_u24 v22, 6554, v22
    v_lshrrev_b32 v22, 16, v22
    v_mul_u32_u24 v22, 1120, v22
    v_add3_u32 v138, v22, v3, s80
    v_mov_b32 v22, 2147418112
    v_cndmask_b32 v138, v22, v138, vcc
    s_mul_i32 s101, s60, 3072
    s_add_u32 s101, s101, 61440
    s_mul_i32 s69, s60, 15360
    v_and_b32 v22, 15, v0
    v_mul_u32_u24 v10, 160, v22
    v_lshrrev_b32 v23, 4, v1
    v_lshlrev_b32 v23, 3, v23
    v_add3_u32 v11, v10, v23, s69
    v_add_u32 v10, v11, v23
    s_mul_i32 s80, s60, 12288
    s_sub_u32 s80, 61440, s80
    s_add_u32 s69, s69, s80
    v_add_u32 v28, s80, v10
    v_add_u32 v29, s80, v11
    s_lshl2_add_u32 s80, s71, 8192
    v_lshl_add_u32 v22, v22, 2, s80
    s_mul_i32 s70, s71, 2979
    s_lshr_b32 s70, s70, 19
    s_lshl_b32 s70, s70, 10
    s_add_u32 s70, s70, 53248
    v_and_b32 v23, 7, v0
    v_lshl_add_u32 v13, v23, 7, s70
    v_lshrrev_b32 v9, 5, v1
    v_mul_u32_u24 v9, 1536, v9
    s_lshl_b32 s70, s60, 9
    v_add3_u32 v9, v9, v3, s70
    v_mov_b32 v142, s100
    v_mov_b32 v143, 2147418112
    v_cmp_eq_u32 vcc, 0, v0
    s_nop 1
    v_cndmask_b32 v142, v143, v142, vcc
    v_mov_b32 v143, 1
    s_waitcnt vmcnt(5)
    s_barrier
    buffer_store_dword v143, v142, s[44:47], 0 offen sc1
    buffer_load_dword v14, v12, s[44:47], 0 offen sc1
    buffer_load_dword v22, v22, s[44:47], 0 offen sc1
    s_mov_b32 m0, s69
    s_nop 0
    buffer_load_dwordx4 v136, s[24:27], 0 offen offset:0 lds
    buffer_load_dwordx4 v137, s[24:27], 0 offen offset:1024 lds
    buffer_load_dwordx4 v138, s[24:27], 0 offen offset:2048 lds
    s_mov_b32 s86, s28
    buffer_load_dwordx4 v[116:119], v3, s[40:43], s86 offen sc1
    buffer_load_dwordx4 v[120:123], v3, s[40:43], s86 offen offset:1024 sc1
    buffer_load_dwordx4 v[124:127], v3, s[40:43], s86 offen offset:2048 sc1
    buffer_load_dwordx4 v[128:131], v3, s[40:43], s86 offen offset:3072 sc1
    buffer_load_dwordx4 v[132:135], v4, s[40:43], s86 offen sc1
    s_waitcnt vmcnt(9)
    v_cmp_ne_u32 vcc, 1, v14
    s_nop 0
    s_cbranch_vccnz L_fspin_qkv
L_fback_qkv:
    s_branch L_p2
L_fspin_qkv:
    s_mov_b32 s81, 0
L_fspin2_qkv:
    buffer_load_dword v14, v12, s[44:47], 0 offen sc1
    s_add_u32 s81, s81, 1
    s_waitcnt vmcnt(0)
    v_cmp_ne_u32 vcc, 1, v14
    s_cmp_lt_u32 s81, 0x40000
    s_nop 0
    s_cbranch_vccz L_fback_qkv
    s_sleep 2
    s_cbranch_scc1 L_fspin2_qkv
    s_branch L_fback_qkv
L_spin_qkve:
    s_mov_b32 s81, 0
L_spin2_qkve:
    s_sleep 8
    buffer_load_dwordx4 v[22:25], v60, s[44:47], 0 offen sc1
    s_add_u32 s81, s81, 1
    s_waitcnt vmcnt(0)
    v_and_b32 v22, v22, v23
    v_and_b32 v24, v24, v25
    v_and_b32 v22, v22, v24
    v_cmp_ne_u32 vcc, s83, v22
    s_cmp_lt_u32 s81, 0x40000
    s_nop 1
    s_cbranch_vccz L_back_qkve
    s_cbranch_scc1 L_spin2_qkve
    s_branch L_back_qkve
L_spin_qkvr:
    s_mov_b32 s81, 0
L_spin2_qkvr:
    s_sleep 8
    buffer_load_dword v75, off, s[52:55], 0 sc1
    s_add_u32 s81, s81, 1
    s_waitcnt vmcnt(0)
    v_cmp_ne_u32 vcc, 1, v75
    s_cmp_lt_u32 s81, 0x40000
    s_nop 1
    s_cbranch_vccz L_back_qkvr
    s_cbranch_scc1 L_spin2_qkvr
    s_branch L_back_qkvr
.p2align 6
.p2align 12,,1408
L_spare:
    s_and_b32 s63, s2, 4
    s_lshl_b32 s63, s63, 8
    s_and_b32 s64, s2, 0xf8
    s_lshl2_add_u32 s63, s64, s63
    s_and_b32 s64, s2, 3
    s_lshl3_add_u32 s63, s64, s63
    v_lshrrev_b32 v44, 5, v0
    v_add_u32 v44, s63, v44
    v_mul_u32_u24 v46, 1280, v44
    v_and_b32 v47, 31, v0
    v_lshl_add_u32 v45, v47, 2, v46
    s_waitcnt lgkmcnt(0)
    s_mov_b32 s24, s4
    s_mov_b32 s25, s5
    s_mov_b32 s26, 2621440
    s_mov_b32 s27, 0x20000
    s_add_u32 s44, s22, 14680064
    s_addc_u32 s45, s23, 0
    s_mov_b32 s46, 65536
    s_mov_b32 s47, 0x20000
    s_mov_b32 s52, s20
    s_mov_b32 s53, s21
    s_mov_b32 s54, 256
    s_mov_b32 s55, 0x20000
    s_mov_b32 s36, s22
    s_mov_b32 s37, s23
    s_mov_b32 s38, 9699328
    s_mov_b32 s39, 0x20000
    s_add_u32 s40, s22, 10485760
    s_addc_u32 s41, s23, 0
    s_mov_b32 s42, 3031040
    s_mov_b32 s43, 0x20000
    s_cmp_eq_u32 s2, 254
    s_cbranch_scc0 L_noreset
    v_mov_b32 v52, 0
    v_mov_b32 v53, 0
    v_mov_b32 v54, 0
    v_mov_b32 v55, 0
    v_lshlrev_b32 v48, 4, v0
    v_add_u32 v48, 20480, v48
    v_lshlrev_b32 v49, 7, v0
    v_add_u32 v49, 32768, v49
    buffer_store_dwordx4 v[52:55], v48, s[44:47], 0 offen sc1
    buffer_store_dwordx4 v[52:55], v49, s[44:47], 0 offen sc1
    v_lshlrev_b32 v48, 8, v0
    v_mov_b32 v49, 1
    s_waitcnt vmcnt(0)
    s_barrier
    buffer_store_dword v49, v48, s[52:55], 0 offen sc1
L_noreset:
    s_mov_b32 s28, s6
    s_mov_b32 s29, s7
    s_mov_b32 s30, 2457600
    s_mov_b32 s31, 0x20000
    s_mov_b32 s32, s12
    s_mov_b32 s33, s13
    s_mov_b32 s34, 2211840
    s_mov_b32 s35, 0x20000
    s_mov_b32 s48, s14
    s_mov_b32 s49, s15
    s_mov_b32 s50, 2211840
    s_mov_b32 s51, 0x20000
    s_bfe_u32 s63, s2, 0x10002
    s_mul_i32 s63, s63, 3
    s_and_b32 s64, s2, 3
    s_add_u32 s63, s63, s64
    s_lshl_b32 s63, s63, 15
    v_lshl_add_u32 v56, v0, 7, s63
    v_add_u32 v57, 983040, v56
    buffer_load_dword a255, v57, s[28:31], 0 offen
    buffer_load_dword v24, v45, s[24:27], 0 offen offset:0
    buffer_load_dword v25, v45, s[24:27], 0 offen offset:128
    buffer_load_dword v26, v45, s[24:27], 0 offen offset:256
    buffer_load_dword v27, v45, s[24:27], 0 offen offset:384
    buffer_load_dword v28, v45, s[24:27], 0 offen offset:512
    buffer_load_dword v29, v45, s[24:27], 0 offen offset:640
    buffer_load_dword v30, v45, s[24:27], 0 offen offset:768
    buffer_load_dword v31, v45, s[24:27], 0 offen offset:896
    buffer_load_dword v32, v45, s[24:27], 0 offen offset:1024
    buffer_load_dword v33, v45, s[24:27], 0 offen offset:1152
    v_add_u32 v57, 1179648, v56
    buffer_load_dword a255, v57, s[28:31], 0 offen
    v_add_u32 v57, 1376256, v56
    buffer_load_dword a255, v57, s[28:31], 0 offen
    s_waitcnt vmcnt(2)
    v_lshlrev_b32 v34, 16, v24
    v_and_b32 v24, 0xffff0000, v24
    v_lshlrev_b32 v35, 16, v25
    v_and_b32 v25, 0xffff0000, v25
    v_lshlrev_b32 v36, 16, v26
    v_and_b32 v26, 0xffff0000, v26
    v_lshlrev_b32 v37, 16, v27
    v_and_b32 v27, 0xffff0000, v27
    v_lshlrev_b32 v38, 16, v28
    v_and_b32 v28, 0xffff0000, v28
    v_lshlrev_b32 v39, 16, v29
    v_and_b32 v29, 0xffff0000, v29
    v_lshlrev_b32 v40, 16, v30
    v_and_b32 v30, 0xffff0000, v30
    v_lshlrev_b32 v41, 16, v31
    v_and_b32 v31, 0xffff0000, v31
    v_lshlrev_b32 v42, 16, v32
    v_and_b32 v32, 0xffff0000, v32
    v_lshlrev_b32 v43, 16, v33
    v_and_b32 v33, 0xffff0000, v33
    v_add_f32 v45, v24, v25
    v_add_f32 v46, v34, v35
    v_add_f32 v45, v45, v26
    v_add_f32 v46, v46, v36
    v_add_f32 v45, v45, v27
    v_add_f32 v46, v46, v37
    v_add_f32 v45, v45, v28
    v_add_f32 v46, v46, v38
    v_add_f32 v45, v45, v29
    v_add_f32 v46, v46, v39
    v_add_f32 v45, v45, v30
    v_add_f32 v46, v46, v40
    v_add_f32 v45, v45, v31
    v_add_f32 v46, v46, v41
    v_add_f32 v45, v45, v32
    v_add_f32 v46, v46, v42
    v_add_f32 v45, v45, v33
    v_add_f32 v46, v46, v43
    v_add_f32 v45, v45, v46
    s_nop 1
    v_add_f32_dpp v45, v45, v45 row_ror:8 row_mask:0xf bank_mask:0xf
    s_nop 1
    v_add_f32_dpp v45, v45, v45 row_ror:4 row_mask:0xf bank_mask:0xf
    s_nop 1
    v_add_f32_dpp v45, v45, v45 row_ror:2 row_mask:0xf bank_mask:0xf
    s_nop 1
    v_add_f32_dpp v45, v45, v45 row_ror:1 row_mask:0xf bank_mask:0xf
    v_mov_b32 v46, v45
    s_nop 1
    v_permlane16_swap_b32 v45, v46
    v_add_f32 v45, v45, v46
    v_mul_f32 v45, 0x3acccccd, v45
    v_sub_f32 v24, v24, v45
    v_sub_f32 v25, v25, v45
    v_sub_f32 v26, v26, v45
    v_sub_f32 v27, v27, v45
    v_sub_f32 v28, v28, v45
    v_sub_f32 v29, v29, v45
    v_sub_f32 v30, v30, v45
    v_sub_f32 v31, v31, v45
    v_sub_f32 v32, v32, v45
    v_sub_f32 v33, v33, v45
    v_sub_f32 v34, v34, v45
    v_sub_f32 v35, v35, v45
    v_sub_f32 v36, v36, v45
    v_sub_f32 v37, v37, v45
    v_sub_f32 v38, v38, v45
    v_sub_f32 v39, v39, v45
    v_sub_f32 v40, v40, v45
    v_sub_f32 v41, v41, v45
    v_sub_f32 v42, v42, v45
    v_sub_f32 v43, v43, v45
    v_cvt_pk_bf16_f32 v47, v45, v45
    v_mul_f32 v45, v24, v24
    v_mul_f32 v46, v25, v25
    v_fmac_f32 v45, v26, v26
    v_fmac_f32 v46, v27, v27
    v_fmac_f32 v45, v28, v28
    v_fmac_f32 v46, v29, v29
    v_fmac_f32 v45, v30, v30
    v_fmac_f32 v46, v31, v31
    v_fmac_f32 v45, v32, v32
    v_fmac_f32 v46, v33, v33
    v_fmac_f32 v45, v34, v34
    v_fmac_f32 v46, v35, v35
    v_fmac_f32 v45, v36, v36
    v_fmac_f32 v46, v37, v37
    v_fmac_f32 v45, v38, v38
    v_fmac_f32 v46, v39, v39
    v_fmac_f32 v45, v40, v40
    v_fmac_f32 v46, v41, v41
    v_fmac_f32 v45, v42, v42
    v_fmac_f32 v46, v43, v43
    v_lshlrev_b32 v47, 16, v47
    v_add_f32 v45, v45, v46
    s_nop 1
    v_add_f32_dpp v45, v45, v45 row_ror:8 row_mask:0xf bank_mask:0xf
    s_nop 1
    v_add_f32_dpp v45, v45, v45 row_ror:4 row_mask:0xf bank_mask:0xf
    s_nop 1
    v_add_f32_dpp v45, v45, v45 row_ror:2 row_mask:0xf bank_mask:0xf
    s_nop 1
    v_add_f32_dpp v45, v45, v45 row_ror:1 row_mask:0xf bank_mask:0xf
    v_mov_b32 v46, v45
    s_nop 1
    v_permlane16_swap_b32 v45, v46
    v_add_f32 v45, v45, v46
    v_mul_f32 v45, 0x3acccccd, v45
    v_cvt_pk_bf16_f32 v45, v45, v45
    v_lshlrev_b32 v45, 16, v45
    v_add_f32 v45, 0x3727c5ac, v45
    v_cvt_pk_bf16_f32 v45, v45, v45
    v_lshlrev_b32 v45, 16, v45
    v_sqrt_f32 v45, v45
    s_nop 0
    v_cvt_pk_bf16_f32 v45, v45, v45
    v_lshlrev_b32 v45, 16, v45
    v_rcp_f32 v45, v45
    v_lshlrev_b32 v44, 2, v44
    v_and_b32 v24, 31, v0
    v_mov_b32 v25, 2147418112
    v_cmp_eq_u32 vcc, 0, v24
    v_lshl_add_u32 v44, v24, 13, v44
    s_nop 0
    v_cndmask_b32 v45, v45, v47, vcc
    v_cmp_gt_u32 vcc, 2, v24
    s_nop 0
    s_nop 0
    v_cndmask_b32 v44, v25, v44, vcc
    buffer_store_dword v45, v44, s[44:47], 0 offen sc1
    buffer_load_dword v52, off, s[52:55], 0 sc1
    v_add_u32 v57, 1572864, v56
    buffer_load_dword a255, v57, s[28:31], 0 offen
    v_add_u32 v57, 1769472, v56
    buffer_load_dword a255, v57, s[28:31], 0 offen
    s_waitcnt vmcnt(2)
    v_cmp_ne_u32 vcc, 1, v52
    s_nop 0
    s_cbranch_vccnz L_spin_sparer
L_back_sparer:
    s_barrier
    s_lshr_b32 s63, s2, 3
    s_lshl_b32 s63, s63, 5
    s_and_b32 s64, s2, 7
    s_add_u32 s63, s63, s64
    s_lshl2_add_u32 s63, s63, 20480
    v_cmp_eq_u32 vcc, 0, v0
    v_mov_b32 v48, s63
    v_mov_b32 v49, 2147418112
    v_cndmask_b32 v48, v49, v48, vcc
    v_mov_b32 v49, 1
    buffer_store_dword v49, v48, s[44:47], 0 offen sc1
    v_add_u32 v57, 1966080, v56
    buffer_load_dword a255, v57, s[28:31], 0 offen
    v_add_u32 v57, 2162688, v56
    buffer_load_dword a255, v57, s[28:31], 0 offen
    v_add_u32 v57, 2359296, v56
    buffer_load_dword a255, v57, s[28:31], 0 offen
    v_add_u32 v57, 1548288, v56
    buffer_load_dword a255, v57, s[32:35], 0 offen
    v_add_u32 v57, 1548288, v56
    buffer_load_dword a255, v57, s[48:51], 0 offen
    v_add_u32 v57, 1744896, v56
    buffer_load_dword a255, v57, s[32:35], 0 offen
    v_add_u32 v57, 1744896, v56
    buffer_load_dword a255, v57, s[48:51], 0 offen
    v_add_u32 v57, 1941504, v56
    buffer_load_dword a255, v57, s[32:35], 0 offen
    v_add_u32 v57, 1941504, v56
    buffer_load_dword a255, v57, s[48:51], 0 offen
    v_add_u32 v57, 2138112, v56
    buffer_load_dword a255, v57, s[32:35], 0 offen
    v_add_u32 v57, 2138112, v56
    buffer_load_dword a255, v57, s[48:51], 0 offen
    s_cmp_eq_u32 s2, 254
    s_cbranch_scc1 L_gather
    s_branch L_gathered
L_gather:
    v_lshrrev_b32 v48, 1, v1
    v_lshlrev_b32 v48, 3, v48
    v_and_or_b32 v48, v1, 1, v48
    s_lshl_b32 s63, s60, 16
    s_add_u32 s63, s63, 20480
    v_lshl_add_u32 v48, v48, 4, s63
    s_cmp_eq_u32 s60, 0
    s_cselect_b32 s83, 1, 0
    buffer_load_dwordx4 v[52:55], v48, s[44:47], 0 offen sc1
    s_waitcnt vmcnt(0)
    v_and_b32 v52, v52, v53
    v_and_b32 v54, v54, v55
    v_and_b32 v52, v52, v54
    v_cmp_ne_u32 vcc, s83, v52
    s_nop 0
    s_cbranch_vccnz L_spin_sparee
L_back_sparee:
    v_lshlrev_b32 v48, 8, v0
    v_mov_b32 v49, 1
    buffer_store_dword v49, v48, s[52:55], 0 offen offset:128 sc1
L_gathered:
    buffer_load_dword v52, off, s[52:55], 0 offset:128 sc1
    s_waitcnt vmcnt(0)
    v_cmp_ne_u32 vcc, 1, v52
    s_nop 0
    s_cbranch_vccnz L_spin_spareg
L_back_spareg:
    s_and_b32 s63, s2, 7
    s_lshr_b32 s64, s2, 3
    s_lshr_b32 s84, s63, 1
    s_lshl_b32 s84, s84, 3
    s_lshr_b32 s65, s64, 2
    s_add_u32 s84, s84, s65
    s_and_b32 s85, s63, 1
    s_lshl_b32 s85, s85, 2
    s_and_b32 s65, s64, 3
    s_add_u32 s85, s85, s65
    s_mul_i32 s63, s60, 13
    s_add_u32 s63, s63, 20
    s_mul_i32 s64, s85, 378880
    s_mul_i32 s65, s63, 5120
    s_add_u32 s87, s64, s65
    s_add_u32 s88, s64, s67
    s_mul_i32 s3, s84, 303104
    s_lshl_b32 s63, s63, 12
    s_add_u32 s89, s3, s63
    v_lshlrev_b32 v3, 4, v1
    v_add_u32 v4, 4096, v3
    s_add_u32 s12, s89, 0
    s_sub_u32 s13, s89, 0
    v_lshlrev_b32 v5, 4, v0
    v_add_u32 v6, 1024, v5
    v_and_b32 v6, 4095, v6
    v_add_u32 v7, 2048, v5
    v_and_b32 v7, 4095, v7
    v_add_u32 v8, 3072, v5
    v_and_b32 v8, 4095, v8
    s_mul_i32 s70, s84, 178496
    v_bfe_u32 v14, v0, 3, 1
    v_mul_u32_u24 v14, 175707, v14
    v_add_u32 v14, s70, v14
    v_lshrrev_b32 v12, 19, v14
    v_and_b32 v14, 7, v0
    v_cmp_gt_u32 vcc, 4, v14
    s_mul_i32 s70, s60, 3
    v_add_u32 v14, s70, v14
    v_cndmask_b32 v14, 13, v14, vcc
    v_mad_u32_u24 v12, v12, 14, v14
    v_lshlrev_b32 v12, 7, v12
    v_add_u32 v12, 32768, v12
    s_mov_b32 s56, s18
    s_mov_b32 s57, s19
    s_mov_b32 s58, 2621440
    s_mov_b32 s59, 0x20000
    s_and_b32 s70, s60, 1
    s_add_u32 s70, s70, 72
    s_mul_i32 s28, s70, 5120
    s_add_u32 s28, s28, s88
    s_sub_u32 s28, s28, s67
    s_lshl_b32 s29, s70, 12
    s_add_u32 s29, s29, s3
    s_add_u32 s70, s60, 0
    s_and_b32 s70, s70, 3
    s_mul_i32 s71, s70, 15360
    v_add_u32 v27, s71, v3
    s_add_u32 s70, s60, 1
    s_and_b32 s70, s70, 3
    s_mul_i32 s71, s70, 15360
    v_add_u32 v24, s71, v3
    s_add_u32 s70, s60, 2
    s_and_b32 s70, s70, 3
    s_mul_i32 s71, s70, 15360
    s_add_u32 s71, s71, 5120
    v_add_u32 v25, s71, v3
    s_add_u32 s70, s60, 3
    s_and_b32 s70, s70, 3
    s_mul_i32 s71, s70, 15360
    s_add_u32 s71, s71, 10240
    v_add_u32 v26, s71, v3
    s_lshl_b32 s70, s84, 6
    s_lshl4_add_u32 s71, s60, s70
    s_lshl_b32 s80, s84, 6
    s_lshl4_add_u32 s80, s60, s80
    s_lshl3_add_u32 s80, s80, s85
    s_mul_i32 s80, s80, 160
    v_cmp_gt_u32 vcc, 32, v1
    v_mul_u32_u24 v22, 6554, v1
    v_lshrrev_b32 v22, 16, v22
    v_mul_u32_u24 v22, 1120, v22
    v_add3_u32 v136, v22, v3, s80
    v_add_u32 v22, 64, v1
    v_mul_u32_u24 v22, 6554, v22
    v_lshrrev_b32 v22, 16, v22
    v_mul_u32_u24 v22, 1120, v22
    v_add3_u32 v137, v22, v3, s80
    v_add_u32 v22, 128, v1
    v_mul_u32_u24 v22, 6554, v22
    v_lshrrev_b32 v22, 16, v22
    v_mul_u32_u24 v22, 1120, v22
    v_add3_u32 v138, v22, v3, s80
    v_mov_b32 v22, 2147418112
    v_cndmask_b32 v138, v22, v138, vcc
    s_mul_i32 s101, s60, 3072
    s_add_u32 s101, s101, 61440
    s_mul_i32 s69, s60, 15360
    v_and_b32 v22, 15, v0
    v_mul_u32_u24 v10, 160, v22
    v_lshrrev_b32 v23, 4, v1
    v_lshlrev_b32 v23, 3, v23
    v_add3_u32 v11, v10, v23, s69
    v_add_u32 v10, v11, v23
    s_mul_i32 s80, s60, 12288
    s_sub_u32 s80, 61440, s80
    s_add_u32 s69, s69, s80
    v_add_u32 v28, s80, v10
    v_add_u32 v29, s80, v11
    s_lshl2_add_u32 s80, s71, 8192
    v_lshl_add_u32 v22, v22, 2, s80
    s_mul_i32 s70, s71, 2979
    s_lshr_b32 s70, s70, 19
    s_lshl_b32 s70, s70, 10
    s_add_u32 s70, s70, 53248
    v_and_b32 v23, 7, v0
    v_lshl_add_u32 v13, v23, 7, s70
    v_lshrrev_b32_e64 v9, 5, v1
    v_mul_u32_u24 v9, 1536, v9
    s_lshl_b32 s70, s60, 9
    v_add3_u32 v9, v9, v3, s70
    s_add_u32 s86, s87, 0
    buffer_load_dwordx4 a[88:91], v3, s[40:43], s86 offen sc1
    buffer_load_dwordx4 a[92:95], v3, s[40:43], s86 offen offset:1024 sc1
    buffer_load_dwordx4 a[96:99], v3, s[40:43], s86 offen offset:2048 sc1
    buffer_load_dwordx4 a[100:103], v3, s[40:43], s86 offen offset:3072 sc1
    buffer_load_dwordx4 a[104:107], v4, s[40:43], s86 offen sc1
    s_add_u32 s86, s87, 5120
    buffer_load_dwordx4 a[108:111], v3, s[40:43], s86 offen sc1
    buffer_load_dwordx4 a[112:115], v3, s[40:43], s86 offen offset:1024 sc1
    buffer_load_dwordx4 a[116:119], v3, s[40:43], s86 offen offset:2048 sc1
    buffer_load_dwordx4 a[120:123], v3, s[40:43], s86 offen offset:3072 sc1
    buffer_load_dwordx4 a[124:127], v4, s[40:43], s86 offen sc1
    s_add_u32 s86, s87, 10240
    buffer_load_dwordx4 a[128:131], v3, s[40:43], s86 offen sc1
    buffer_load_dwordx4 a[132:135], v3, s[40:43], s86 offen offset:1024 sc1
    buffer_load_dwordx4 a[136:139], v3, s[40:43], s86 offen offset:2048 sc1
    buffer_load_dwordx4 a[140:143], v3, s[40:43], s86 offen offset:3072 sc1
    buffer_load_dwordx4 a[144:147], v4, s[40:43], s86 offen sc1
    s_add_u32 s86, s87, 15360
    buffer_load_dwordx4 a[148:151], v3, s[40:43], s86 offen sc1
    buffer_load_dwordx4 a[152:155], v3, s[40:43], s86 offen offset:1024 sc1
    buffer_load_dwordx4 a[156:159], v3, s[40:43], s86 offen offset:2048 sc1
    buffer_load_dwordx4 a[160:163], v3, s[40:43], s86 offen offset:3072 sc1
    buffer_load_dwordx4 a[164:167], v4, s[40:43], s86 offen sc1
    s_add_u32 s86, s87, 20480
    buffer_load_dwordx4 a[168:171], v3, s[40:43], s86 offen sc1
    buffer_load_dwordx4 a[172:175], v3, s[40:43], s86 offen offset:1024 sc1
    buffer_load_dwordx4 a[176:179], v3, s[40:43], s86 offen offset:2048 sc1
    buffer_load_dwordx4 a[180:183], v3, s[40:43], s86 offen offset:3072 sc1
    buffer_load_dwordx4 a[184:187], v4, s[40:43], s86 offen sc1
    s_add_u32 s86, s87, 25600
    buffer_load_dwordx4 a[188:191], v3, s[40:43], s86 offen sc1
    buffer_load_dwordx4 a[192:195], v3, s[40:43], s86 offen offset:1024 sc1
    buffer_load_dwordx4 a[196:199], v3, s[40:43], s86 offen offset:2048 sc1
    buffer_load_dwordx4 a[200:203], v3, s[40:43], s86 offen offset:3072 sc1
    buffer_load_dwordx4 a[204:207], v4, s[40:43], s86 offen sc1
    s_add_u32 s86, s87, 30720
    buffer_load_dwordx4 a[208:211], v3, s[40:43], s86 offen sc1
    buffer_load_dwordx4 a[212:215], v3, s[40:43], s86 offen offset:1024 sc1
    buffer_load_dwordx4 a[216:219], v3, s[40:43], s86 offen offset:2048 sc1
    buffer_load_dwordx4 a[220:223], v3, s[40:43], s86 offen offset:3072 sc1
    buffer_load_dwordx4 a[224:227], v4, s[40:43], s86 offen sc1
    s_add_u32 s86, s87, 35840
    buffer_load_dwordx4 a[228:231], v3, s[40:43], s86 offen sc1
    buffer_load_dwordx4 a[232:235], v3, s[40:43], s86 offen offset:1024 sc1
    buffer_load_dwordx4 a[236:239], v3, s[40:43], s86 offen offset:2048 sc1
    buffer_load_dwordx4 a[240:243], v3, s[40:43], s86 offen offset:3072 sc1
    buffer_load_dwordx4 a[244:247], v4, s[40:43], s86 offen sc1
    s_add_u32 s86, s87, 40960
    buffer_load_dwordx4 a[0:3], v3, s[40:43], s86 offen sc1
    buffer_load_dwordx4 a[4:7], v3, s[40:43], s86 offen offset:1024 sc1
    buffer_load_dwordx4 a[8:11], v3, s[40:43], s86 offen offset:2048 sc1
    buffer_load_dwordx4 a[12:15], v3, s[40:43], s86 offen offset:3072 sc1
    buffer_load_dwordx4 a[16:19], v4, s[40:43], s86 offen sc1
    s_add_u32 s86, s87, 46080
    buffer_load_dwordx4 a[20:23], v3, s[40:43], s86 offen sc1
    buffer_load_dwordx4 a[24:27], v3, s[40:43], s86 offen offset:1024 sc1
    buffer_load_dwordx4 a[28:31], v3, s[40:43], s86 offen offset:2048 sc1
    buffer_load_dwordx4 a[32:35], v3, s[40:43], s86 offen offset:3072 sc1
    buffer_load_dwordx4 a[36:39], v4, s[40:43], s86 offen sc1
    s_add_u32 s86, s87, 51200
    buffer_load_dwordx4 a[40:43], v3, s[40:43], s86 offen sc1
    buffer_load_dwordx4 a[44:47], v3, s[40:43], s86 offen offset:1024 sc1
    buffer_load_dwordx4 a[48:51], v3, s[40:43], s86 offen offset:2048 sc1
    buffer_load_dwordx4 a[52:55], v3, s[40:43], s86 offen offset:3072 sc1
    buffer_load_dwordx4 a[56:59], v4, s[40:43], s86 offen sc1
    s_add_u32 s86, s87, 56320
    buffer_load_dwordx4 a[60:63], v3, s[40:43], s86 offen sc1
    buffer_load_dwordx4 a[64:67], v3, s[40:43], s86 offen offset:1024 sc1
    buffer_load_dwordx4 a[68:71], v3, s[40:43], s86 offen offset:2048 sc1
    buffer_load_dwordx4 a[72:75], v3, s[40:43], s86 offen offset:3072 sc1
    buffer_load_dwordx4 a[76:79], v4, s[40:43], s86 offen sc1
    s_add_u32 s86, s87, 61440
    buffer_load_dwordx4 v[96:99], v3, s[40:43], s86 offen sc1
    buffer_load_dwordx4 v[100:103], v3, s[40:43], s86 offen offset:1024 sc1
    buffer_load_dwordx4 v[104:107], v3, s[40:43], s86 offen offset:2048 sc1
    buffer_load_dwordx4 v[108:111], v3, s[40:43], s86 offen offset:3072 sc1
    buffer_load_dwordx4 v[112:115], v4, s[40:43], s86 offen sc1
    s_mov_b32 s86, s28
    s_nop 0
    buffer_load_dwordx4 v[116:119], v3, s[40:43], s86 offen sc1
    buffer_load_dwordx4 v[120:123], v3, s[40:43], s86 offen offset:1024 sc1
    buffer_load_dwordx4 v[124:127], v3, s[40:43], s86 offen offset:2048 sc1
    buffer_load_dwordx4 v[128:131], v3, s[40:43], s86 offen offset:3072 sc1
    buffer_load_dwordx4 v[132:135], v4, s[40:43], s86 offen sc1
    s_add_u32 m0, s67, 73728
    s_add_u32 s86, s88, 12288
    buffer_load_dwordx4 v3, s[40:43], s86 offen sc1 lds
    s_add_u32 m0, s67, 77824
    s_add_u32 s86, s88, 16384
    buffer_load_dwordx4 v3, s[40:43], s86 offen sc1 lds
    s_add_u32 m0, s67, 81920
    s_add_u32 s86, s88, 20480
    buffer_load_dwordx4 v3, s[40:43], s86 offen sc1 lds
    s_add_u32 m0, s67, 86016
    s_add_u32 s86, s88, 24576
    buffer_load_dwordx4 v3, s[40:43], s86 offen sc1 lds
    s_add_u32 m0, s67, 90112
    s_add_u32 s86, s88, 28672
    buffer_load_dwordx4 v3, s[40:43], s86 offen sc1 lds
    s_add_u32 m0, s67, 94208
    s_add_u32 s86, s88, 32768
    buffer_load_dwordx4 v3, s[40:43], s86 offen sc1 lds
    s_add_u32 m0, s67, 98304
    s_add_u32 s86, s88, 36864
    buffer_load_dwordx4 v3, s[40:43], s86 offen sc1 lds
    s_add_u32 m0, s67, 102400
    s_add_u32 s86, s88, 40960
    buffer_load_dwordx4 v3, s[40:43], s86 offen sc1 lds
    s_add_u32 m0, s67, 106496
    s_add_u32 s86, s88, 45056
    buffer_load_dwordx4 v3, s[40:43], s86 offen sc1 lds
    s_add_u32 m0, s67, 110592
    s_add_u32 s86, s88, 49152
    buffer_load_dwordx4 v3, s[40:43], s86 offen sc1 lds
    s_add_u32 m0, s67, 114688
    s_add_u32 s86, s88, 53248
    buffer_load_dwordx4 v3, s[40:43], s86 offen sc1 lds
    s_add_u32 m0, s67, 118784
    s_add_u32 s86, s88, 57344
    buffer_load_dwordx4 v3, s[40:43], s86 offen sc1 lds
    s_add_u32 m0, s67, 122880
    s_add_u32 s86, s88, 61440
    buffer_load_dwordx4 v3, s[40:43], s86 offen sc1 lds
    s_add_u32 m0, s67, 126976
    s_add_u32 s86, s88, 65536
    buffer_load_dwordx4 v3, s[40:43], s86 offen sc1 lds
    s_add_u32 m0, s67, 131072
    s_add_u32 s86, s88, 69632
    buffer_load_dwordx4 v3, s[40:43], s86 offen sc1 lds
    s_add_u32 m0, s67, 135168
    s_add_u32 s86, s88, 73728
    buffer_load_dwordx4 v3, s[40:43], s86 offen sc1 lds
    s_add_u32 m0, s67, 139264
    s_add_u32 s86, s88, 77824
    buffer_load_dwordx4 v3, s[40:43], s86 offen sc1 lds
    s_add_u32 m0, s67, 143360
    s_add_u32 s86, s88, 81920
    buffer_load_dwordx4 v3, s[40:43], s86 offen sc1 lds
    s_add_u32 m0, s67, 147456
    s_add_u32 s86, s88, 86016
    buffer_load_dwordx4 v3, s[40:43], s86 offen sc1 lds
    s_add_u32 m0, s67, 151552
    s_add_u32 s86, s88, 90112
    buffer_load_dwordx4 v3, s[40:43], s86 offen sc1 lds
    s_add_u32 m0, s67, 155648
    s_add_u32 s86, s88, 94208
    buffer_load_dwordx4 v3, s[40:43], s86 offen sc1 lds
    s_add_u32 m0, s67, 159744
    s_add_u32 s86, s88, 98304
    buffer_load_dwordx4 v3, s[40:43], s86 offen sc1 lds
    buffer_load_dword v22, v22, s[44:47], 0 offen sc1
    s_mov_b32 m0, s69
    s_nop 0
    buffer_load_dwordx4 v136, s[24:27], 0 offen offset:0 lds
    buffer_load_dwordx4 v137, s[24:27], 0 offen offset:1024 lds
    buffer_load_dwordx4 v138, s[24:27], 0 offen offset:2048 lds
    buffer_load_dword v14, v12, s[44:47], 0 offen sc1
    s_waitcnt vmcnt(0)
    v_cmp_ne_u32 vcc, 1, v14
    s_nop 0
    s_cbranch_vccnz L_fspin_spare
L_fback_spare:
    s_barrier
    s_branch L_p2
L_fspin_spare:
    s_mov_b32 s81, 0
L_fspin2_spare:
    buffer_load_dword v14, v12, s[44:47], 0 offen sc1
    s_add_u32 s81, s81, 1
    s_waitcnt vmcnt(0)
    v_cmp_ne_u32 vcc, 1, v14
    s_cmp_lt_u32 s81, 0x40000
    s_nop 0
    s_cbranch_vccz L_fback_spare
    s_sleep 16
    s_cbranch_scc1 L_fspin2_spare
    s_branch L_fback_spare
L_spin_spareg:
    s_mov_b32 s81, 0
L_spin2_spareg:
    s_sleep 8
    buffer_load_dword v52, off, s[52:55], 0 offset:128 sc1
    s_add_u32 s81, s81, 1
    s_waitcnt vmcnt(0)
    v_cmp_ne_u32 vcc, 1, v52
    s_cmp_lt_u32 s81, 0x40000
    s_nop 1
    s_cbranch_vccz L_back_spareg
    s_cbranch_scc1 L_spin2_spareg
    s_branch L_back_spareg
L_spin_sparee:
    s_mov_b32 s81, 0
L_spin2_sparee:
    s_sleep 16
    buffer_load_dwordx4 v[52:55], v48, s[44:47], 0 offen sc1
    s_add_u32 s81, s81, 1
    s_waitcnt vmcnt(0)
    v_and_b32 v52, v52, v53
    v_and_b32 v54, v54, v55
    v_and_b32 v52, v52, v54
    v_cmp_ne_u32 vcc, s83, v52
    s_cmp_lt_u32 s81, 0x40000
    s_nop 1
    s_cbranch_vccz L_back_sparee
    s_cbranch_scc1 L_spin2_sparee
    s_branch L_back_sparee
L_spin_sparer:
    s_mov_b32 s81, 0
L_spin2_sparer:
    s_sleep 8
    buffer_load_dword v52, off, s[52:55], 0 sc1
    s_add_u32 s81, s81, 1
    s_waitcnt vmcnt(0)
    v_cmp_ne_u32 vcc, 1, v52
    s_cmp_lt_u32 s81, 0x40000
    s_nop 1
    s_cbranch_vccz L_back_sparer
    s_cbranch_scc1 L_spin2_sparer
    s_branch L_back_sparer
L_codeend:
.section .rodata,"a"
.p2align 6
.amdhsa_kernel recurrent_scan__sliding_local_dilated__glu_gated_reglu__prompt_kernel
  .amdhsa_next_free_vgpr 512
  .amdhsa_next_free_sgpr 102
  .amdhsa_accum_offset 256
  .amdhsa_group_segment_fixed_size 0
  .amdhsa_kernarg_size 80
  .amdhsa_user_sgpr_count 2
  .amdhsa_user_sgpr_kernarg_segment_ptr 1
  .amdhsa_system_sgpr_workgroup_id_x 1
  .amdhsa_float_denorm_mode_32 3
.end_amdhsa_kernel
```
